```python
import torch

def _softmax(x, axis=-1):
    return torch.softmax(x, dim=axis)

def _gelu(x):
    return torch.nn.functional.gelu(x, approximate='tanh')

def _silu(x):
    return torch.nn.functional.silu(x)

def _sigmoid(x):
    return torch.sigmoid(x)

def _layernorm(x, axis=-1, eps=1e-05):
    m = x.mean(dim=axis, keepdim=True)
    v = x.var(dim=axis, keepdim=True, unbiased=False)
    return (x - m) / torch.sqrt(v + eps)

def _scatter_add(tgt, idx, src, axis=0):
    return tgt.clone().index_add_(axis, idx, src)

def _segment_sum(src, seg, n):
    out = torch.zeros((n,) + src.shape[1:], dtype=src.dtype)
    return out.index_add_(0, seg, src)

def _pad(x, pw):
    flat = tuple((v for pair in reversed(pw) for v in pair))
    return torch.nn.functional.pad(x, flat)
kernel_name = 'adaLN_cond__spectral_fnet__dense_activation_relu__prompt'

def setup_inputs():

    _w = lambda a: (lambda t: t.to(torch.bfloat16) if t.is_floating_point() else t)(torch.as_tensor(a))

    def _A_setup():
        B, S, D = (1, 2048, 576)
        ns = torch.arange(S)[:, None] * torch.arange(S)[None, :]
        nd = torch.arange(D)[:, None] * torch.arange(D)[None, :]
        Ws_re = torch.cos(-2.0 * torch.pi * ns / S).to(float)
        Ws_im = torch.sin(-2.0 * torch.pi * ns / S).to(float)
        Wd_re = torch.cos(-2.0 * torch.pi * nd / D).to(float)
        Wd_im = torch.sin(-2.0 * torch.pi * nd / D).to(float)
        return {'x': _w((lambda *s: torch.randn(*s, dtype=torch.bfloat16) * 0.05)(B, S, D)), 'dft_seq_re': _w(Ws_re), 'dft_seq_im': _w(Ws_im), 'dft_hid_re': _w(Wd_re), 'dft_hid_im': _w(Wd_im)}
    _A_in = _A_setup()

    def _B_setup():
        B, S, D, Dff = (1, 2048, 576, 4608)
        return {'x': _w((lambda *s: torch.randn(*s, dtype=torch.bfloat16) * 0.05)(B, S, D)), 'w1': _w((lambda *s: torch.randn(*s, dtype=torch.bfloat16) * 1.6)(D, Dff)), 'w2': _w((lambda *s: torch.randn(*s, dtype=torch.bfloat16) * 1.6)(Dff, D))}
    _B_in = _B_setup()
    return {'A_x': _A_in['x'], 'A_dft_seq_re': _A_in['dft_seq_re'], 'A_dft_seq_im': _A_in['dft_seq_im'], 'A_dft_hid_re': _A_in['dft_hid_re'], 'A_dft_hid_im': _A_in['dft_hid_im'], 'B_x': _B_in['x'], 'B_w1': _B_in['w1'], 'B_w2': _B_in['w2'], 'c': _w((lambda *s: torch.randn(*s, dtype=torch.bfloat16) * 0.1)(1, 576) * 8.0), 'w_mod': _w((lambda *s: torch.randn(*s, dtype=torch.bfloat16) * 0.1)(576, 6 * 576) * 576 ** (-0.5) * 8.0)}

def reference(A_x, A_dft_seq_re, A_dft_seq_im, A_dft_hid_re, A_dft_hid_im, B_x, B_w1, B_w2, c, w_mod):

    def _A_ref(x, dft_seq_re, dft_seq_im, dft_hid_re, dft_hid_im):
        a = torch.einsum('bsd,ed->bse', x, dft_hid_re)
        b = torch.einsum('bsd,ed->bse', x, dft_hid_im)
        y = torch.einsum('ts,bse->bte', dft_seq_re, a) - torch.einsum('ts,bse->bte', dft_seq_im, b)
        return y

    def _B_ref(x, w1, w2):
        h = torch.einsum('bsd,df->bsf', x, w1)
        zero = torch.zeros_like(h)
        h = torch.maximum(h, zero)
        return torch.einsum('bsf,fd->bsd', h, w2)
    x = A_x
    mod = (_silu(c) @ w_mod).reshape(c.shape[0], 6, 1, -1)
    sa, ca, ga, sb, cb, gb = (mod[:, 0].clone(), mod[:, 1].clone(), mod[:, 2].clone(), mod[:, 3].clone(), mod[:, 4].clone(), mod[:, 5].clone())
    h = _layernorm(x, axis=-1) * (1 + ca) + sa
    x = x + ga * _A_ref(h, A_dft_seq_re, A_dft_seq_im, A_dft_hid_re, A_dft_hid_im)
    h = _layernorm(x, axis=-1) * (1 + cb) + sb
    x = x + gb * _B_ref(h, B_w1, B_w2)
    return x
```

```asm
; @launch kernel=ka_kernel grid=(350,1,1) block=(256,1,1) lds=36864
; @launch kernel=kbf_kernel grid=(256,1,1) block=(256,1,1) lds=161792
.amdgcn_target "amdgcn-amd-amdhsa--gfx950"
.text
.globl ka_kernel
.p2align 8
.type ka_kernel,@function
ka_kernel:
    s_load_dwordx16 s[4:19], s[0:1], 0
    s_load_dwordx4 s[20:23], s[0:1], 64
    s_load_dwordx2 s[24:25], s[0:1], 96
    s_cmp_ge_u32 s2, 16
    s_cbranch_scc1 ka_nspf
    s_getpc_b64 s[44:45]
    v_lshlrev_b32 v5, 7, v0
    v_cmp_gt_u32 vcc, kbf_kernel-ka_kernel, v5
    s_nop 0
    s_and_saveexec_b64 s[46:47], vcc
    s_cbranch_execz ka_spf2
    global_load_dword v126, v5, s[44:45]
ka_spf2:
    s_mov_b64 exec, s[46:47]
ka_nspf:
    v_and_b32 v1, 63, v0
    v_lshrrev_b32 v2, 6, v0
    v_lshrrev_b32 v3, 3, v1
    v_and_b32 v4, 7, v1
    v_readfirstlane_b32 s26, v2
    s_mov_b32 s31, 0x20000
    s_add_u32 s27, s2, 200
    s_add_u32 s28, s2, 48
    s_cmp_lt_u32 s2, 96
    s_cselect_b32 s27, s27, s28
    s_sub_u32 s28, s2, 152
    s_cmp_lt_u32 s2, 152
    s_cselect_b32 s27, s27, s28
    s_cmp_lt_u32 s2, 296
    s_cselect_b32 s2, s27, s2
    s_cmp_ge_u32 s2, 144
    s_cbranch_scc1 ka_h1
    s_and_b32 s32, s2, 7
    s_lshr_b32 s33, s2, 3
    v_mul_u32_u24 v5, 9216, v3
    v_lshl_add_u32 v5, v4, 4, v5
    s_lshl_b32 s34, s33, 2
    s_add_u32 s34, s34, s26
    s_mul_i32 s34, s34, 73728
    s_mul_i32 s35, s32, 1152
    s_add_u32 s34, s34, s35
    s_mul_i32 m0, s26, 9216
    s_mov_b32 s30, 5308416
    v_lshlrev_b32 v20, 4, v1
    s_lshl_b32 s46, s33, 2
    s_add_u32 s46, s46, s26
    s_lshl_b32 s46, s46, 10
    s_min_u32 s46, s46, code_end-kbf_kernel-1024
    s_getpc_b64 s[44:45]
ka_pc:
    s_add_u32 s44, s44, kbf_kernel-ka_pc
    s_addc_u32 s45, s45, 0
    v_add_u32 v100, s46, v20
    global_load_dwordx4 v[112:115], v100, s[44:45]
    s_waitcnt lgkmcnt(0)
    s_mov_b32 s28, s16
    s_and_b32 s29, s17, 0xffff
    s_waitcnt vmcnt(0)
    buffer_load_dwordx4 v5, s[28:31], s34 offen lds
    s_add_u32 m0, m0, 1024
    s_add_u32 s34, s34, 128
    buffer_load_dwordx4 v5, s[28:31], s34 offen lds
    s_add_u32 m0, m0, 1024
    s_add_u32 s34, s34, 128
    buffer_load_dwordx4 v5, s[28:31], s34 offen lds
    s_add_u32 m0, m0, 1024
    s_add_u32 s34, s34, 128
    buffer_load_dwordx4 v5, s[28:31], s34 offen lds
    s_add_u32 m0, m0, 1024
    s_add_u32 s34, s34, 128
    buffer_load_dwordx4 v5, s[28:31], s34 offen lds
    s_add_u32 m0, m0, 1024
    s_add_u32 s34, s34, 128
    buffer_load_dwordx4 v5, s[28:31], s34 offen lds
    s_add_u32 m0, m0, 1024
    s_add_u32 s34, s34, 128
    buffer_load_dwordx4 v5, s[28:31], s34 offen lds
    s_add_u32 m0, m0, 1024
    s_add_u32 s34, s34, 128
    buffer_load_dwordx4 v5, s[28:31], s34 offen lds
    s_add_u32 m0, m0, 1024
    s_add_u32 s34, s34, 128
    buffer_load_dwordx4 v5, s[28:31], s34 offen lds
    s_branch ka_wpack
ka_h1:
    s_cmp_ge_u32 s2, 200
    s_cbranch_scc1 ka_h2
    s_cmp_ge_u32 s2, 198
    s_cbranch_scc1 ka_done
    s_sub_u32 s32, s2, 144
    v_mul_u32_u24 v5, 144, v2
    v_add_u32 v5, v5, v3
    v_mul_u32_u24 v6, 6912, v5
    v_lshl_add_u32 v6, v4, 4, v6
    v_lshlrev_b32 v7, 1, v0
    s_lshl_b32 s33, s32, 7
    s_mov_b32 s30, 3981312
    s_mov_b32 s38, 1152
    s_mov_b32 s39, 0x20000
    s_waitcnt lgkmcnt(0)
    s_mov_b32 s28, s22
    s_and_b32 s29, s23, 0xffff
    s_mov_b32 s36, s20
    s_and_b32 s37, s21, 0xffff
    buffer_load_ushort v8, v7, s[36:39], 0 offen offset:0
    buffer_load_ushort v9, v7, s[36:39], 0 offen offset:512
    buffer_load_ushort v10, v7, s[36:39], 0 offen offset:1024
    buffer_load_dwordx4 v[32:35], v6, s[28:31], s33 offen
    s_add_u32 s33, s33, 55296
    buffer_load_dwordx4 v[36:39], v6, s[28:31], s33 offen
    s_add_u32 s33, s33, 55296
    buffer_load_dwordx4 v[40:43], v6, s[28:31], s33 offen
    s_add_u32 s33, s33, 55296
    buffer_load_dwordx4 v[44:47], v6, s[28:31], s33 offen
    s_add_u32 s33, s33, 55296
    buffer_load_dwordx4 v[48:51], v6, s[28:31], s33 offen
    s_add_u32 s33, s33, 55296
    buffer_load_dwordx4 v[52:55], v6, s[28:31], s33 offen
    s_add_u32 s33, s33, 55296
    buffer_load_dwordx4 v[56:59], v6, s[28:31], s33 offen
    s_add_u32 s33, s33, 55296
    buffer_load_dwordx4 v[60:63], v6, s[28:31], s33 offen
    s_add_u32 s33, s33, 55296
    buffer_load_dwordx4 v[64:67], v6, s[28:31], s33 offen
    s_add_u32 s33, s33, 55296
    buffer_load_dwordx4 v[68:71], v6, s[28:31], s33 offen
    s_add_u32 s33, s33, 55296
    buffer_load_dwordx4 v[72:75], v6, s[28:31], s33 offen
    s_add_u32 s33, s33, 55296
    buffer_load_dwordx4 v[76:79], v6, s[28:31], s33 offen
    s_add_u32 s33, s33, 55296
    buffer_load_dwordx4 v[80:83], v6, s[28:31], s33 offen
    s_add_u32 s33, s33, 55296
    buffer_load_dwordx4 v[84:87], v6, s[28:31], s33 offen
    s_add_u32 s33, s33, 55296
    buffer_load_dwordx4 v[88:91], v6, s[28:31], s33 offen
    s_add_u32 s33, s33, 55296
    buffer_load_dwordx4 v[92:95], v6, s[28:31], s33 offen
    s_add_u32 s33, s33, 55296
    buffer_load_dwordx4 v[96:99], v6, s[28:31], s33 offen
    s_add_u32 s33, s33, 55296
    buffer_load_dwordx4 v[100:103], v6, s[28:31], s33 offen
    s_branch ka_mod
ka_h2:
    s_cmp_ge_u32 s2, 296
    s_cbranch_scc1 ka_pack
    s_sub_u32 s27, s2, 200
    s_and_b32 s32, s27, 7
    s_lshr_b32 s33, s27, 3
    s_mul_i32 s34, s33, 86
    s_lshr_b32 s34, s34, 8
    s_lshl_b32 s32, s32, 2
    s_add_u32 s32, s32, s34
    s_mul_i32 s34, s34, 3
    s_sub_u32 s33, s33, s34
    v_lshl_add_u32 v5, v2, 4, v3
    v_mul_u32_u24 v6, 36864, v5
    v_lshl_add_u32 v6, v4, 4, v6
    v_add_u32 v7, 294912, v6
    s_mul_i32 s45, s32, 1152
    s_mul_i32 s34, s33, 384
    s_add_u32 s35, s34, 384
    s_cmp_eq_u32 s33, 2
    s_cselect_b32 s35, 0, s35
    s_sub_u32 s36, s34, 384
    s_cmp_eq_u32 s33, 0
    s_cselect_b32 s36, 768, s36
    s_add_u32 s34, s34, s45
    s_add_u32 s35, s35, s45
    s_add_u32 s36, s36, s45
    s_mov_b32 s30, 2359296
    s_waitcnt lgkmcnt(0)
    s_mov_b32 s28, s4
    s_and_b32 s29, s5, 0xffff
    buffer_load_dwordx4 v[32:35], v6, s[28:31], s34 offen offset:0
    buffer_load_dwordx4 v[36:39], v6, s[28:31], s34 offen offset:128
    buffer_load_dwordx4 v[40:43], v6, s[28:31], s34 offen offset:256
    buffer_load_dwordx4 v[44:47], v6, s[28:31], s35 offen offset:0
    buffer_load_dwordx4 v[48:51], v6, s[28:31], s35 offen offset:128
    buffer_load_dwordx4 v[52:55], v6, s[28:31], s35 offen offset:256
    buffer_load_dwordx4 v[56:59], v6, s[28:31], s36 offen offset:0
    buffer_load_dwordx4 v[60:63], v6, s[28:31], s36 offen offset:128
    buffer_load_dwordx4 v[64:67], v6, s[28:31], s36 offen offset:256
    buffer_load_dwordx4 v[68:71], v7, s[28:31], s34 offen offset:0
    buffer_load_dwordx4 v[72:75], v7, s[28:31], s34 offen offset:128
    buffer_load_dwordx4 v[76:79], v7, s[28:31], s34 offen offset:256
    buffer_load_dwordx4 v[80:83], v7, s[28:31], s35 offen offset:0
    buffer_load_dwordx4 v[84:87], v7, s[28:31], s35 offen offset:128
    buffer_load_dwordx4 v[88:91], v7, s[28:31], s35 offen offset:256
    buffer_load_dwordx4 v[92:95], v7, s[28:31], s36 offen offset:0
    buffer_load_dwordx4 v[96:99], v7, s[28:31], s36 offen offset:128
    buffer_load_dwordx4 v[100:103], v7, s[28:31], s36 offen offset:256
    v_and_b32 v18, 15, v1
    v_lshrrev_b32 v19, 4, v1
    v_lshl_add_u32 v20, v2, 4, v18
    v_cmp_lt_u32 vcc, 32, v20
    v_subrev_u32 v21, 32, v20
    v_mov_b32 v22, s6
    v_mov_b32 v23, s7
    v_mov_b32 v24, s8
    v_mov_b32 v25, s9
    v_cndmask_b32 v21, v20, v21, vcc
    v_cndmask_b32 v22, v22, v24, vcc
    v_cndmask_b32 v23, v23, v25, vcc
    v_lshlrev_b32 v21, 17, v21
    v_lshl_add_u32 v21, v19, 4, v21
    v_add_co_u32 v22, vcc, v22, v21
    s_nop 1
    v_addc_co_u32 v23, vcc, 0, v23, vcc
    global_load_dwordx4 v[104:107], v[22:23], off
    global_load_dwordx4 v[108:111], v[22:23], off offset:64
    s_add_u32 s40, s24, 65536
    s_addc_u32 s41, s25, 0
    s_and_b32 s41, s41, 0xffff
    s_mov_b32 s42, 2359296
    s_mov_b32 s43, 0x20000
    s_mov_b32 s37, 0x3f803f80
    s_mov_b32 s38, 0xffff0000
    v_mul_u32_u24 v8, 400, v5
    v_lshl_add_u32 v8, v4, 4, v8
    v_bfe_u32 v9, v1, 2, 2
    v_lshl_add_u32 v9, v19, 3, v9
    v_mul_u32_u24 v9, 400, v9
    v_and_b32 v10, 1, v1
    v_lshl_add_u32 v9, v10, 5, v9
    v_bfe_u32 v10, v1, 1, 1
    v_lshl_add_u32 v9, v10, 3, v9
    v_lshlrev_b32 v11, 5, v20
    v_add_u32 v11, s32, v11
    v_mul_u32_u24 v11, 1152, v11
    s_mul_i32 s39, s33, 384
    s_and_b32 s44, s32, 6
    v_add_u32 v13, 4, v19
    v_xor_b32 v12, s44, v19
    v_xor_b32 v13, s44, v13
    v_lshl_add_u32 v12, v12, 4, v11
    v_lshl_add_u32 v13, v13, 4, v11
    v_mov_b32 v24, 0
    v_mov_b32 v25, 0
    v_mov_b32 v26, 0
    v_mov_b32 v27, 0
    s_waitcnt vmcnt(17)
    v_dot2_f32_bf16 v24, v32, s37, v24
    v_dot2_f32_bf16 v25, v32, v32, v25
    v_dot2_f32_bf16 v24, v33, s37, v24
    v_dot2_f32_bf16 v25, v33, v33, v25
    v_dot2_f32_bf16 v24, v34, s37, v24
    v_dot2_f32_bf16 v25, v34, v34, v25
    v_dot2_f32_bf16 v24, v35, s37, v24
    v_dot2_f32_bf16 v25, v35, v35, v25
    v_dot2_f32_bf16 v24, v36, s37, v24
    v_dot2_f32_bf16 v25, v36, v36, v25
    v_dot2_f32_bf16 v24, v37, s37, v24
    v_dot2_f32_bf16 v25, v37, v37, v25
    v_dot2_f32_bf16 v24, v38, s37, v24
    v_dot2_f32_bf16 v25, v38, v38, v25
    v_dot2_f32_bf16 v24, v39, s37, v24
    v_dot2_f32_bf16 v25, v39, v39, v25
    v_dot2_f32_bf16 v24, v40, s37, v24
    v_dot2_f32_bf16 v25, v40, v40, v25
    v_dot2_f32_bf16 v24, v41, s37, v24
    v_dot2_f32_bf16 v25, v41, v41, v25
    v_dot2_f32_bf16 v24, v42, s37, v24
    v_dot2_f32_bf16 v25, v42, v42, v25
    v_dot2_f32_bf16 v24, v43, s37, v24
    v_dot2_f32_bf16 v25, v43, v43, v25
    s_waitcnt vmcnt(14)
    v_dot2_f32_bf16 v24, v44, s37, v24
    v_dot2_f32_bf16 v25, v44, v44, v25
    v_dot2_f32_bf16 v24, v45, s37, v24
    v_dot2_f32_bf16 v25, v45, v45, v25
    v_dot2_f32_bf16 v24, v46, s37, v24
    v_dot2_f32_bf16 v25, v46, v46, v25
    v_dot2_f32_bf16 v24, v47, s37, v24
    v_dot2_f32_bf16 v25, v47, v47, v25
    v_dot2_f32_bf16 v24, v48, s37, v24
    v_dot2_f32_bf16 v25, v48, v48, v25
    v_dot2_f32_bf16 v24, v49, s37, v24
    v_dot2_f32_bf16 v25, v49, v49, v25
    v_dot2_f32_bf16 v24, v50, s37, v24
    v_dot2_f32_bf16 v25, v50, v50, v25
    v_dot2_f32_bf16 v24, v51, s37, v24
    v_dot2_f32_bf16 v25, v51, v51, v25
    v_dot2_f32_bf16 v24, v52, s37, v24
    v_dot2_f32_bf16 v25, v52, v52, v25
    v_dot2_f32_bf16 v24, v53, s37, v24
    v_dot2_f32_bf16 v25, v53, v53, v25
    v_dot2_f32_bf16 v24, v54, s37, v24
    v_dot2_f32_bf16 v25, v54, v54, v25
    v_dot2_f32_bf16 v24, v55, s37, v24
    v_dot2_f32_bf16 v25, v55, v55, v25
    s_waitcnt vmcnt(11)
    v_dot2_f32_bf16 v24, v56, s37, v24
    v_dot2_f32_bf16 v25, v56, v56, v25
    v_dot2_f32_bf16 v24, v57, s37, v24
    v_dot2_f32_bf16 v25, v57, v57, v25
    v_dot2_f32_bf16 v24, v58, s37, v24
    v_dot2_f32_bf16 v25, v58, v58, v25
    v_dot2_f32_bf16 v24, v59, s37, v24
    v_dot2_f32_bf16 v25, v59, v59, v25
    v_dot2_f32_bf16 v24, v60, s37, v24
    v_dot2_f32_bf16 v25, v60, v60, v25
    v_dot2_f32_bf16 v24, v61, s37, v24
    v_dot2_f32_bf16 v25, v61, v61, v25
    v_dot2_f32_bf16 v24, v62, s37, v24
    v_dot2_f32_bf16 v25, v62, v62, v25
    v_dot2_f32_bf16 v24, v63, s37, v24
    v_dot2_f32_bf16 v25, v63, v63, v25
    v_dot2_f32_bf16 v24, v64, s37, v24
    v_dot2_f32_bf16 v25, v64, v64, v25
    v_dot2_f32_bf16 v24, v65, s37, v24
    v_dot2_f32_bf16 v25, v65, v65, v25
    v_dot2_f32_bf16 v24, v66, s37, v24
    v_dot2_f32_bf16 v25, v66, v66, v25
    v_dot2_f32_bf16 v24, v67, s37, v24
    v_dot2_f32_bf16 v25, v67, v67, v25
    s_waitcnt vmcnt(8)
    v_dot2_f32_bf16 v26, v68, s37, v26
    v_dot2_f32_bf16 v27, v68, v68, v27
    v_dot2_f32_bf16 v26, v69, s37, v26
    v_dot2_f32_bf16 v27, v69, v69, v27
    v_dot2_f32_bf16 v26, v70, s37, v26
    v_dot2_f32_bf16 v27, v70, v70, v27
    v_dot2_f32_bf16 v26, v71, s37, v26
    v_dot2_f32_bf16 v27, v71, v71, v27
    v_dot2_f32_bf16 v26, v72, s37, v26
    v_dot2_f32_bf16 v27, v72, v72, v27
    v_dot2_f32_bf16 v26, v73, s37, v26
    v_dot2_f32_bf16 v27, v73, v73, v27
    v_dot2_f32_bf16 v26, v74, s37, v26
    v_dot2_f32_bf16 v27, v74, v74, v27
    v_dot2_f32_bf16 v26, v75, s37, v26
    v_dot2_f32_bf16 v27, v75, v75, v27
    v_dot2_f32_bf16 v26, v76, s37, v26
    v_dot2_f32_bf16 v27, v76, v76, v27
    v_dot2_f32_bf16 v26, v77, s37, v26
    v_dot2_f32_bf16 v27, v77, v77, v27
    v_dot2_f32_bf16 v26, v78, s37, v26
    v_dot2_f32_bf16 v27, v78, v78, v27
    v_dot2_f32_bf16 v26, v79, s37, v26
    v_dot2_f32_bf16 v27, v79, v79, v27
    s_waitcnt vmcnt(5)
    v_dot2_f32_bf16 v26, v80, s37, v26
    v_dot2_f32_bf16 v27, v80, v80, v27
    v_dot2_f32_bf16 v26, v81, s37, v26
    v_dot2_f32_bf16 v27, v81, v81, v27
    v_dot2_f32_bf16 v26, v82, s37, v26
    v_dot2_f32_bf16 v27, v82, v82, v27
    v_dot2_f32_bf16 v26, v83, s37, v26
    v_dot2_f32_bf16 v27, v83, v83, v27
    v_dot2_f32_bf16 v26, v84, s37, v26
    v_dot2_f32_bf16 v27, v84, v84, v27
    v_dot2_f32_bf16 v26, v85, s37, v26
    v_dot2_f32_bf16 v27, v85, v85, v27
    v_dot2_f32_bf16 v26, v86, s37, v26
    v_dot2_f32_bf16 v27, v86, v86, v27
    v_dot2_f32_bf16 v26, v87, s37, v26
    v_dot2_f32_bf16 v27, v87, v87, v27
    v_dot2_f32_bf16 v26, v88, s37, v26
    v_dot2_f32_bf16 v27, v88, v88, v27
    v_dot2_f32_bf16 v26, v89, s37, v26
    v_dot2_f32_bf16 v27, v89, v89, v27
    v_dot2_f32_bf16 v26, v90, s37, v26
    v_dot2_f32_bf16 v27, v90, v90, v27
    v_dot2_f32_bf16 v26, v91, s37, v26
    v_dot2_f32_bf16 v27, v91, v91, v27
    s_waitcnt vmcnt(2)
    v_dot2_f32_bf16 v26, v92, s37, v26
    v_dot2_f32_bf16 v27, v92, v92, v27
    v_dot2_f32_bf16 v26, v93, s37, v26
    v_dot2_f32_bf16 v27, v93, v93, v27
    v_dot2_f32_bf16 v26, v94, s37, v26
    v_dot2_f32_bf16 v27, v94, v94, v27
    v_dot2_f32_bf16 v26, v95, s37, v26
    v_dot2_f32_bf16 v27, v95, v95, v27
    v_dot2_f32_bf16 v26, v96, s37, v26
    v_dot2_f32_bf16 v27, v96, v96, v27
    v_dot2_f32_bf16 v26, v97, s37, v26
    v_dot2_f32_bf16 v27, v97, v97, v27
    v_dot2_f32_bf16 v26, v98, s37, v26
    v_dot2_f32_bf16 v27, v98, v98, v27
    v_dot2_f32_bf16 v26, v99, s37, v26
    v_dot2_f32_bf16 v27, v99, v99, v27
    v_dot2_f32_bf16 v26, v100, s37, v26
    v_dot2_f32_bf16 v27, v100, v100, v27
    v_dot2_f32_bf16 v26, v101, s37, v26
    v_dot2_f32_bf16 v27, v101, v101, v27
    v_dot2_f32_bf16 v26, v102, s37, v26
    v_dot2_f32_bf16 v27, v102, v102, v27
    v_dot2_f32_bf16 v26, v103, s37, v26
    v_dot2_f32_bf16 v27, v103, v103, v27
    v_add_f32_dpp v24, v24, v24 quad_perm:[1,0,3,2] row_mask:0xf bank_mask:0xf
    v_add_f32_dpp v25, v25, v25 quad_perm:[1,0,3,2] row_mask:0xf bank_mask:0xf
    v_add_f32_dpp v26, v26, v26 quad_perm:[1,0,3,2] row_mask:0xf bank_mask:0xf
    v_add_f32_dpp v27, v27, v27 quad_perm:[1,0,3,2] row_mask:0xf bank_mask:0xf
    v_add_f32_dpp v24, v24, v24 quad_perm:[2,3,0,1] row_mask:0xf bank_mask:0xf
    v_add_f32_dpp v25, v25, v25 quad_perm:[2,3,0,1] row_mask:0xf bank_mask:0xf
    v_add_f32_dpp v26, v26, v26 quad_perm:[2,3,0,1] row_mask:0xf bank_mask:0xf
    v_add_f32_dpp v27, v27, v27 quad_perm:[2,3,0,1] row_mask:0xf bank_mask:0xf
    v_add_f32_dpp v24, v24, v24 row_half_mirror row_mask:0xf bank_mask:0xf
    v_add_f32_dpp v25, v25, v25 row_half_mirror row_mask:0xf bank_mask:0xf
    v_add_f32_dpp v26, v26, v26 row_half_mirror row_mask:0xf bank_mask:0xf
    v_add_f32_dpp v27, v27, v27 row_half_mirror row_mask:0xf bank_mask:0xf
    v_mul_f32 v24, 0x3ae38e39, v24
    v_mul_f32 v25, 0x3ae38e39, v25
    v_fma_f32 v25, -v24, v24, v25
    v_max_f32 v25, 0, v25
    v_add_f32 v25, 0x3727c5ac, v25
    v_rsq_f32 v28, v25
    s_nop 0
    v_mul_f32 v16, -v24, v28
    v_mul_f32 v26, 0x3ae38e39, v26
    v_mul_f32 v27, 0x3ae38e39, v27
    v_fma_f32 v27, -v26, v26, v27
    v_max_f32 v27, 0, v27
    v_add_f32 v27, 0x3727c5ac, v27
    v_rsq_f32 v30, v27
    s_nop 0
    v_mul_f32 v18, -v26, v30
    v_lshlrev_b32 v112, 16, v32
    v_and_b32 v113, s38, v32
    v_pk_fma_f32 v[112:113], v[112:113], v[28:29], v[16:17] op_sel_hi:[1,0,0]
    v_cvt_pk_bf16_f32 v32, v112, v113
    v_lshlrev_b32 v114, 16, v33
    v_and_b32 v115, s38, v33
    v_pk_fma_f32 v[114:115], v[114:115], v[28:29], v[16:17] op_sel_hi:[1,0,0]
    v_cvt_pk_bf16_f32 v33, v114, v115
    v_lshlrev_b32 v116, 16, v34
    v_and_b32 v117, s38, v34
    v_pk_fma_f32 v[116:117], v[116:117], v[28:29], v[16:17] op_sel_hi:[1,0,0]
    v_cvt_pk_bf16_f32 v34, v116, v117
    v_lshlrev_b32 v118, 16, v35
    v_and_b32 v119, s38, v35
    v_pk_fma_f32 v[118:119], v[118:119], v[28:29], v[16:17] op_sel_hi:[1,0,0]
    v_cvt_pk_bf16_f32 v35, v118, v119
    ds_write_b128 v8, v[32:35] offset:0
    v_lshlrev_b32 v112, 16, v36
    v_and_b32 v113, s38, v36
    v_pk_fma_f32 v[112:113], v[112:113], v[28:29], v[16:17] op_sel_hi:[1,0,0]
    v_cvt_pk_bf16_f32 v36, v112, v113
    v_lshlrev_b32 v114, 16, v37
    v_and_b32 v115, s38, v37
    v_pk_fma_f32 v[114:115], v[114:115], v[28:29], v[16:17] op_sel_hi:[1,0,0]
    v_cvt_pk_bf16_f32 v37, v114, v115
    v_lshlrev_b32 v116, 16, v38
    v_and_b32 v117, s38, v38
    v_pk_fma_f32 v[116:117], v[116:117], v[28:29], v[16:17] op_sel_hi:[1,0,0]
    v_cvt_pk_bf16_f32 v38, v116, v117
    v_lshlrev_b32 v118, 16, v39
    v_and_b32 v119, s38, v39
    v_pk_fma_f32 v[118:119], v[118:119], v[28:29], v[16:17] op_sel_hi:[1,0,0]
    v_cvt_pk_bf16_f32 v39, v118, v119
    ds_write_b128 v8, v[36:39] offset:128
    v_lshlrev_b32 v112, 16, v40
    v_and_b32 v113, s38, v40
    v_pk_fma_f32 v[112:113], v[112:113], v[28:29], v[16:17] op_sel_hi:[1,0,0]
    v_cvt_pk_bf16_f32 v40, v112, v113
    v_lshlrev_b32 v114, 16, v41
    v_and_b32 v115, s38, v41
    v_pk_fma_f32 v[114:115], v[114:115], v[28:29], v[16:17] op_sel_hi:[1,0,0]
    v_cvt_pk_bf16_f32 v41, v114, v115
    v_lshlrev_b32 v116, 16, v42
    v_and_b32 v117, s38, v42
    v_pk_fma_f32 v[116:117], v[116:117], v[28:29], v[16:17] op_sel_hi:[1,0,0]
    v_cvt_pk_bf16_f32 v42, v116, v117
    v_lshlrev_b32 v118, 16, v43
    v_and_b32 v119, s38, v43
    v_pk_fma_f32 v[118:119], v[118:119], v[28:29], v[16:17] op_sel_hi:[1,0,0]
    v_cvt_pk_bf16_f32 v43, v118, v119
    ds_write_b128 v8, v[40:43] offset:256
    v_lshlrev_b32 v112, 16, v68
    v_and_b32 v113, s38, v68
    v_pk_fma_f32 v[112:113], v[112:113], v[30:31], v[18:19] op_sel_hi:[1,0,0]
    v_cvt_pk_bf16_f32 v68, v112, v113
    v_lshlrev_b32 v114, 16, v69
    v_and_b32 v115, s38, v69
    v_pk_fma_f32 v[114:115], v[114:115], v[30:31], v[18:19] op_sel_hi:[1,0,0]
    v_cvt_pk_bf16_f32 v69, v114, v115
    v_lshlrev_b32 v116, 16, v70
    v_and_b32 v117, s38, v70
    v_pk_fma_f32 v[116:117], v[116:117], v[30:31], v[18:19] op_sel_hi:[1,0,0]
    v_cvt_pk_bf16_f32 v70, v116, v117
    v_lshlrev_b32 v118, 16, v71
    v_and_b32 v119, s38, v71
    v_pk_fma_f32 v[118:119], v[118:119], v[30:31], v[18:19] op_sel_hi:[1,0,0]
    v_cvt_pk_bf16_f32 v71, v118, v119
    ds_write_b128 v8, v[68:71] offset:3200
    v_lshlrev_b32 v112, 16, v72
    v_and_b32 v113, s38, v72
    v_pk_fma_f32 v[112:113], v[112:113], v[30:31], v[18:19] op_sel_hi:[1,0,0]
    v_cvt_pk_bf16_f32 v72, v112, v113
    v_lshlrev_b32 v114, 16, v73
    v_and_b32 v115, s38, v73
    v_pk_fma_f32 v[114:115], v[114:115], v[30:31], v[18:19] op_sel_hi:[1,0,0]
    v_cvt_pk_bf16_f32 v73, v114, v115
    v_lshlrev_b32 v116, 16, v74
    v_and_b32 v117, s38, v74
    v_pk_fma_f32 v[116:117], v[116:117], v[30:31], v[18:19] op_sel_hi:[1,0,0]
    v_cvt_pk_bf16_f32 v74, v116, v117
    v_lshlrev_b32 v118, 16, v75
    v_and_b32 v119, s38, v75
    v_pk_fma_f32 v[118:119], v[118:119], v[30:31], v[18:19] op_sel_hi:[1,0,0]
    v_cvt_pk_bf16_f32 v75, v118, v119
    ds_write_b128 v8, v[72:75] offset:3328
    v_lshlrev_b32 v112, 16, v76
    v_and_b32 v113, s38, v76
    v_pk_fma_f32 v[112:113], v[112:113], v[30:31], v[18:19] op_sel_hi:[1,0,0]
    v_cvt_pk_bf16_f32 v76, v112, v113
    v_lshlrev_b32 v114, 16, v77
    v_and_b32 v115, s38, v77
    v_pk_fma_f32 v[114:115], v[114:115], v[30:31], v[18:19] op_sel_hi:[1,0,0]
    v_cvt_pk_bf16_f32 v77, v114, v115
    v_lshlrev_b32 v116, 16, v78
    v_and_b32 v117, s38, v78
    v_pk_fma_f32 v[116:117], v[116:117], v[30:31], v[18:19] op_sel_hi:[1,0,0]
    v_cvt_pk_bf16_f32 v78, v116, v117
    v_lshlrev_b32 v118, 16, v79
    v_and_b32 v119, s38, v79
    v_pk_fma_f32 v[118:119], v[118:119], v[30:31], v[18:19] op_sel_hi:[1,0,0]
    v_cvt_pk_bf16_f32 v79, v118, v119
    ds_write_b128 v8, v[76:79] offset:3456
    s_waitcnt lgkmcnt(0)
    s_barrier
    s_waitcnt vmcnt(0)
    ds_read_b64_tr_b16 v[32:33], v9 offset:0
    ds_read_b64_tr_b16 v[34:35], v9 offset:1600
    ds_read_b64_tr_b16 v[36:37], v9 offset:16
    ds_read_b64_tr_b16 v[38:39], v9 offset:1616
    ds_read_b64_tr_b16 v[40:41], v9 offset:64
    ds_read_b64_tr_b16 v[42:43], v9 offset:1664
    ds_read_b64_tr_b16 v[44:45], v9 offset:80
    ds_read_b64_tr_b16 v[46:47], v9 offset:1680
    ds_read_b64_tr_b16 v[48:49], v9 offset:128
    ds_read_b64_tr_b16 v[50:51], v9 offset:1728
    ds_read_b64_tr_b16 v[52:53], v9 offset:144
    ds_read_b64_tr_b16 v[54:55], v9 offset:1744
    ds_read_b64_tr_b16 v[56:57], v9 offset:12800
    ds_read_b64_tr_b16 v[58:59], v9 offset:14400
    ds_read_b64_tr_b16 v[60:61], v9 offset:12816
    ds_read_b64_tr_b16 v[62:63], v9 offset:14416
    ds_read_b64_tr_b16 v[64:65], v9 offset:12864
    ds_read_b64_tr_b16 v[66:67], v9 offset:14464
    ds_read_b64_tr_b16 v[68:69], v9 offset:12880
    ds_read_b64_tr_b16 v[70:71], v9 offset:14480
    ds_read_b64_tr_b16 v[72:73], v9 offset:12928
    ds_read_b64_tr_b16 v[74:75], v9 offset:14528
    ds_read_b64_tr_b16 v[76:77], v9 offset:12944
    ds_read_b64_tr_b16 v[78:79], v9 offset:14544
    s_waitcnt lgkmcnt(15)
    v_mfma_f32_16x16x32_bf16 v[80:83], v[32:35], v[104:107], 0
    v_mfma_f32_16x16x32_bf16 v[84:87], v[36:39], v[104:107], 0
    s_waitcnt lgkmcnt(15)
    v_mfma_f32_16x16x32_bf16 v[88:91], v[40:43], v[104:107], 0
    v_mfma_f32_16x16x32_bf16 v[92:95], v[44:47], v[104:107], 0
    s_waitcnt lgkmcnt(12)
    v_mfma_f32_16x16x32_bf16 v[96:99], v[48:51], v[104:107], 0
    v_mfma_f32_16x16x32_bf16 v[100:103], v[52:55], v[104:107], 0
    s_waitcnt lgkmcnt(8)
    v_mfma_f32_16x16x32_bf16 v[80:83], v[56:59], v[108:111], v[80:83]
    v_mfma_f32_16x16x32_bf16 v[84:87], v[60:63], v[108:111], v[84:87]
    s_waitcnt lgkmcnt(4)
    v_mfma_f32_16x16x32_bf16 v[88:91], v[64:67], v[108:111], v[88:91]
    v_mfma_f32_16x16x32_bf16 v[92:95], v[68:71], v[108:111], v[92:95]
    s_waitcnt lgkmcnt(0)
    v_mfma_f32_16x16x32_bf16 v[96:99], v[72:75], v[108:111], v[96:99]
    v_mfma_f32_16x16x32_bf16 v[100:103], v[76:79], v[108:111], v[100:103]
    s_nop 0
    v_cvt_pk_bf16_f32 v112, v80, v81
    v_cvt_pk_bf16_f32 v113, v82, v83
    v_cvt_pk_bf16_f32 v114, v84, v85
    v_cvt_pk_bf16_f32 v115, v86, v87
    buffer_store_dwordx4 v[112:115], v12, s[40:43], s39 offen offset:0
    v_cvt_pk_bf16_f32 v116, v88, v89
    v_cvt_pk_bf16_f32 v117, v90, v91
    v_cvt_pk_bf16_f32 v118, v92, v93
    v_cvt_pk_bf16_f32 v119, v94, v95
    buffer_store_dwordx4 v[116:119], v13, s[40:43], s39 offen offset:0
    v_cvt_pk_bf16_f32 v120, v96, v97
    v_cvt_pk_bf16_f32 v121, v98, v99
    v_cvt_pk_bf16_f32 v122, v100, v101
    v_cvt_pk_bf16_f32 v123, v102, v103
    buffer_store_dwordx4 v[120:123], v12, s[40:43], s39 offen offset:128
    ds_read_b64_tr_b16 v[32:33], v9 offset:192
    ds_read_b64_tr_b16 v[34:35], v9 offset:1792
    ds_read_b64_tr_b16 v[36:37], v9 offset:208
    ds_read_b64_tr_b16 v[38:39], v9 offset:1808
    ds_read_b64_tr_b16 v[40:41], v9 offset:256
    ds_read_b64_tr_b16 v[42:43], v9 offset:1856
    ds_read_b64_tr_b16 v[44:45], v9 offset:272
    ds_read_b64_tr_b16 v[46:47], v9 offset:1872
    ds_read_b64_tr_b16 v[48:49], v9 offset:320
    ds_read_b64_tr_b16 v[50:51], v9 offset:1920
    ds_read_b64_tr_b16 v[52:53], v9 offset:336
    ds_read_b64_tr_b16 v[54:55], v9 offset:1936
    ds_read_b64_tr_b16 v[56:57], v9 offset:12992
    ds_read_b64_tr_b16 v[58:59], v9 offset:14592
    ds_read_b64_tr_b16 v[60:61], v9 offset:13008
    ds_read_b64_tr_b16 v[62:63], v9 offset:14608
    ds_read_b64_tr_b16 v[64:65], v9 offset:13056
    ds_read_b64_tr_b16 v[66:67], v9 offset:14656
    ds_read_b64_tr_b16 v[68:69], v9 offset:13072
    ds_read_b64_tr_b16 v[70:71], v9 offset:14672
    ds_read_b64_tr_b16 v[72:73], v9 offset:13120
    ds_read_b64_tr_b16 v[74:75], v9 offset:14720
    ds_read_b64_tr_b16 v[76:77], v9 offset:13136
    ds_read_b64_tr_b16 v[78:79], v9 offset:14736
    s_waitcnt lgkmcnt(15)
    v_mfma_f32_16x16x32_bf16 v[80:83], v[32:35], v[104:107], 0
    v_mfma_f32_16x16x32_bf16 v[84:87], v[36:39], v[104:107], 0
    s_waitcnt lgkmcnt(15)
    v_mfma_f32_16x16x32_bf16 v[88:91], v[40:43], v[104:107], 0
    v_mfma_f32_16x16x32_bf16 v[92:95], v[44:47], v[104:107], 0
    s_waitcnt lgkmcnt(12)
    v_mfma_f32_16x16x32_bf16 v[96:99], v[48:51], v[104:107], 0
    v_mfma_f32_16x16x32_bf16 v[100:103], v[52:55], v[104:107], 0
    s_waitcnt lgkmcnt(8)
    v_mfma_f32_16x16x32_bf16 v[80:83], v[56:59], v[108:111], v[80:83]
    v_mfma_f32_16x16x32_bf16 v[84:87], v[60:63], v[108:111], v[84:87]
    s_waitcnt lgkmcnt(4)
    v_mfma_f32_16x16x32_bf16 v[88:91], v[64:67], v[108:111], v[88:91]
    v_mfma_f32_16x16x32_bf16 v[92:95], v[68:71], v[108:111], v[92:95]
    s_waitcnt lgkmcnt(0)
    v_mfma_f32_16x16x32_bf16 v[96:99], v[72:75], v[108:111], v[96:99]
    v_mfma_f32_16x16x32_bf16 v[100:103], v[76:79], v[108:111], v[100:103]
    s_nop 0
    v_cvt_pk_bf16_f32 v16, v80, v81
    v_cvt_pk_bf16_f32 v17, v82, v83
    v_cvt_pk_bf16_f32 v18, v84, v85
    v_cvt_pk_bf16_f32 v19, v86, v87
    buffer_store_dwordx4 v[16:19], v13, s[40:43], s39 offen offset:128
    v_cvt_pk_bf16_f32 v20, v88, v89
    v_cvt_pk_bf16_f32 v21, v90, v91
    v_cvt_pk_bf16_f32 v22, v92, v93
    v_cvt_pk_bf16_f32 v23, v94, v95
    buffer_store_dwordx4 v[20:23], v12, s[40:43], s39 offen offset:256
    v_cvt_pk_bf16_f32 v24, v96, v97
    v_cvt_pk_bf16_f32 v25, v98, v99
    v_cvt_pk_bf16_f32 v26, v100, v101
    v_cvt_pk_bf16_f32 v27, v102, v103
    buffer_store_dwordx4 v[24:27], v13, s[40:43], s39 offen offset:256
ka_done:
    s_endpgm
ka_wpack:
    v_lshrrev_b32 v21, 5, v1
    v_mul_u32_u24 v21, 9216, v21
    v_bfe_u32 v22, v1, 2, 3
    v_lshl_add_u32 v21, v22, 7, v21
    v_and_b32 v22, 3, v1
    v_lshl_add_u32 v21, v22, 3, v21
    s_mul_i32 s36, s26, 288
    s_add_u32 s37, s36, 0
    s_lshr_b32 s38, s37, 7
    s_lshl_b32 s38, s38, 10
    s_and_b32 s37, s37, 127
    s_add_u32 s37, s37, s38
    v_add_u32 v8, s37, v21
    s_add_u32 s37, s36, 32
    s_lshr_b32 s38, s37, 7
    s_lshl_b32 s38, s38, 10
    s_and_b32 s37, s37, 127
    s_add_u32 s37, s37, s38
    v_add_u32 v9, s37, v21
    s_add_u32 s37, s36, 64
    s_lshr_b32 s38, s37, 7
    s_lshl_b32 s38, s38, 10
    s_and_b32 s37, s37, 127
    s_add_u32 s37, s37, s38
    v_add_u32 v10, s37, v21
    s_add_u32 s37, s36, 96
    s_lshr_b32 s38, s37, 7
    s_lshl_b32 s38, s38, 10
    s_and_b32 s37, s37, 127
    s_add_u32 s37, s37, s38
    v_add_u32 v11, s37, v21
    s_add_u32 s37, s36, 128
    s_lshr_b32 s38, s37, 7
    s_lshl_b32 s38, s38, 10
    s_and_b32 s37, s37, 127
    s_add_u32 s37, s37, s38
    v_add_u32 v12, s37, v21
    s_add_u32 s37, s36, 160
    s_lshr_b32 s38, s37, 7
    s_lshl_b32 s38, s38, 10
    s_and_b32 s37, s37, 127
    s_add_u32 s37, s37, s38
    v_add_u32 v13, s37, v21
    s_add_u32 s37, s36, 192
    s_lshr_b32 s38, s37, 7
    s_lshl_b32 s38, s38, 10
    s_and_b32 s37, s37, 127
    s_add_u32 s37, s37, s38
    v_add_u32 v14, s37, v21
    s_add_u32 s37, s36, 224
    s_lshr_b32 s38, s37, 7
    s_lshl_b32 s38, s38, 10
    s_and_b32 s37, s37, 127
    s_add_u32 s37, s37, s38
    v_add_u32 v15, s37, v21
    s_add_u32 s37, s36, 256
    s_lshr_b32 s38, s37, 7
    s_lshl_b32 s38, s38, 10
    s_and_b32 s37, s37, 127
    s_add_u32 s37, s37, s38
    v_add_u32 v16, s37, v21
    s_lshl_b32 s48, s32, 1
    s_lshr_b32 s49, s26, 1
    s_add_u32 s48, s48, s49
    s_and_b32 s49, s48, 3
    s_mul_i32 s49, s49, 9
    s_lshr_b32 s49, s49, 1
    s_sub_u32 s33, s33, s49
    s_cselect_b32 s49, 18, 0
    s_add_u32 s33, s33, s49
    s_mul_i32 s48, s48, 331776
    s_and_b32 s50, s26, 1
    s_mul_i32 s50, s50, 9
    s_mul_i32 s51, s33, 8
    s_mul_i32 s52, s33, 6
    s_add_u32 s52, s52, 136
    s_mul_i32 s53, s33, 4
    s_add_u32 s53, s53, 238
    s_add_u32 s40, s24, 50741248
    s_addc_u32 s41, s25, 0
    s_and_b32 s41, s41, 0xffff
    s_mov_b32 s42, 10616832
    s_mov_b32 s43, 0x20000
    s_waitcnt vmcnt(0)
    s_barrier
    ds_read_b64_tr_b16 v[32:33], v8
    ds_read_b64_tr_b16 v[34:35], v8 offset:18432
    ds_read_b64_tr_b16 v[36:37], v9
    ds_read_b64_tr_b16 v[38:39], v9 offset:18432
    ds_read_b64_tr_b16 v[40:41], v10
    ds_read_b64_tr_b16 v[42:43], v10 offset:18432
    ds_read_b64_tr_b16 v[44:45], v11
    ds_read_b64_tr_b16 v[46:47], v11 offset:18432
    ds_read_b64_tr_b16 v[48:49], v12
    ds_read_b64_tr_b16 v[50:51], v12 offset:18432
    ds_read_b64_tr_b16 v[52:53], v13
    ds_read_b64_tr_b16 v[54:55], v13 offset:18432
    ds_read_b64_tr_b16 v[56:57], v14
    ds_read_b64_tr_b16 v[58:59], v14 offset:18432
    ds_read_b64_tr_b16 v[60:61], v15
    ds_read_b64_tr_b16 v[62:63], v15 offset:18432
    ds_read_b64_tr_b16 v[64:65], v16
    ds_read_b64_tr_b16 v[66:67], v16 offset:18432
    s_add_u32 s36, s50, 0
    s_cmp_lt_u32 s36, 8
    s_cselect_b32 s37, s51, s52
    s_cmp_lt_u32 s36, 14
    s_cselect_b32 s37, s37, s53
    s_add_u32 s36, s36, s37
    s_lshl_b32 s36, s36, 10
    s_add_u32 s36, s36, s48
    s_waitcnt lgkmcnt(15)
    buffer_store_dwordx4 v[32:35], v20, s[40:43], s36 offen sc1
    s_add_u32 s36, s50, 1
    s_cmp_lt_u32 s36, 8
    s_cselect_b32 s37, s51, s52
    s_cmp_lt_u32 s36, 14
    s_cselect_b32 s37, s37, s53
    s_add_u32 s36, s36, s37
    s_lshl_b32 s36, s36, 10
    s_add_u32 s36, s36, s48
    s_waitcnt lgkmcnt(14)
    buffer_store_dwordx4 v[36:39], v20, s[40:43], s36 offen sc1
    s_add_u32 s36, s50, 2
    s_cmp_lt_u32 s36, 8
    s_cselect_b32 s37, s51, s52
    s_cmp_lt_u32 s36, 14
    s_cselect_b32 s37, s37, s53
    s_add_u32 s36, s36, s37
    s_lshl_b32 s36, s36, 10
    s_add_u32 s36, s36, s48
    s_waitcnt lgkmcnt(12)
    buffer_store_dwordx4 v[40:43], v20, s[40:43], s36 offen sc1
    s_add_u32 s36, s50, 3
    s_cmp_lt_u32 s36, 8
    s_cselect_b32 s37, s51, s52
    s_cmp_lt_u32 s36, 14
    s_cselect_b32 s37, s37, s53
    s_add_u32 s36, s36, s37
    s_lshl_b32 s36, s36, 10
    s_add_u32 s36, s36, s48
    s_waitcnt lgkmcnt(10)
    buffer_store_dwordx4 v[44:47], v20, s[40:43], s36 offen sc1
    s_add_u32 s36, s50, 4
    s_cmp_lt_u32 s36, 8
    s_cselect_b32 s37, s51, s52
    s_cmp_lt_u32 s36, 14
    s_cselect_b32 s37, s37, s53
    s_add_u32 s36, s36, s37
    s_lshl_b32 s36, s36, 10
    s_add_u32 s36, s36, s48
    s_waitcnt lgkmcnt(8)
    buffer_store_dwordx4 v[48:51], v20, s[40:43], s36 offen sc1
    s_add_u32 s36, s50, 5
    s_cmp_lt_u32 s36, 8
    s_cselect_b32 s37, s51, s52
    s_cmp_lt_u32 s36, 14
    s_cselect_b32 s37, s37, s53
    s_add_u32 s36, s36, s37
    s_lshl_b32 s36, s36, 10
    s_add_u32 s36, s36, s48
    s_waitcnt lgkmcnt(6)
    buffer_store_dwordx4 v[52:55], v20, s[40:43], s36 offen sc1
    s_add_u32 s36, s50, 6
    s_cmp_lt_u32 s36, 8
    s_cselect_b32 s37, s51, s52
    s_cmp_lt_u32 s36, 14
    s_cselect_b32 s37, s37, s53
    s_add_u32 s36, s36, s37
    s_lshl_b32 s36, s36, 10
    s_add_u32 s36, s36, s48
    s_waitcnt lgkmcnt(4)
    buffer_store_dwordx4 v[56:59], v20, s[40:43], s36 offen sc1
    s_add_u32 s36, s50, 7
    s_cmp_lt_u32 s36, 8
    s_cselect_b32 s37, s51, s52
    s_cmp_lt_u32 s36, 14
    s_cselect_b32 s37, s37, s53
    s_add_u32 s36, s36, s37
    s_lshl_b32 s36, s36, 10
    s_add_u32 s36, s36, s48
    s_waitcnt lgkmcnt(2)
    buffer_store_dwordx4 v[60:63], v20, s[40:43], s36 offen sc1
    s_add_u32 s36, s50, 8
    s_cmp_lt_u32 s36, 8
    s_cselect_b32 s37, s51, s52
    s_cmp_lt_u32 s36, 14
    s_cselect_b32 s37, s37, s53
    s_add_u32 s36, s36, s37
    s_lshl_b32 s36, s36, 10
    s_add_u32 s36, s36, s48
    s_waitcnt lgkmcnt(0)
    buffer_store_dwordx4 v[64:67], v20, s[40:43], s36 offen sc1
    s_endpgm
ka_mod:
    s_mov_b32 s40, s24
    s_and_b32 s41, s25, 0xffff
    s_mov_b32 s42, 32768
    s_mov_b32 s43, 0x20000
    s_waitcnt vmcnt(18)
    v_lshlrev_b32 v7, 2, v0
    v_lshlrev_b32 v8, 16, v8
    v_mul_f32 v11, 0x3fb8aa3b, v8
    v_exp_f32 v11, -v11
    s_nop 0
    v_add_f32 v11, 1.0, v11
    v_rcp_f32 v11, v11
    s_nop 0
    v_mul_f32 v11, v11, v8
    v_cvt_pk_bf16_f32 v11, v11, v11
    v_lshlrev_b32 v11, 16, v11
    ds_write_b32 v7, v11 offset:0
    v_lshlrev_b32 v9, 16, v9
    v_mul_f32 v11, 0x3fb8aa3b, v9
    v_exp_f32 v11, -v11
    s_nop 0
    v_add_f32 v11, 1.0, v11
    v_rcp_f32 v11, v11
    s_nop 0
    v_mul_f32 v11, v11, v9
    v_cvt_pk_bf16_f32 v11, v11, v11
    v_lshlrev_b32 v11, 16, v11
    ds_write_b32 v7, v11 offset:1024
    v_lshlrev_b32 v10, 16, v10
    v_mul_f32 v11, 0x3fb8aa3b, v10
    v_exp_f32 v11, -v11
    s_nop 0
    v_add_f32 v11, 1.0, v11
    v_rcp_f32 v11, v11
    s_nop 0
    v_mul_f32 v11, v11, v10
    v_cvt_pk_bf16_f32 v11, v11, v11
    v_lshlrev_b32 v11, 16, v11
    ds_write_b32 v7, v11 offset:2048
    v_lshlrev_b32 v5, 2, v5
    s_waitcnt lgkmcnt(0)
    s_barrier
    ds_read_b32 v104, v5 offset:0
    ds_read_b32 v105, v5 offset:32
    ds_read_b32 v106, v5 offset:64
    ds_read_b32 v107, v5 offset:96
    ds_read_b32 v108, v5 offset:128
    ds_read_b32 v109, v5 offset:160
    ds_read_b32 v110, v5 offset:192
    ds_read_b32 v111, v5 offset:224
    ds_read_b32 v112, v5 offset:256
    ds_read_b32 v113, v5 offset:288
    ds_read_b32 v114, v5 offset:320
    ds_read_b32 v115, v5 offset:352
    ds_read_b32 v116, v5 offset:384
    ds_read_b32 v117, v5 offset:416
    ds_read_b32 v118, v5 offset:448
    ds_read_b32 v119, v5 offset:480
    ds_read_b32 v120, v5 offset:512
    ds_read_b32 v121, v5 offset:544
    v_mov_b32 v16, 0
    v_mov_b32 v17, 0
    v_mov_b32 v18, 0
    v_mov_b32 v19, 0
    v_mov_b32 v20, 0
    v_mov_b32 v21, 0
    v_mov_b32 v22, 0
    v_mov_b32 v23, 0
    s_mov_b32 s34, 0xffff0000
    s_waitcnt lgkmcnt(0)
    s_waitcnt vmcnt(16)
    v_lshlrev_b32 v12, 16, v32
    v_and_b32 v13, s34, v32
    v_fmac_f32 v16, v12, v104
    v_fmac_f32 v17, v13, v104
    v_lshlrev_b32 v12, 16, v33
    v_and_b32 v13, s34, v33
    v_fmac_f32 v18, v12, v104
    v_fmac_f32 v19, v13, v104
    v_lshlrev_b32 v12, 16, v34
    v_and_b32 v13, s34, v34
    v_fmac_f32 v20, v12, v104
    v_fmac_f32 v21, v13, v104
    v_lshlrev_b32 v12, 16, v35
    v_and_b32 v13, s34, v35
    v_fmac_f32 v22, v12, v104
    v_fmac_f32 v23, v13, v104
    v_lshlrev_b32 v12, 16, v36
    v_and_b32 v13, s34, v36
    v_fmac_f32 v16, v12, v105
    v_fmac_f32 v17, v13, v105
    v_lshlrev_b32 v12, 16, v37
    v_and_b32 v13, s34, v37
    v_fmac_f32 v18, v12, v105
    v_fmac_f32 v19, v13, v105
    v_lshlrev_b32 v12, 16, v38
    v_and_b32 v13, s34, v38
    v_fmac_f32 v20, v12, v105
    v_fmac_f32 v21, v13, v105
    v_lshlrev_b32 v12, 16, v39
    v_and_b32 v13, s34, v39
    v_fmac_f32 v22, v12, v105
    v_fmac_f32 v23, v13, v105
    s_waitcnt vmcnt(14)
    v_lshlrev_b32 v12, 16, v40
    v_and_b32 v13, s34, v40
    v_fmac_f32 v16, v12, v106
    v_fmac_f32 v17, v13, v106
    v_lshlrev_b32 v12, 16, v41
    v_and_b32 v13, s34, v41
    v_fmac_f32 v18, v12, v106
    v_fmac_f32 v19, v13, v106
    v_lshlrev_b32 v12, 16, v42
    v_and_b32 v13, s34, v42
    v_fmac_f32 v20, v12, v106
    v_fmac_f32 v21, v13, v106
    v_lshlrev_b32 v12, 16, v43
    v_and_b32 v13, s34, v43
    v_fmac_f32 v22, v12, v106
    v_fmac_f32 v23, v13, v106
    v_lshlrev_b32 v12, 16, v44
    v_and_b32 v13, s34, v44
    v_fmac_f32 v16, v12, v107
    v_fmac_f32 v17, v13, v107
    v_lshlrev_b32 v12, 16, v45
    v_and_b32 v13, s34, v45
    v_fmac_f32 v18, v12, v107
    v_fmac_f32 v19, v13, v107
    v_lshlrev_b32 v12, 16, v46
    v_and_b32 v13, s34, v46
    v_fmac_f32 v20, v12, v107
    v_fmac_f32 v21, v13, v107
    v_lshlrev_b32 v12, 16, v47
    v_and_b32 v13, s34, v47
    v_fmac_f32 v22, v12, v107
    v_fmac_f32 v23, v13, v107
    s_waitcnt vmcnt(12)
    v_lshlrev_b32 v12, 16, v48
    v_and_b32 v13, s34, v48
    v_fmac_f32 v16, v12, v108
    v_fmac_f32 v17, v13, v108
    v_lshlrev_b32 v12, 16, v49
    v_and_b32 v13, s34, v49
    v_fmac_f32 v18, v12, v108
    v_fmac_f32 v19, v13, v108
    v_lshlrev_b32 v12, 16, v50
    v_and_b32 v13, s34, v50
    v_fmac_f32 v20, v12, v108
    v_fmac_f32 v21, v13, v108
    v_lshlrev_b32 v12, 16, v51
    v_and_b32 v13, s34, v51
    v_fmac_f32 v22, v12, v108
    v_fmac_f32 v23, v13, v108
    v_lshlrev_b32 v12, 16, v52
    v_and_b32 v13, s34, v52
    v_fmac_f32 v16, v12, v109
    v_fmac_f32 v17, v13, v109
    v_lshlrev_b32 v12, 16, v53
    v_and_b32 v13, s34, v53
    v_fmac_f32 v18, v12, v109
    v_fmac_f32 v19, v13, v109
    v_lshlrev_b32 v12, 16, v54
    v_and_b32 v13, s34, v54
    v_fmac_f32 v20, v12, v109
    v_fmac_f32 v21, v13, v109
    v_lshlrev_b32 v12, 16, v55
    v_and_b32 v13, s34, v55
    v_fmac_f32 v22, v12, v109
    v_fmac_f32 v23, v13, v109
    s_waitcnt vmcnt(10)
    v_lshlrev_b32 v12, 16, v56
    v_and_b32 v13, s34, v56
    v_fmac_f32 v16, v12, v110
    v_fmac_f32 v17, v13, v110
    v_lshlrev_b32 v12, 16, v57
    v_and_b32 v13, s34, v57
    v_fmac_f32 v18, v12, v110
    v_fmac_f32 v19, v13, v110
    v_lshlrev_b32 v12, 16, v58
    v_and_b32 v13, s34, v58
    v_fmac_f32 v20, v12, v110
    v_fmac_f32 v21, v13, v110
    v_lshlrev_b32 v12, 16, v59
    v_and_b32 v13, s34, v59
    v_fmac_f32 v22, v12, v110
    v_fmac_f32 v23, v13, v110
    v_lshlrev_b32 v12, 16, v60
    v_and_b32 v13, s34, v60
    v_fmac_f32 v16, v12, v111
    v_fmac_f32 v17, v13, v111
    v_lshlrev_b32 v12, 16, v61
    v_and_b32 v13, s34, v61
    v_fmac_f32 v18, v12, v111
    v_fmac_f32 v19, v13, v111
    v_lshlrev_b32 v12, 16, v62
    v_and_b32 v13, s34, v62
    v_fmac_f32 v20, v12, v111
    v_fmac_f32 v21, v13, v111
    v_lshlrev_b32 v12, 16, v63
    v_and_b32 v13, s34, v63
    v_fmac_f32 v22, v12, v111
    v_fmac_f32 v23, v13, v111
    s_waitcnt vmcnt(8)
    v_lshlrev_b32 v12, 16, v64
    v_and_b32 v13, s34, v64
    v_fmac_f32 v16, v12, v112
    v_fmac_f32 v17, v13, v112
    v_lshlrev_b32 v12, 16, v65
    v_and_b32 v13, s34, v65
    v_fmac_f32 v18, v12, v112
    v_fmac_f32 v19, v13, v112
    v_lshlrev_b32 v12, 16, v66
    v_and_b32 v13, s34, v66
    v_fmac_f32 v20, v12, v112
    v_fmac_f32 v21, v13, v112
    v_lshlrev_b32 v12, 16, v67
    v_and_b32 v13, s34, v67
    v_fmac_f32 v22, v12, v112
    v_fmac_f32 v23, v13, v112
    v_lshlrev_b32 v12, 16, v68
    v_and_b32 v13, s34, v68
    v_fmac_f32 v16, v12, v113
    v_fmac_f32 v17, v13, v113
    v_lshlrev_b32 v12, 16, v69
    v_and_b32 v13, s34, v69
    v_fmac_f32 v18, v12, v113
    v_fmac_f32 v19, v13, v113
    v_lshlrev_b32 v12, 16, v70
    v_and_b32 v13, s34, v70
    v_fmac_f32 v20, v12, v113
    v_fmac_f32 v21, v13, v113
    v_lshlrev_b32 v12, 16, v71
    v_and_b32 v13, s34, v71
    v_fmac_f32 v22, v12, v113
    v_fmac_f32 v23, v13, v113
    s_waitcnt vmcnt(6)
    v_lshlrev_b32 v12, 16, v72
    v_and_b32 v13, s34, v72
    v_fmac_f32 v16, v12, v114
    v_fmac_f32 v17, v13, v114
    v_lshlrev_b32 v12, 16, v73
    v_and_b32 v13, s34, v73
    v_fmac_f32 v18, v12, v114
    v_fmac_f32 v19, v13, v114
    v_lshlrev_b32 v12, 16, v74
    v_and_b32 v13, s34, v74
    v_fmac_f32 v20, v12, v114
    v_fmac_f32 v21, v13, v114
    v_lshlrev_b32 v12, 16, v75
    v_and_b32 v13, s34, v75
    v_fmac_f32 v22, v12, v114
    v_fmac_f32 v23, v13, v114
    v_lshlrev_b32 v12, 16, v76
    v_and_b32 v13, s34, v76
    v_fmac_f32 v16, v12, v115
    v_fmac_f32 v17, v13, v115
    v_lshlrev_b32 v12, 16, v77
    v_and_b32 v13, s34, v77
    v_fmac_f32 v18, v12, v115
    v_fmac_f32 v19, v13, v115
    v_lshlrev_b32 v12, 16, v78
    v_and_b32 v13, s34, v78
    v_fmac_f32 v20, v12, v115
    v_fmac_f32 v21, v13, v115
    v_lshlrev_b32 v12, 16, v79
    v_and_b32 v13, s34, v79
    v_fmac_f32 v22, v12, v115
    v_fmac_f32 v23, v13, v115
    s_waitcnt vmcnt(4)
    v_lshlrev_b32 v12, 16, v80
    v_and_b32 v13, s34, v80
    v_fmac_f32 v16, v12, v116
    v_fmac_f32 v17, v13, v116
    v_lshlrev_b32 v12, 16, v81
    v_and_b32 v13, s34, v81
    v_fmac_f32 v18, v12, v116
    v_fmac_f32 v19, v13, v116
    v_lshlrev_b32 v12, 16, v82
    v_and_b32 v13, s34, v82
    v_fmac_f32 v20, v12, v116
    v_fmac_f32 v21, v13, v116
    v_lshlrev_b32 v12, 16, v83
    v_and_b32 v13, s34, v83
    v_fmac_f32 v22, v12, v116
    v_fmac_f32 v23, v13, v116
    v_lshlrev_b32 v12, 16, v84
    v_and_b32 v13, s34, v84
    v_fmac_f32 v16, v12, v117
    v_fmac_f32 v17, v13, v117
    v_lshlrev_b32 v12, 16, v85
    v_and_b32 v13, s34, v85
    v_fmac_f32 v18, v12, v117
    v_fmac_f32 v19, v13, v117
    v_lshlrev_b32 v12, 16, v86
    v_and_b32 v13, s34, v86
    v_fmac_f32 v20, v12, v117
    v_fmac_f32 v21, v13, v117
    v_lshlrev_b32 v12, 16, v87
    v_and_b32 v13, s34, v87
    v_fmac_f32 v22, v12, v117
    v_fmac_f32 v23, v13, v117
    s_waitcnt vmcnt(2)
    v_lshlrev_b32 v12, 16, v88
    v_and_b32 v13, s34, v88
    v_fmac_f32 v16, v12, v118
    v_fmac_f32 v17, v13, v118
    v_lshlrev_b32 v12, 16, v89
    v_and_b32 v13, s34, v89
    v_fmac_f32 v18, v12, v118
    v_fmac_f32 v19, v13, v118
    v_lshlrev_b32 v12, 16, v90
    v_and_b32 v13, s34, v90
    v_fmac_f32 v20, v12, v118
    v_fmac_f32 v21, v13, v118
    v_lshlrev_b32 v12, 16, v91
    v_and_b32 v13, s34, v91
    v_fmac_f32 v22, v12, v118
    v_fmac_f32 v23, v13, v118
    v_lshlrev_b32 v12, 16, v92
    v_and_b32 v13, s34, v92
    v_fmac_f32 v16, v12, v119
    v_fmac_f32 v17, v13, v119
    v_lshlrev_b32 v12, 16, v93
    v_and_b32 v13, s34, v93
    v_fmac_f32 v18, v12, v119
    v_fmac_f32 v19, v13, v119
    v_lshlrev_b32 v12, 16, v94
    v_and_b32 v13, s34, v94
    v_fmac_f32 v20, v12, v119
    v_fmac_f32 v21, v13, v119
    v_lshlrev_b32 v12, 16, v95
    v_and_b32 v13, s34, v95
    v_fmac_f32 v22, v12, v119
    v_fmac_f32 v23, v13, v119
    s_waitcnt vmcnt(0)
    v_lshlrev_b32 v12, 16, v96
    v_and_b32 v13, s34, v96
    v_fmac_f32 v16, v12, v120
    v_fmac_f32 v17, v13, v120
    v_lshlrev_b32 v12, 16, v97
    v_and_b32 v13, s34, v97
    v_fmac_f32 v18, v12, v120
    v_fmac_f32 v19, v13, v120
    v_lshlrev_b32 v12, 16, v98
    v_and_b32 v13, s34, v98
    v_fmac_f32 v20, v12, v120
    v_fmac_f32 v21, v13, v120
    v_lshlrev_b32 v12, 16, v99
    v_and_b32 v13, s34, v99
    v_fmac_f32 v22, v12, v120
    v_fmac_f32 v23, v13, v120
    v_lshlrev_b32 v12, 16, v100
    v_and_b32 v13, s34, v100
    v_fmac_f32 v16, v12, v121
    v_fmac_f32 v17, v13, v121
    v_lshlrev_b32 v12, 16, v101
    v_and_b32 v13, s34, v101
    v_fmac_f32 v18, v12, v121
    v_fmac_f32 v19, v13, v121
    v_lshlrev_b32 v12, 16, v102
    v_and_b32 v13, s34, v102
    v_fmac_f32 v20, v12, v121
    v_fmac_f32 v21, v13, v121
    v_lshlrev_b32 v12, 16, v103
    v_and_b32 v13, s34, v103
    v_fmac_f32 v22, v12, v121
    v_fmac_f32 v23, v13, v121
    v_add_f32_dpp v16, v16, v16 row_ror:8 row_mask:0xf bank_mask:0xf
    v_add_f32_dpp v17, v17, v17 row_ror:8 row_mask:0xf bank_mask:0xf
    v_add_f32_dpp v18, v18, v18 row_ror:8 row_mask:0xf bank_mask:0xf
    v_add_f32_dpp v19, v19, v19 row_ror:8 row_mask:0xf bank_mask:0xf
    v_add_f32_dpp v20, v20, v20 row_ror:8 row_mask:0xf bank_mask:0xf
    v_add_f32_dpp v21, v21, v21 row_ror:8 row_mask:0xf bank_mask:0xf
    v_add_f32_dpp v22, v22, v22 row_ror:8 row_mask:0xf bank_mask:0xf
    v_add_f32_dpp v23, v23, v23 row_ror:8 row_mask:0xf bank_mask:0xf
    v_mov_b32 v24, v16
    v_mov_b32 v25, v17
    v_mov_b32 v26, v18
    v_mov_b32 v27, v19
    v_mov_b32 v28, v20
    v_mov_b32 v29, v21
    v_mov_b32 v30, v22
    v_mov_b32 v31, v23
    v_permlane16_swap_b32 v16, v24
    v_permlane16_swap_b32 v17, v25
    v_permlane16_swap_b32 v18, v26
    v_permlane16_swap_b32 v19, v27
    v_permlane16_swap_b32 v20, v28
    v_permlane16_swap_b32 v21, v29
    v_permlane16_swap_b32 v22, v30
    v_permlane16_swap_b32 v23, v31
    v_add_f32 v16, v16, v24
    v_add_f32 v17, v17, v25
    v_add_f32 v18, v18, v26
    v_add_f32 v19, v19, v27
    v_add_f32 v20, v20, v28
    v_add_f32 v21, v21, v29
    v_add_f32 v22, v22, v30
    v_add_f32 v23, v23, v31
    v_mov_b32 v24, v16
    v_mov_b32 v25, v17
    v_mov_b32 v26, v18
    v_mov_b32 v27, v19
    v_mov_b32 v28, v20
    v_mov_b32 v29, v21
    v_mov_b32 v30, v22
    v_mov_b32 v31, v23
    v_permlane32_swap_b32 v16, v24
    v_permlane32_swap_b32 v17, v25
    v_permlane32_swap_b32 v18, v26
    v_permlane32_swap_b32 v19, v27
    v_permlane32_swap_b32 v20, v28
    v_permlane32_swap_b32 v21, v29
    v_permlane32_swap_b32 v22, v30
    v_permlane32_swap_b32 v23, v31
    v_add_f32 v16, v16, v24
    v_add_f32 v17, v17, v25
    v_add_f32 v18, v18, v26
    v_add_f32 v19, v19, v27
    v_add_f32 v20, v20, v28
    v_add_f32 v21, v21, v29
    v_add_f32 v22, v22, v30
    v_add_f32 v23, v23, v31
    v_lshlrev_b32 v12, 8, v2
    v_lshl_add_u32 v12, v4, 5, v12
    ds_write_b128 v12, v[16:19] offset:3072
    ds_write_b128 v12, v[20:23] offset:3088
    s_waitcnt lgkmcnt(0)
    s_barrier
    s_cmp_lg_u32 s26, 0
    s_cbranch_scc1 ka_done2
    ds_read_b32 v32, v7 offset:3072
    ds_read_b32 v33, v7 offset:3328
    ds_read_b32 v34, v7 offset:3584
    ds_read_b32 v35, v7 offset:3840
    s_mul_i32 s35, s32, 57
    s_lshr_b32 s35, s35, 9
    s_waitcnt lgkmcnt(0)
    v_add_f32 v32, v32, v33
    v_add_f32 v34, v34, v35
    v_add_f32 v32, v32, v34
    v_cvt_pk_bf16_f32 v32, v32, v32
    v_lshlrev_b32 v32, 16, v32
    s_cmp_eq_u32 s35, 1
    s_cbranch_scc1 ka_mod_plus1
    s_cmp_eq_u32 s35, 4
    s_cbranch_scc0 ka_mod_store
ka_mod_plus1:
    v_add_f32 v32, 1.0, v32
    v_cvt_pk_bf16_f32 v32, v32, v32
    v_lshlrev_b32 v32, 16, v32
ka_mod_store:
    s_lshl_b32 s33, s32, 8
    buffer_store_dword v32, v7, s[40:43], s33 offen
    s_sub_u32 s36, s35, 3
    s_cmp_gt_u32 s36, 1
    s_cbranch_scc1 ka_done2
    s_mul_i32 s37, s35, 9
    s_sub_u32 s37, s32, s37
    s_lshl_b32 s37, s37, 7
    s_xor_b32 s36, s36, 1
    s_mul_i32 s36, s36, 1152
    s_add_u32 s37, s37, s36
    s_add_u32 s40, s24, 61497344
    s_addc_u32 s41, s25, 0
    s_and_b32 s41, s41, 0xffff
    v_lshlrev_b32 v7, 1, v0
    buffer_store_short_d16_hi v32, v7, s[40:43], s37 offen
ka_done2:
    s_endpgm
ka_pack:
    s_cmp_ge_u32 s2, 350
    s_cbranch_scc1 ka_done3
    s_sub_u32 s32, s2, 296
    s_lshl_b32 s33, s32, 2
    s_add_u32 s33, s33, s26
    s_mul_i32 s34, s33, 171
    s_lshr_b32 s34, s34, 9
    s_mul_i32 s35, s34, 3
    s_sub_u32 s35, s33, s35
    s_cmp_ge_u32 s34, 36
    s_cselect_b32 s36, 36, 0
    s_sub_u32 s36, s34, s36
    v_and_b32 v3, 15, v1
    v_lshrrev_b32 v4, 4, v1
    v_lshlrev_b32 v6, 18, v3
    v_lshl_add_u32 v6, v4, 3, v6
    v_mul_u32_u24 v3, 1152, v3
    v_lshl_add_u32 v3, v4, 4, v3
    s_mul_i32 s36, s36, 18432
    s_mul_i32 s37, s35, 384
    s_add_u32 s36, s36, s37
    s_mov_b32 s30, 663552
    s_waitcnt lgkmcnt(0)
    s_cmp_ge_u32 s34, 36
    s_cselect_b32 s28, s12, s10
    s_cselect_b32 s29, s13, s11
    s_and_b32 s29, s29, 0xffff
    buffer_load_dwordx4 v[8:11], v3, s[28:31], s36 offen offset:0
    buffer_load_dwordx4 v[12:15], v3, s[28:31], s36 offen offset:64
    buffer_load_dwordx4 v[16:19], v3, s[28:31], s36 offen offset:128
    buffer_load_dwordx4 v[20:23], v3, s[28:31], s36 offen offset:192
    buffer_load_dwordx4 v[24:27], v3, s[28:31], s36 offen offset:256
    buffer_load_dwordx4 v[28:31], v3, s[28:31], s36 offen offset:320
    s_bitcmp1_b32 s33, 1
    s_cselect_b32 s40, s8, s6
    s_cselect_b32 s41, s9, s7
    s_and_b32 s41, s41, 0xffff
    s_cmp_lt_u32 s33, 132
    s_cselect_b32 s42, 8388608, 0
    s_mov_b32 s43, 0x20000
    s_lshr_b32 s44, s33, 2
    s_and_b32 s45, s33, 1
    s_lshl_b32 s45, s45, 10
    s_add_u32 s44, s44, s45
    s_lshl_b32 s44, s44, 12
    buffer_load_dwordx2 v[36:37], v6, s[40:43], s44 offen
    buffer_load_dwordx2 v[38:39], v6, s[40:43], s44 offen offset:32
    s_mul_i32 s38, s33, 6144
    s_add_u32 s39, s38, 4096
    v_lshlrev_b32 v5, 4, v1
    s_add_u32 s48, s24, 61358080
    s_addc_u32 s49, s25, 0
    s_and_b32 s49, s49, 0xffff
    s_mov_b32 s50, 135168
    s_mov_b32 s51, 0x20000
    s_add_u32 s52, s24, 49348608
    s_addc_u32 s53, s25, 0
    s_and_b32 s53, s53, 0xffff
    s_mov_b32 s54, 1327104
    s_mov_b32 s55, 0x20000
    s_add_u32 s56, s24, 61575168
    s_addc_u32 s57, s25, 0
    s_and_b32 s57, s57, 0xffff
    s_mov_b32 s58, 84992
    s_mov_b32 s59, 0x20000
    v_mov_b32 v32, 0
    v_mov_b32 v33, 0
    v_mov_b32 v34, 0
    v_mov_b32 v35, 0
    s_lshl_b32 s46, s33, 10
    buffer_store_dwordx4 v[32:35], v5, s[56:59], s46 offen
    s_waitcnt vmcnt(3)
    buffer_store_dwordx4 v[8:11], v5, s[52:55], s38 offen offset:0
    buffer_store_dwordx4 v[12:15], v5, s[52:55], s38 offen offset:1024
    buffer_store_dwordx4 v[16:19], v5, s[52:55], s38 offen offset:2048
    buffer_store_dwordx4 v[20:23], v5, s[52:55], s38 offen offset:3072
    buffer_store_dwordx4 v[24:27], v5, s[52:55], s39 offen offset:0
    buffer_store_dwordx4 v[28:31], v5, s[52:55], s39 offen offset:1024
    s_waitcnt vmcnt(7)
    buffer_store_dwordx4 v[36:39], v5, s[48:51], s46 offen
ka_done3:
    s_endpgm
.globl kbf_kernel
.p2align 8
.type kbf_kernel,@function
kbf_kernel:
    s_cmp_ge_u32 s2, 256
    s_cbranch_scc1 ffn_done
    s_load_dwordx2 s[4:5], s[0:1], 0
    s_load_dwordx2 s[14:15], s[0:1], 96
    s_load_dwordx2 s[18:19], s[0:1], 56
    s_and_b32 s20, s2, 7
    s_lshr_b32 s21, s2, 3
    s_mul_i32 s22, s21, 43
    s_lshr_b32 s22, s22, 8
    s_mul_i32 s23, s22, 6
    s_sub_u32 s23, s21, s23
    s_lshl_b32 s22, s22, 3
    s_add_u32 s22, s22, s20
    v_and_b32 v1, 63, v0
    v_lshrrev_b32 v2, 6, v0
    v_lshlrev_b32 v15, 4, v1
    v_readfirstlane_b32 s24, v2
    s_cmp_gt_u32 s22, 32
    s_cbranch_scc1 kb_side
    s_lshr_b32 s25, s24, 1
    s_and_b32 s26, s24, 1
    s_and_b32 s27, s22, 31
    s_cmp_lg_u32 s27, 0
    s_cselect_b32 s27, -1, 0
    s_and_b32 s28, s27, 32
    s_add_u32 s28, s28, s22
    s_cmp_lg_u32 s25, 0
    s_cselect_b32 s29, s28, s22
    s_mul_i32 s29, s29, 36864
    s_mul_i32 s30, s26, 18432
    s_add_u32 s29, s29, s30
    s_mul_i32 s31, s24, 18432
    s_add_u32 s31, s31, 73728
    s_waitcnt lgkmcnt(0)
    s_add_u32 s32, s14, 65536
    s_addc_u32 s33, s15, 0
    s_and_b32 s33, s33, 0xffff
    s_mov_b32 s34, 2359296
    s_mov_b32 s35, 0x20000
    s_mul_i32 s40, s23, 3072
    s_add_u32 s41, s29, s40
    s_add_u32 m0, s31, s40
    s_nop 0
    buffer_load_dwordx4 v15, s[32:35], s41 offen offset:0 lds
    buffer_load_dwordx4 v15, s[32:35], s41 offen offset:1024 lds
    buffer_load_dwordx4 v15, s[32:35], s41 offen offset:2048 lds
    s_add_u32 s40, s40, 3072
    s_cmp_eq_u32 s40, 18432
    s_cselect_b32 s40, 0, s40
    s_add_u32 s41, s29, s40
    s_add_u32 m0, s31, s40
    s_nop 0
    buffer_load_dwordx4 v15, s[32:35], s41 offen offset:0 lds
    buffer_load_dwordx4 v15, s[32:35], s41 offen offset:1024 lds
    buffer_load_dwordx4 v15, s[32:35], s41 offen offset:2048 lds
    s_add_u32 s40, s40, 3072
    s_cmp_eq_u32 s40, 18432
    s_cselect_b32 s40, 0, s40
    s_add_u32 s41, s29, s40
    s_add_u32 m0, s31, s40
    s_nop 0
    buffer_load_dwordx4 v15, s[32:35], s41 offen offset:0 lds
    buffer_load_dwordx4 v15, s[32:35], s41 offen offset:1024 lds
    buffer_load_dwordx4 v15, s[32:35], s41 offen offset:2048 lds
    s_add_u32 s40, s40, 3072
    s_cmp_eq_u32 s40, 18432
    s_cselect_b32 s40, 0, s40
    s_add_u32 s41, s29, s40
    s_add_u32 m0, s31, s40
    s_nop 0
    buffer_load_dwordx4 v15, s[32:35], s41 offen offset:0 lds
    buffer_load_dwordx4 v15, s[32:35], s41 offen offset:1024 lds
    buffer_load_dwordx4 v15, s[32:35], s41 offen offset:2048 lds
    s_add_u32 s40, s40, 3072
    s_cmp_eq_u32 s40, 18432
    s_cselect_b32 s40, 0, s40
    s_add_u32 s41, s29, s40
    s_add_u32 m0, s31, s40
    s_nop 0
    buffer_load_dwordx4 v15, s[32:35], s41 offen offset:0 lds
    buffer_load_dwordx4 v15, s[32:35], s41 offen offset:1024 lds
    buffer_load_dwordx4 v15, s[32:35], s41 offen offset:2048 lds
    s_add_u32 s40, s40, 3072
    s_cmp_eq_u32 s40, 18432
    s_cselect_b32 s40, 0, s40
    s_add_u32 s41, s29, s40
    s_add_u32 m0, s31, s40
    s_nop 0
    buffer_load_dwordx4 v15, s[32:35], s41 offen offset:0 lds
    buffer_load_dwordx4 v15, s[32:35], s41 offen offset:1024 lds
    buffer_load_dwordx4 v15, s[32:35], s41 offen offset:2048 lds
    s_add_u32 s44, s14, 61358080
    s_addc_u32 s45, s15, 0
    s_and_b32 s45, s45, 0xffff
    s_mov_b32 s46, 135168
    s_mov_b32 s47, 0x20000
    s_lshl_b32 s40, s22, 12
    s_lshl_b32 s41, s25, 11
    s_add_u32 s42, s40, s41
    s_xor_b32 s41, s41, 2048
    s_add_u32 s43, s40, s41
    buffer_load_dwordx4 v[20:23], v15, s[44:47], s42 offen offset:0
    buffer_load_dwordx4 v[28:31], v15, s[44:47], s43 offen offset:0
    buffer_load_dwordx4 v[24:27], v15, s[44:47], s42 offen offset:1024
    buffer_load_dwordx4 v[32:35], v15, s[44:47], s43 offen offset:1024
    s_mov_b32 s36, s14
    s_and_b32 s37, s15, 0xffff
    s_mov_b32 s38, 13824
    s_mov_b32 s39, 0x20000
    s_mul_i32 s40, s24, 3424
    s_add_u32 m0, s40, 147456
    s_nop 0
    buffer_load_dwordx4 v15, s[36:39], s40 offen offset:0 lds
    buffer_load_dwordx4 v15, s[36:39], s40 offen offset:1024 lds
    buffer_load_dwordx4 v15, s[36:39], s40 offen offset:2048 lds
    buffer_load_dwordx4 v15, s[36:39], s40 offen offset:2528 lds
    s_add_u32 s52, s14, 49348608
    s_addc_u32 s53, s15, 0
    s_and_b32 s53, s53, 0xffff
    s_mov_b32 s54, 1327104
    s_mov_b32 s55, 0x20000
    v_add_u32 v16, 4096, v15
    v_add_u32 v17, 8192, v15
    s_mul_i32 s62, s25, 36
    s_mul_i32 s63, s23, 6
    s_add_u32 s62, s62, s63
    s_mul_i32 s62, s62, 18
    s_mul_i32 s63, s26, 9
    s_add_u32 s62, s62, s63
    s_lshl_b32 s62, s62, 10
    s_add_u32 s56, s62, 0
    s_add_u32 s57, s62, 18432
    s_add_u32 s58, s62, 36864
    s_add_u32 s59, s62, 55296
    s_add_u32 s60, s62, 73728
    s_add_u32 s61, s62, 92160
    buffer_load_dwordx4 a[0:3], v15, s[52:55], s56 offen offset:0
    buffer_load_dwordx4 a[4:7], v15, s[52:55], s57 offen offset:0
    buffer_load_dwordx4 a[8:11], v15, s[52:55], s58 offen offset:0
    buffer_load_dwordx4 a[12:15], v15, s[52:55], s59 offen offset:0
    buffer_load_dwordx4 a[16:19], v15, s[52:55], s60 offen offset:0
    buffer_load_dwordx4 a[20:23], v15, s[52:55], s61 offen offset:0
    v_and_b32 v4, 15, v1
    v_lshrrev_b32 v5, 4, v1
    v_lshlrev_b32 v6, 6, v4
    v_add_u32 v6, s22, v6
    s_cmp_lg_u32 s25, 0
    s_cselect_b32 s42, 0x80008000, 0
    v_bfe_u32 v12, v1, 2, 2
    v_lshl_add_u32 v12, v5, 2, v12
    v_and_b32 v13, 6, v12
    v_lshlrev_b32 v13, 4, v13
    v_mul_u32_u24 v12, 1152, v12
    v_and_b32 v14, 3, v1
    v_lshl_add_u32 v12, v14, 3, v12
    s_lshl_b32 s64, s26, 9
    s_add_u32 s64, s64, 73728
    v_add_u32 v12, s64, v12
    s_lshl_b32 s65, s26, 1
    s_add_u32 s66, s65, 0
    s_lshr_b32 s67, s66, 2
    s_lshl_b32 s67, s67, 7
    s_and_b32 s66, s66, 3
    s_lshl_b32 s66, s66, 5
    v_xor_b32 v14, s66, v13
    v_add3_u32 v8, v12, v14, s67
    s_add_u32 s66, s65, 1
    s_lshr_b32 s67, s66, 2
    s_lshl_b32 s67, s67, 7
    s_and_b32 s66, s66, 3
    s_lshl_b32 s66, s66, 5
    v_xor_b32 v14, s66, v13
    v_add3_u32 v9, v12, v14, s67
    s_add_u32 s66, s65, 2
    s_lshr_b32 s67, s66, 2
    s_lshl_b32 s67, s67, 7
    s_and_b32 s66, s66, 3
    s_lshl_b32 s66, s66, 5
    v_xor_b32 v14, s66, v13
    v_add3_u32 v10, v12, v14, s67
    s_add_u32 s66, s65, 3
    s_lshr_b32 s67, s66, 2
    s_lshl_b32 s67, s67, 7
    s_and_b32 s66, s66, 3
    s_lshl_b32 s66, s66, 5
    v_xor_b32 v14, s66, v13
    v_add3_u32 v11, v12, v14, s67
    s_mul_i32 s66, s26, 1152
    s_add_u32 s66, s66, 147456
    v_lshlrev_b32 v18, 5, v5
    v_add_u32 v18, s66, v18
    s_or_b32 s67, s22, s25
    s_cmp_eq_u32 s67, 0
    s_cselect_b32 s67, 0x45000000, 0
    v_mov_b32 v36, s67
    v_cmp_eq_u32 vcc, 0, v4
    s_nop 1
    v_cndmask_b32 v36, 0, v36, vcc
    s_lshr_b32 s68, s24, 1
    s_and_b32 s69, s24, 1
    s_lshl_b32 s70, s69, 10
    s_add_u32 s70, s70, s22
    s_mul_i32 s71, s23, 192
    s_cmp_lg_u32 s68, 0
    s_cselect_b64 vcc, -1, 0
    v_add_u32 v3, 0, v1
    v_mul_u32_u24 v7, 5462, v3
    v_lshrrev_b32 v7, 16, v7
    v_mul_u32_u24 v37, 12, v7
    v_sub_u32 v3, v3, v37
    v_lshlrev_b32 v7, 6, v7
    v_add_u32 v7, s70, v7
    v_sub_u32 v37, 2048, v7
    v_cndmask_b32 v7, v7, v37, vcc
    v_mul_u32_u24 v7, 1152, v7
    v_lshl_add_u32 v233, v3, 4, v7
    v_add_u32 v3, 64, v1
    v_mul_u32_u24 v7, 5462, v3
    v_lshrrev_b32 v7, 16, v7
    v_mul_u32_u24 v37, 12, v7
    v_sub_u32 v3, v3, v37
    v_lshlrev_b32 v7, 6, v7
    v_add_u32 v7, s70, v7
    v_sub_u32 v37, 2048, v7
    v_cndmask_b32 v7, v7, v37, vcc
    v_mul_u32_u24 v7, 1152, v7
    v_lshl_add_u32 v234, v3, 4, v7
    v_add_u32 v3, 128, v1
    v_mul_u32_u24 v7, 5462, v3
    v_lshrrev_b32 v7, 16, v7
    v_mul_u32_u24 v37, 12, v7
    v_sub_u32 v3, v3, v37
    v_lshlrev_b32 v7, 6, v7
    v_add_u32 v7, s70, v7
    v_sub_u32 v37, 2048, v7
    v_cndmask_b32 v7, v7, v37, vcc
    v_mul_u32_u24 v7, 1152, v7
    v_lshl_add_u32 v235, v3, 4, v7
    s_mul_i32 s43, s24, 3072
    v_mul_u32_u24 v38, 192, v4
    v_lshl_add_u32 v38, v5, 3, v38
    v_add_u32 v38, s43, v38
    s_mov_b32 s72, s4
    s_and_b32 s73, s5, 0xffff
    s_mov_b32 s74, 2359296
    s_mov_b32 s75, 0x20000
    v_add_u32 v3, 0, v1
    v_mul_u32_u24 v7, 1821, v3
    v_lshrrev_b32 v7, 16, v7
    v_mul_u32_u24 v37, 36, v7
    v_sub_u32 v3, v3, v37
    v_lshlrev_b32 v3, 4, v3
    v_mul_u32_u24 v37, 1152, v7
    v_add_u32 v224, v3, v37
    v_add_u32 v3, 64, v1
    v_mul_u32_u24 v7, 1821, v3
    v_lshrrev_b32 v7, 16, v7
    v_mul_u32_u24 v37, 36, v7
    v_sub_u32 v3, v3, v37
    v_lshlrev_b32 v3, 4, v3
    v_mul_u32_u24 v37, 1152, v7
    v_add_u32 v225, v3, v37
    v_add_u32 v3, 128, v1
    v_mul_u32_u24 v7, 1821, v3
    v_lshrrev_b32 v7, 16, v7
    v_mul_u32_u24 v37, 36, v7
    v_sub_u32 v3, v3, v37
    v_lshlrev_b32 v3, 4, v3
    v_mul_u32_u24 v37, 1152, v7
    v_add_u32 v226, v3, v37
    v_add_u32 v3, 192, v1
    v_mul_u32_u24 v7, 1821, v3
    v_lshrrev_b32 v7, 16, v7
    v_mul_u32_u24 v37, 36, v7
    v_sub_u32 v3, v3, v37
    v_lshlrev_b32 v3, 4, v3
    v_mul_u32_u24 v37, 1152, v7
    v_add_u32 v227, v3, v37
    v_add_u32 v3, 256, v1
    v_mul_u32_u24 v7, 1821, v3
    v_lshrrev_b32 v7, 16, v7
    v_mul_u32_u24 v37, 36, v7
    v_sub_u32 v3, v3, v37
    v_lshlrev_b32 v3, 4, v3
    v_mul_u32_u24 v37, 1152, v7
    v_add_u32 v228, v3, v37
    v_add_u32 v3, 320, v1
    v_mul_u32_u24 v7, 1821, v3
    v_lshrrev_b32 v7, 16, v7
    v_mul_u32_u24 v37, 36, v7
    v_sub_u32 v3, v3, v37
    v_lshlrev_b32 v3, 4, v3
    v_mul_u32_u24 v37, 1152, v7
    v_add_u32 v229, v3, v37
    v_add_u32 v3, 384, v1
    v_mul_u32_u24 v7, 1821, v3
    v_lshrrev_b32 v7, 16, v7
    v_mul_u32_u24 v37, 36, v7
    v_sub_u32 v3, v3, v37
    v_lshlrev_b32 v3, 4, v3
    v_mul_u32_u24 v37, 1152, v7
    v_add_u32 v230, v3, v37
    v_add_u32 v3, 448, v1
    v_mul_u32_u24 v7, 1821, v3
    v_lshrrev_b32 v7, 16, v7
    v_mul_u32_u24 v37, 36, v7
    v_sub_u32 v3, v3, v37
    v_lshlrev_b32 v3, 4, v3
    v_mul_u32_u24 v37, 1152, v7
    v_add_u32 v231, v3, v37
    v_add_u32 v3, 512, v1
    v_mul_u32_u24 v7, 1821, v3
    v_lshrrev_b32 v7, 16, v7
    v_mul_u32_u24 v37, 36, v7
    v_sub_u32 v3, v3, v37
    v_lshlrev_b32 v3, 4, v3
    v_mul_u32_u24 v37, 1152, v7
    v_add_u32 v232, v3, v37
    s_mov_b32 s8, s18
    s_and_b32 s9, s19, 0xffff
    s_mov_b32 s10, 5308416
    s_mov_b32 s11, 0x20000
    s_mul_i32 s13, s22, 6
    s_add_u32 s13, s13, s23
    s_lshr_b32 s40, s13, 3
    s_bfe_u32 s41, s13, 0x20001
    s_mul_i32 s12, s41, 1152
    s_lshl_b32 s40, s40, 6
    s_add_u32 s12, s12, s40
    s_lshl_b32 s40, s24, 4
    s_add_u32 s12, s12, s40
    s_mul_i32 s12, s12, 1152
    s_and_b32 s40, s13, 1
    s_mul_i32 s40, s40, 576
    s_add_u32 s12, s12, s40
    s_cmp_lt_u32 s13, 144
    s_cselect_b32 s12, s12, 0x70000000
    s_mul_i32 s40, s24, 9216
    s_mul_i32 s76, s24, 12288
    s_add_u32 s76, s76, 73728
    v_add_u32 v39, s76, v15
    s_mul_i32 s76, s23, 384
    s_add_u32 s76, s76, 147456
    v_lshlrev_b32 v2, 4, v5
    v_add_u32 v2, s76, v2
    s_sub_u32 s77, 64, s22
    s_cmp_lg_u32 s68, 0
    s_cselect_b32 s77, s77, s22
    s_cselect_b32 s48, -1.0, 1.0
    s_lshl_b32 s79, s77, 1
    s_add_u32 s79, s79, s69
    s_lshl_b32 s78, s79, 4
    v_add_u32 v244, s78, v4
    v_lshlrev_b32 v244, 6, v244
    s_mul_i32 s80, s23, 3
    s_mul_i32 s79, s79, 18
    s_add_u32 s79, s79, s80
    s_lshl_b32 s79, s79, 10
    s_lshl_b32 s80, s23, 3
    s_mov_b32 s81, 0xffff0000
    s_mov_b32 s82, 0x3f803f80
    s_lshl_b32 s76, s69, 10
    s_add_u32 s76, s76, 73728
    v_add_u32 v245, s76, v15
    s_lshl_b32 s83, s77, 7
    s_add_u32 s83, s83, s80
    s_lshl_b32 s76, s69, 2
    s_add_u32 s83, s83, s76
    s_add_u32 s83, s83, 65536
    s_and_b32 s76, s68, s27
    s_cmp_lg_u32 s76, s68
    s_cselect_b32 s83, 0x70000000, s83
    v_lshrrev_b32 v6, 2, v1
    v_mul_u32_u24 v6, 576, v6
    v_and_b32 v7, 3, v1
    v_lshl_add_u32 v6, v7, 3, v6
    s_mul_i32 s76, s68, 18432
    s_mul_i32 s78, s69, 288
    s_add_u32 s76, s76, s78
    s_add_u32 s76, s76, 36864
    v_add_u32 v6, s76, v6
    s_waitcnt vmcnt(6)
    s_mov_b32 s66, 0x80008000
    v_xor_b32 v20, s42, v20
    v_xor_b32 v28, s66, v28
    v_and_b32 v28, s27, v28
    v_xor_b32 v21, s42, v21
    v_xor_b32 v29, s66, v29
    v_and_b32 v29, s27, v29
    v_xor_b32 v22, s42, v22
    v_xor_b32 v30, s66, v30
    v_and_b32 v30, s27, v30
    v_xor_b32 v23, s42, v23
    v_xor_b32 v31, s66, v31
    v_and_b32 v31, s27, v31
    v_xor_b32 v24, s42, v24
    v_xor_b32 v32, s66, v32
    v_and_b32 v32, s27, v32
    v_xor_b32 v25, s42, v25
    v_xor_b32 v33, s66, v33
    v_and_b32 v33, s27, v33
    v_xor_b32 v26, s42, v26
    v_xor_b32 v34, s66, v34
    v_and_b32 v34, s27, v34
    v_xor_b32 v27, s42, v27
    v_xor_b32 v35, s66, v35
    v_and_b32 v35, s27, v35
    s_barrier
    ds_read_b64_tr_b16 v[88:89], v8 offset:0
    ds_read_b64_tr_b16 v[90:91], v8 offset:18432
    ds_read_b64_tr_b16 v[92:93], v8 offset:36864
    ds_read_b64_tr_b16 v[94:95], v8 offset:55296
    ds_read_b64_tr_b16 v[96:97], v9 offset:0
    ds_read_b64_tr_b16 v[98:99], v9 offset:18432
    ds_read_b64_tr_b16 v[100:101], v9 offset:36864
    ds_read_b64_tr_b16 v[102:103], v9 offset:55296
    ds_read_b128 v[168:171], v18 offset:2304
    ds_read_b128 v[176:179], v18 offset:0
    ds_read_b128 v[172:175], v18 offset:2320
    ds_read_b128 v[180:183], v18 offset:16
    ds_read_b64_tr_b16 v[104:105], v10 offset:0
    ds_read_b64_tr_b16 v[106:107], v10 offset:18432
    ds_read_b64_tr_b16 v[108:109], v10 offset:36864
    ds_read_b64_tr_b16 v[110:111], v10 offset:55296
    ds_read_b64_tr_b16 v[112:113], v11 offset:0
    ds_read_b64_tr_b16 v[114:115], v11 offset:18432
    ds_read_b64_tr_b16 v[116:117], v11 offset:36864
    ds_read_b64_tr_b16 v[118:119], v11 offset:55296
    ds_read_b128 v[184:187], v18 offset:2432
    ds_read_b128 v[192:195], v18 offset:128
    ds_read_b128 v[188:191], v18 offset:2448
    ds_read_b128 v[196:199], v18 offset:144
    buffer_load_dwordx4 a[24:27], v15, s[52:55], s56 offen offset:1024
    buffer_load_dwordx4 a[28:31], v15, s[52:55], s57 offen offset:1024
    buffer_load_dwordx4 a[32:35], v15, s[52:55], s58 offen offset:1024
    buffer_load_dwordx4 a[36:39], v15, s[52:55], s59 offen offset:1024
    buffer_load_dwordx4 a[40:43], v15, s[52:55], s60 offen offset:1024
    buffer_load_dwordx4 a[44:47], v15, s[52:55], s61 offen offset:1024
    buffer_load_dwordx4 a[48:51], v15, s[52:55], s56 offen offset:2048
    buffer_load_dwordx4 a[52:55], v15, s[52:55], s57 offen offset:2048
    buffer_load_dwordx4 a[56:59], v15, s[52:55], s58 offen offset:2048
    buffer_load_dwordx4 a[60:63], v15, s[52:55], s59 offen offset:2048
    buffer_load_dwordx4 a[64:67], v15, s[52:55], s60 offen offset:2048
    buffer_load_dwordx4 a[68:71], v15, s[52:55], s61 offen offset:2048
    buffer_load_dwordx4 a[72:75], v15, s[52:55], s56 offen offset:3072
    buffer_load_dwordx4 a[76:79], v15, s[52:55], s57 offen offset:3072
    buffer_load_dwordx4 a[80:83], v15, s[52:55], s58 offen offset:3072
    buffer_load_dwordx4 a[84:87], v15, s[52:55], s59 offen offset:3072
    buffer_load_dwordx4 a[88:91], v15, s[52:55], s60 offen offset:3072
    buffer_load_dwordx4 a[92:95], v15, s[52:55], s61 offen offset:3072
    s_waitcnt lgkmcnt(12)
    v_mfma_f32_16x16x32_bf16 v[120:123], v[88:91], v[20:23], 0
    v_mfma_f32_16x16x32_bf16 v[124:127], v[88:91], v[24:27], 0
    v_mfma_f32_16x16x32_bf16 v[128:131], v[96:99], v[20:23], 0
    v_mfma_f32_16x16x32_bf16 v[132:135], v[96:99], v[24:27], 0
    v_mfma_f32_16x16x32_bf16 v[120:123], v[92:95], v[28:31], v[120:123]
    v_mfma_f32_16x16x32_bf16 v[124:127], v[92:95], v[32:35], v[124:127]
    v_mfma_f32_16x16x32_bf16 v[128:131], v[100:103], v[28:31], v[128:131]
    v_mfma_f32_16x16x32_bf16 v[132:135], v[100:103], v[32:35], v[132:135]
    s_nop 5
    v_mul_f32 v124, v124, v168
    v_mul_f32 v125, v125, v169
    v_mul_f32 v126, v126, v170
    v_mul_f32 v127, v127, v171
    v_mul_f32 v132, v132, v172
    v_mul_f32 v133, v133, v173
    v_mul_f32 v134, v134, v174
    v_mul_f32 v135, v135, v175
    v_cvt_pk_bf16_f32 v156, v124, v125
    v_cvt_pk_bf16_f32 v157, v126, v127
    v_cvt_pk_bf16_f32 v158, v132, v133
    v_cvt_pk_bf16_f32 v159, v134, v135
    v_mul_f32 v120, v120, v168
    v_mul_f32 v121, v121, v169
    v_mul_f32 v122, v122, v170
    v_mul_f32 v123, v123, v171
    v_mul_f32 v128, v128, v172
    v_mul_f32 v129, v129, v173
    v_mul_f32 v130, v130, v174
    v_mul_f32 v131, v131, v175
    s_cmp_lg_u32 s67, 0
    s_cbranch_scc0 kb_nd0
    v_fmac_f32 v120, v176, v36
    v_fmac_f32 v121, v177, v36
    v_fmac_f32 v122, v178, v36
    v_fmac_f32 v123, v179, v36
    v_fmac_f32 v128, v180, v36
    v_fmac_f32 v129, v181, v36
    v_fmac_f32 v130, v182, v36
    v_fmac_f32 v131, v183, v36
kb_nd0:
    v_cvt_pk_bf16_f32 v152, v120, v121
    v_cvt_pk_bf16_f32 v153, v122, v123
    v_cvt_pk_bf16_f32 v154, v128, v129
    v_cvt_pk_bf16_f32 v155, v130, v131
    s_waitcnt lgkmcnt(0)
    v_mfma_f32_16x16x32_bf16 v[136:139], v[104:107], v[20:23], 0
    ds_read_b64_tr_b16 v[88:89], v8 offset:128
    ds_read_b64_tr_b16 v[90:91], v8 offset:18560
    v_mfma_f32_16x16x32_bf16 v[140:143], v[104:107], v[24:27], 0
    ds_read_b64_tr_b16 v[92:93], v8 offset:36992
    ds_read_b64_tr_b16 v[94:95], v8 offset:55424
    v_mfma_f32_16x16x32_bf16 v[144:147], v[112:115], v[20:23], 0
    ds_read_b64_tr_b16 v[96:97], v9 offset:128
    ds_read_b64_tr_b16 v[98:99], v9 offset:18560
    v_mfma_f32_16x16x32_bf16 v[148:151], v[112:115], v[24:27], 0
    ds_read_b64_tr_b16 v[100:101], v9 offset:36992
    ds_read_b64_tr_b16 v[102:103], v9 offset:55424
    v_mfma_f32_16x16x32_bf16 v[136:139], v[108:111], v[28:31], v[136:139]
    ds_read_b128 v[168:171], v18 offset:2560
    ds_read_b128 v[176:179], v18 offset:256
    v_mfma_f32_16x16x32_bf16 v[140:143], v[108:111], v[32:35], v[140:143]
    ds_read_b128 v[172:175], v18 offset:2576
    ds_read_b128 v[180:183], v18 offset:272
    v_mfma_f32_16x16x32_bf16 v[144:147], v[116:119], v[28:31], v[144:147]
    buffer_load_dwordx4 a[96:99], v16, s[52:55], s56 offen offset:0
    buffer_load_dwordx4 a[100:103], v16, s[52:55], s57 offen offset:0
    v_mfma_f32_16x16x32_bf16 v[148:151], v[116:119], v[32:35], v[148:151]
    buffer_load_dwordx4 a[104:107], v16, s[52:55], s58 offen offset:0
    buffer_load_dwordx4 a[108:111], v16, s[52:55], s59 offen offset:0
    buffer_load_dwordx4 a[112:115], v16, s[52:55], s60 offen offset:0
    buffer_load_dwordx4 a[116:119], v16, s[52:55], s61 offen offset:0
    s_waitcnt vmcnt(24)
    v_mfma_f32_16x16x32_bf16 v[40:43], a[0:3], v[152:155], 0
    v_mul_f32 v140, v140, v184
    v_mul_f32 v141, v141, v185
    v_mfma_f32_16x16x32_bf16 v[44:47], a[0:3], v[156:159], 0
    v_mul_f32 v142, v142, v186
    v_mul_f32 v143, v143, v187
    v_mfma_f32_16x16x32_bf16 v[48:51], a[4:7], v[152:155], 0
    v_mul_f32 v148, v148, v188
    v_mul_f32 v149, v149, v189
    v_mfma_f32_16x16x32_bf16 v[52:55], a[4:7], v[156:159], 0
    v_mul_f32 v150, v150, v190
    v_mul_f32 v151, v151, v191
    v_mfma_f32_16x16x32_bf16 v[56:59], a[8:11], v[152:155], 0
    v_cvt_pk_bf16_f32 v164, v140, v141
    v_cvt_pk_bf16_f32 v165, v142, v143
    v_mfma_f32_16x16x32_bf16 v[60:63], a[8:11], v[156:159], 0
    v_cvt_pk_bf16_f32 v166, v148, v149
    v_cvt_pk_bf16_f32 v167, v150, v151
    v_mfma_f32_16x16x32_bf16 v[64:67], a[12:15], v[152:155], 0
    v_mul_f32 v136, v136, v184
    v_mul_f32 v137, v137, v185
    v_mfma_f32_16x16x32_bf16 v[68:71], a[12:15], v[156:159], 0
    v_mul_f32 v138, v138, v186
    v_mul_f32 v139, v139, v187
    v_mfma_f32_16x16x32_bf16 v[72:75], a[16:19], v[152:155], 0
    v_mul_f32 v144, v144, v188
    v_mul_f32 v145, v145, v189
    v_mfma_f32_16x16x32_bf16 v[76:79], a[16:19], v[156:159], 0
    v_mul_f32 v146, v146, v190
    v_mul_f32 v147, v147, v191
    v_mfma_f32_16x16x32_bf16 v[80:83], a[20:23], v[152:155], 0
    s_cmp_lg_u32 s67, 0
    s_cbranch_scc0 kb_nd1
    v_fmac_f32 v136, v192, v36
    v_fmac_f32 v137, v193, v36
    v_fmac_f32 v138, v194, v36
    v_fmac_f32 v139, v195, v36
    v_fmac_f32 v144, v196, v36
    v_fmac_f32 v145, v197, v36
    v_fmac_f32 v146, v198, v36
    v_fmac_f32 v147, v199, v36
kb_nd1:
    v_cvt_pk_bf16_f32 v160, v136, v137
    v_mfma_f32_16x16x32_bf16 v[84:87], a[20:23], v[156:159], 0
    v_cvt_pk_bf16_f32 v161, v138, v139
    v_cvt_pk_bf16_f32 v162, v144, v145
    v_cvt_pk_bf16_f32 v163, v146, v147
    s_waitcnt lgkmcnt(0)
    v_mfma_f32_16x16x32_bf16 v[120:123], v[88:91], v[20:23], 0
    ds_read_b64_tr_b16 v[104:105], v10 offset:128
    ds_read_b64_tr_b16 v[106:107], v10 offset:18560
    v_mfma_f32_16x16x32_bf16 v[124:127], v[88:91], v[24:27], 0
    ds_read_b64_tr_b16 v[108:109], v10 offset:36992
    ds_read_b64_tr_b16 v[110:111], v10 offset:55424
    v_mfma_f32_16x16x32_bf16 v[128:131], v[96:99], v[20:23], 0
    ds_read_b64_tr_b16 v[112:113], v11 offset:128
    ds_read_b64_tr_b16 v[114:115], v11 offset:18560
    v_mfma_f32_16x16x32_bf16 v[132:135], v[96:99], v[24:27], 0
    ds_read_b64_tr_b16 v[116:117], v11 offset:36992
    ds_read_b64_tr_b16 v[118:119], v11 offset:55424
    v_mfma_f32_16x16x32_bf16 v[120:123], v[92:95], v[28:31], v[120:123]
    ds_read_b128 v[184:187], v18 offset:2688
    ds_read_b128 v[192:195], v18 offset:384
    v_mfma_f32_16x16x32_bf16 v[124:127], v[92:95], v[32:35], v[124:127]
    ds_read_b128 v[188:191], v18 offset:2704
    ds_read_b128 v[196:199], v18 offset:400
    v_mfma_f32_16x16x32_bf16 v[128:131], v[100:103], v[28:31], v[128:131]
    buffer_load_dwordx4 a[120:123], v16, s[52:55], s56 offen offset:1024
    buffer_load_dwordx4 a[124:127], v16, s[52:55], s57 offen offset:1024
    v_mfma_f32_16x16x32_bf16 v[132:135], v[100:103], v[32:35], v[132:135]
    buffer_load_dwordx4 a[128:131], v16, s[52:55], s58 offen offset:1024
    buffer_load_dwordx4 a[132:135], v16, s[52:55], s59 offen offset:1024
    buffer_load_dwordx4 a[136:139], v16, s[52:55], s60 offen offset:1024
    buffer_load_dwordx4 a[140:143], v16, s[52:55], s61 offen offset:1024
    s_waitcnt vmcnt(24)
    v_mfma_f32_16x16x32_bf16 v[40:43], a[24:27], v[160:163], v[40:43]
    v_mul_f32 v124, v124, v168
    v_mul_f32 v125, v125, v169
    v_mfma_f32_16x16x32_bf16 v[44:47], a[24:27], v[164:167], v[44:47]
    v_mul_f32 v126, v126, v170
    v_mul_f32 v127, v127, v171
    v_mfma_f32_16x16x32_bf16 v[48:51], a[28:31], v[160:163], v[48:51]
    v_mul_f32 v132, v132, v172
    v_mul_f32 v133, v133, v173
    v_mfma_f32_16x16x32_bf16 v[52:55], a[28:31], v[164:167], v[52:55]
    v_mul_f32 v134, v134, v174
    v_mul_f32 v135, v135, v175
    v_mfma_f32_16x16x32_bf16 v[56:59], a[32:35], v[160:163], v[56:59]
    v_cvt_pk_bf16_f32 v156, v124, v125
    v_cvt_pk_bf16_f32 v157, v126, v127
    v_mfma_f32_16x16x32_bf16 v[60:63], a[32:35], v[164:167], v[60:63]
    v_cvt_pk_bf16_f32 v158, v132, v133
    v_cvt_pk_bf16_f32 v159, v134, v135
    v_mfma_f32_16x16x32_bf16 v[64:67], a[36:39], v[160:163], v[64:67]
    v_mul_f32 v120, v120, v168
    v_mul_f32 v121, v121, v169
    v_mfma_f32_16x16x32_bf16 v[68:71], a[36:39], v[164:167], v[68:71]
    v_mul_f32 v122, v122, v170
    v_mul_f32 v123, v123, v171
    v_mfma_f32_16x16x32_bf16 v[72:75], a[40:43], v[160:163], v[72:75]
    v_mul_f32 v128, v128, v172
    v_mul_f32 v129, v129, v173
    v_mfma_f32_16x16x32_bf16 v[76:79], a[40:43], v[164:167], v[76:79]
    v_mul_f32 v130, v130, v174
    v_mul_f32 v131, v131, v175
    v_mfma_f32_16x16x32_bf16 v[80:83], a[44:47], v[160:163], v[80:83]
    s_cmp_lg_u32 s67, 0
    s_cbranch_scc0 kb_nd2
    v_fmac_f32 v120, v176, v36
    v_fmac_f32 v121, v177, v36
    v_fmac_f32 v122, v178, v36
    v_fmac_f32 v123, v179, v36
    v_fmac_f32 v128, v180, v36
    v_fmac_f32 v129, v181, v36
    v_fmac_f32 v130, v182, v36
    v_fmac_f32 v131, v183, v36
kb_nd2:
    v_cvt_pk_bf16_f32 v152, v120, v121
    v_mfma_f32_16x16x32_bf16 v[84:87], a[44:47], v[164:167], v[84:87]
    v_cvt_pk_bf16_f32 v153, v122, v123
    v_cvt_pk_bf16_f32 v154, v128, v129
    v_cvt_pk_bf16_f32 v155, v130, v131
    s_waitcnt lgkmcnt(0)
    v_mfma_f32_16x16x32_bf16 v[136:139], v[104:107], v[20:23], 0
    ds_read_b64_tr_b16 v[88:89], v8 offset:256
    ds_read_b64_tr_b16 v[90:91], v8 offset:18688
    v_mfma_f32_16x16x32_bf16 v[140:143], v[104:107], v[24:27], 0
    ds_read_b64_tr_b16 v[92:93], v8 offset:37120
    ds_read_b64_tr_b16 v[94:95], v8 offset:55552
    v_mfma_f32_16x16x32_bf16 v[144:147], v[112:115], v[20:23], 0
    ds_read_b64_tr_b16 v[96:97], v9 offset:256
    ds_read_b64_tr_b16 v[98:99], v9 offset:18688
    v_mfma_f32_16x16x32_bf16 v[148:151], v[112:115], v[24:27], 0
    ds_read_b64_tr_b16 v[100:101], v9 offset:37120
    ds_read_b64_tr_b16 v[102:103], v9 offset:55552
    v_mfma_f32_16x16x32_bf16 v[136:139], v[108:111], v[28:31], v[136:139]
    ds_read_b128 v[168:171], v18 offset:2816
    ds_read_b128 v[176:179], v18 offset:512
    v_mfma_f32_16x16x32_bf16 v[140:143], v[108:111], v[32:35], v[140:143]
    ds_read_b128 v[172:175], v18 offset:2832
    ds_read_b128 v[180:183], v18 offset:528
    v_mfma_f32_16x16x32_bf16 v[144:147], v[116:119], v[28:31], v[144:147]
    buffer_load_dwordx4 a[144:147], v16, s[52:55], s56 offen offset:2048
    buffer_load_dwordx4 a[148:151], v16, s[52:55], s57 offen offset:2048
    v_mfma_f32_16x16x32_bf16 v[148:151], v[116:119], v[32:35], v[148:151]
    buffer_load_dwordx4 a[152:155], v16, s[52:55], s58 offen offset:2048
    buffer_load_dwordx4 a[156:159], v16, s[52:55], s59 offen offset:2048
    buffer_load_dwordx4 a[160:163], v16, s[52:55], s60 offen offset:2048
    buffer_load_dwordx4 a[164:167], v16, s[52:55], s61 offen offset:2048
    s_waitcnt vmcnt(24)
    v_mfma_f32_16x16x32_bf16 v[40:43], a[48:51], v[152:155], v[40:43]
    v_mul_f32 v140, v140, v184
    v_mul_f32 v141, v141, v185
    v_mfma_f32_16x16x32_bf16 v[44:47], a[48:51], v[156:159], v[44:47]
    v_mul_f32 v142, v142, v186
    v_mul_f32 v143, v143, v187
    v_mfma_f32_16x16x32_bf16 v[48:51], a[52:55], v[152:155], v[48:51]
    v_mul_f32 v148, v148, v188
    v_mul_f32 v149, v149, v189
    v_mfma_f32_16x16x32_bf16 v[52:55], a[52:55], v[156:159], v[52:55]
    v_mul_f32 v150, v150, v190
    v_mul_f32 v151, v151, v191
    v_mfma_f32_16x16x32_bf16 v[56:59], a[56:59], v[152:155], v[56:59]
    v_cvt_pk_bf16_f32 v164, v140, v141
    v_cvt_pk_bf16_f32 v165, v142, v143
    v_mfma_f32_16x16x32_bf16 v[60:63], a[56:59], v[156:159], v[60:63]
    v_cvt_pk_bf16_f32 v166, v148, v149
    v_cvt_pk_bf16_f32 v167, v150, v151
    v_mfma_f32_16x16x32_bf16 v[64:67], a[60:63], v[152:155], v[64:67]
    v_mul_f32 v136, v136, v184
    v_mul_f32 v137, v137, v185
    v_mfma_f32_16x16x32_bf16 v[68:71], a[60:63], v[156:159], v[68:71]
    v_mul_f32 v138, v138, v186
    v_mul_f32 v139, v139, v187
    v_mfma_f32_16x16x32_bf16 v[72:75], a[64:67], v[152:155], v[72:75]
    v_mul_f32 v144, v144, v188
    v_mul_f32 v145, v145, v189
    v_mfma_f32_16x16x32_bf16 v[76:79], a[64:67], v[156:159], v[76:79]
    v_mul_f32 v146, v146, v190
    v_mul_f32 v147, v147, v191
    v_mfma_f32_16x16x32_bf16 v[80:83], a[68:71], v[152:155], v[80:83]
    s_cmp_lg_u32 s67, 0
    s_cbranch_scc0 kb_nd3
    v_fmac_f32 v136, v192, v36
    v_fmac_f32 v137, v193, v36
    v_fmac_f32 v138, v194, v36
    v_fmac_f32 v139, v195, v36
    v_fmac_f32 v144, v196, v36
    v_fmac_f32 v145, v197, v36
    v_fmac_f32 v146, v198, v36
    v_fmac_f32 v147, v199, v36
kb_nd3:
    v_cvt_pk_bf16_f32 v160, v136, v137
    v_mfma_f32_16x16x32_bf16 v[84:87], a[68:71], v[156:159], v[84:87]
    v_cvt_pk_bf16_f32 v161, v138, v139
    v_cvt_pk_bf16_f32 v162, v144, v145
    v_cvt_pk_bf16_f32 v163, v146, v147
    s_waitcnt lgkmcnt(0)
    v_mfma_f32_16x16x32_bf16 v[120:123], v[88:91], v[20:23], 0
    ds_read_b64_tr_b16 v[104:105], v10 offset:256
    ds_read_b64_tr_b16 v[106:107], v10 offset:18688
    v_mfma_f32_16x16x32_bf16 v[124:127], v[88:91], v[24:27], 0
    ds_read_b64_tr_b16 v[108:109], v10 offset:37120
    ds_read_b64_tr_b16 v[110:111], v10 offset:55552
    v_mfma_f32_16x16x32_bf16 v[128:131], v[96:99], v[20:23], 0
    ds_read_b64_tr_b16 v[112:113], v11 offset:256
    ds_read_b64_tr_b16 v[114:115], v11 offset:18688
    v_mfma_f32_16x16x32_bf16 v[132:135], v[96:99], v[24:27], 0
    ds_read_b64_tr_b16 v[116:117], v11 offset:37120
    ds_read_b64_tr_b16 v[118:119], v11 offset:55552
    v_mfma_f32_16x16x32_bf16 v[120:123], v[92:95], v[28:31], v[120:123]
    ds_read_b128 v[184:187], v18 offset:2944
    ds_read_b128 v[192:195], v18 offset:640
    v_mfma_f32_16x16x32_bf16 v[124:127], v[92:95], v[32:35], v[124:127]
    ds_read_b128 v[188:191], v18 offset:2960
    ds_read_b128 v[196:199], v18 offset:656
    v_mfma_f32_16x16x32_bf16 v[128:131], v[100:103], v[28:31], v[128:131]
    buffer_load_dwordx4 a[168:171], v16, s[52:55], s56 offen offset:3072
    buffer_load_dwordx4 a[172:175], v16, s[52:55], s57 offen offset:3072
    v_mfma_f32_16x16x32_bf16 v[132:135], v[100:103], v[32:35], v[132:135]
    buffer_load_dwordx4 a[176:179], v16, s[52:55], s58 offen offset:3072
    buffer_load_dwordx4 a[180:183], v16, s[52:55], s59 offen offset:3072
    buffer_load_dwordx4 a[184:187], v16, s[52:55], s60 offen offset:3072
    buffer_load_dwordx4 a[188:191], v16, s[52:55], s61 offen offset:3072
    s_waitcnt vmcnt(24)
    v_mfma_f32_16x16x32_bf16 v[40:43], a[72:75], v[160:163], v[40:43]
    v_mul_f32 v124, v124, v168
    v_mul_f32 v125, v125, v169
    v_mfma_f32_16x16x32_bf16 v[44:47], a[72:75], v[164:167], v[44:47]
    v_mul_f32 v126, v126, v170
    v_mul_f32 v127, v127, v171
    v_mfma_f32_16x16x32_bf16 v[48:51], a[76:79], v[160:163], v[48:51]
    v_mul_f32 v132, v132, v172
    v_mul_f32 v133, v133, v173
    v_mfma_f32_16x16x32_bf16 v[52:55], a[76:79], v[164:167], v[52:55]
    v_mul_f32 v134, v134, v174
    v_mul_f32 v135, v135, v175
    v_mfma_f32_16x16x32_bf16 v[56:59], a[80:83], v[160:163], v[56:59]
    v_cvt_pk_bf16_f32 v156, v124, v125
    v_cvt_pk_bf16_f32 v157, v126, v127
    v_mfma_f32_16x16x32_bf16 v[60:63], a[80:83], v[164:167], v[60:63]
    v_cvt_pk_bf16_f32 v158, v132, v133
    v_cvt_pk_bf16_f32 v159, v134, v135
    v_mfma_f32_16x16x32_bf16 v[64:67], a[84:87], v[160:163], v[64:67]
    v_mul_f32 v120, v120, v168
    v_mul_f32 v121, v121, v169
    v_mfma_f32_16x16x32_bf16 v[68:71], a[84:87], v[164:167], v[68:71]
    v_mul_f32 v122, v122, v170
    v_mul_f32 v123, v123, v171
    v_mfma_f32_16x16x32_bf16 v[72:75], a[88:91], v[160:163], v[72:75]
    v_mul_f32 v128, v128, v172
    v_mul_f32 v129, v129, v173
    v_mfma_f32_16x16x32_bf16 v[76:79], a[88:91], v[164:167], v[76:79]
    v_mul_f32 v130, v130, v174
    v_mul_f32 v131, v131, v175
    v_mfma_f32_16x16x32_bf16 v[80:83], a[92:95], v[160:163], v[80:83]
    s_cmp_lg_u32 s67, 0
    s_cbranch_scc0 kb_nd4
    v_fmac_f32 v120, v176, v36
    v_fmac_f32 v121, v177, v36
    v_fmac_f32 v122, v178, v36
    v_fmac_f32 v123, v179, v36
    v_fmac_f32 v128, v180, v36
    v_fmac_f32 v129, v181, v36
    v_fmac_f32 v130, v182, v36
    v_fmac_f32 v131, v183, v36
kb_nd4:
    v_cvt_pk_bf16_f32 v152, v120, v121
    v_mfma_f32_16x16x32_bf16 v[84:87], a[92:95], v[164:167], v[84:87]
    v_cvt_pk_bf16_f32 v153, v122, v123
    v_cvt_pk_bf16_f32 v154, v128, v129
    v_cvt_pk_bf16_f32 v155, v130, v131
    s_waitcnt lgkmcnt(0)
    v_mfma_f32_16x16x32_bf16 v[136:139], v[104:107], v[20:23], 0
    ds_read_b64_tr_b16 v[88:89], v8 offset:384
    ds_read_b64_tr_b16 v[90:91], v8 offset:18816
    v_mfma_f32_16x16x32_bf16 v[140:143], v[104:107], v[24:27], 0
    ds_read_b64_tr_b16 v[92:93], v8 offset:37248
    ds_read_b64_tr_b16 v[94:95], v8 offset:55680
    v_mfma_f32_16x16x32_bf16 v[144:147], v[112:115], v[20:23], 0
    ds_read_b64_tr_b16 v[96:97], v9 offset:384
    ds_read_b64_tr_b16 v[98:99], v9 offset:18816
    v_mfma_f32_16x16x32_bf16 v[148:151], v[112:115], v[24:27], 0
    ds_read_b64_tr_b16 v[100:101], v9 offset:37248
    ds_read_b64_tr_b16 v[102:103], v9 offset:55680
    v_mfma_f32_16x16x32_bf16 v[136:139], v[108:111], v[28:31], v[136:139]
    ds_read_b128 v[168:171], v18 offset:3072
    ds_read_b128 v[176:179], v18 offset:768
    v_mfma_f32_16x16x32_bf16 v[140:143], v[108:111], v[32:35], v[140:143]
    ds_read_b128 v[172:175], v18 offset:3088
    ds_read_b128 v[180:183], v18 offset:784
    v_mfma_f32_16x16x32_bf16 v[144:147], v[116:119], v[28:31], v[144:147]
    buffer_load_dwordx4 a[192:195], v17, s[52:55], s56 offen offset:0
    buffer_load_dwordx4 a[196:199], v17, s[52:55], s57 offen offset:0
    v_mfma_f32_16x16x32_bf16 v[148:151], v[116:119], v[32:35], v[148:151]
    buffer_load_dwordx4 a[200:203], v17, s[52:55], s58 offen offset:0
    buffer_load_dwordx4 a[204:207], v17, s[52:55], s59 offen offset:0
    buffer_load_dwordx4 a[208:211], v17, s[52:55], s60 offen offset:0
    buffer_load_dwordx4 a[212:215], v17, s[52:55], s61 offen offset:0
    s_waitcnt vmcnt(24)
    v_mfma_f32_16x16x32_bf16 v[40:43], a[96:99], v[152:155], v[40:43]
    v_mul_f32 v140, v140, v184
    v_mul_f32 v141, v141, v185
    v_mfma_f32_16x16x32_bf16 v[44:47], a[96:99], v[156:159], v[44:47]
    v_mul_f32 v142, v142, v186
    v_mul_f32 v143, v143, v187
    v_mfma_f32_16x16x32_bf16 v[48:51], a[100:103], v[152:155], v[48:51]
    v_mul_f32 v148, v148, v188
    v_mul_f32 v149, v149, v189
    v_mfma_f32_16x16x32_bf16 v[52:55], a[100:103], v[156:159], v[52:55]
    v_mul_f32 v150, v150, v190
    v_mul_f32 v151, v151, v191
    v_mfma_f32_16x16x32_bf16 v[56:59], a[104:107], v[152:155], v[56:59]
    v_cvt_pk_bf16_f32 v164, v140, v141
    v_cvt_pk_bf16_f32 v165, v142, v143
    v_mfma_f32_16x16x32_bf16 v[60:63], a[104:107], v[156:159], v[60:63]
    v_cvt_pk_bf16_f32 v166, v148, v149
    v_cvt_pk_bf16_f32 v167, v150, v151
    v_mfma_f32_16x16x32_bf16 v[64:67], a[108:111], v[152:155], v[64:67]
    v_mul_f32 v136, v136, v184
    v_mul_f32 v137, v137, v185
    v_mfma_f32_16x16x32_bf16 v[68:71], a[108:111], v[156:159], v[68:71]
    v_mul_f32 v138, v138, v186
    v_mul_f32 v139, v139, v187
    v_mfma_f32_16x16x32_bf16 v[72:75], a[112:115], v[152:155], v[72:75]
    v_mul_f32 v144, v144, v188
    v_mul_f32 v145, v145, v189
    v_mfma_f32_16x16x32_bf16 v[76:79], a[112:115], v[156:159], v[76:79]
    v_mul_f32 v146, v146, v190
    v_mul_f32 v147, v147, v191
    v_mfma_f32_16x16x32_bf16 v[80:83], a[116:119], v[152:155], v[80:83]
    s_cmp_lg_u32 s67, 0
    s_cbranch_scc0 kb_nd5
    v_fmac_f32 v136, v192, v36
    v_fmac_f32 v137, v193, v36
    v_fmac_f32 v138, v194, v36
    v_fmac_f32 v139, v195, v36
    v_fmac_f32 v144, v196, v36
    v_fmac_f32 v145, v197, v36
    v_fmac_f32 v146, v198, v36
    v_fmac_f32 v147, v199, v36
kb_nd5:
    v_cvt_pk_bf16_f32 v160, v136, v137
    v_mfma_f32_16x16x32_bf16 v[84:87], a[116:119], v[156:159], v[84:87]
    v_cvt_pk_bf16_f32 v161, v138, v139
    v_cvt_pk_bf16_f32 v162, v144, v145
    v_cvt_pk_bf16_f32 v163, v146, v147
    s_waitcnt lgkmcnt(0)
    v_mfma_f32_16x16x32_bf16 v[120:123], v[88:91], v[20:23], 0
    ds_read_b64_tr_b16 v[104:105], v10 offset:384
    ds_read_b64_tr_b16 v[106:107], v10 offset:18816
    v_mfma_f32_16x16x32_bf16 v[124:127], v[88:91], v[24:27], 0
    ds_read_b64_tr_b16 v[108:109], v10 offset:37248
    ds_read_b64_tr_b16 v[110:111], v10 offset:55680
    v_mfma_f32_16x16x32_bf16 v[128:131], v[96:99], v[20:23], 0
    ds_read_b64_tr_b16 v[112:113], v11 offset:384
    ds_read_b64_tr_b16 v[114:115], v11 offset:18816
    v_mfma_f32_16x16x32_bf16 v[132:135], v[96:99], v[24:27], 0
    ds_read_b64_tr_b16 v[116:117], v11 offset:37248
    ds_read_b64_tr_b16 v[118:119], v11 offset:55680
    v_mfma_f32_16x16x32_bf16 v[120:123], v[92:95], v[28:31], v[120:123]
    ds_read_b128 v[184:187], v18 offset:3200
    ds_read_b128 v[192:195], v18 offset:896
    v_mfma_f32_16x16x32_bf16 v[124:127], v[92:95], v[32:35], v[124:127]
    ds_read_b128 v[188:191], v18 offset:3216
    ds_read_b128 v[196:199], v18 offset:912
    v_mfma_f32_16x16x32_bf16 v[128:131], v[100:103], v[28:31], v[128:131]
    s_add_u32 m0, s43, 0
    s_nop 0
    buffer_load_dwordx4 v233, s[72:75], s71 offen lds
    s_add_u32 m0, s43, 1024
    s_nop 0
    buffer_load_dwordx4 v234, s[72:75], s71 offen lds
    s_add_u32 m0, s43, 2048
    s_nop 0
    buffer_load_dwordx4 v235, s[72:75], s71 offen lds
    v_mfma_f32_16x16x32_bf16 v[132:135], v[100:103], v[32:35], v[132:135]
    s_waitcnt vmcnt(21)
    v_mfma_f32_16x16x32_bf16 v[40:43], a[120:123], v[160:163], v[40:43]
    v_mul_f32 v124, v124, v168
    v_mul_f32 v125, v125, v169
    v_mfma_f32_16x16x32_bf16 v[44:47], a[120:123], v[164:167], v[44:47]
    v_mul_f32 v126, v126, v170
    v_mul_f32 v127, v127, v171
    v_mfma_f32_16x16x32_bf16 v[48:51], a[124:127], v[160:163], v[48:51]
    v_mul_f32 v132, v132, v172
    v_mul_f32 v133, v133, v173
    v_mfma_f32_16x16x32_bf16 v[52:55], a[124:127], v[164:167], v[52:55]
    v_mul_f32 v134, v134, v174
    v_mul_f32 v135, v135, v175
    v_mfma_f32_16x16x32_bf16 v[56:59], a[128:131], v[160:163], v[56:59]
    v_cvt_pk_bf16_f32 v156, v124, v125
    v_cvt_pk_bf16_f32 v157, v126, v127
    v_mfma_f32_16x16x32_bf16 v[60:63], a[128:131], v[164:167], v[60:63]
    v_cvt_pk_bf16_f32 v158, v132, v133
    v_cvt_pk_bf16_f32 v159, v134, v135
    v_mfma_f32_16x16x32_bf16 v[64:67], a[132:135], v[160:163], v[64:67]
    v_mul_f32 v120, v120, v168
    v_mul_f32 v121, v121, v169
    v_mfma_f32_16x16x32_bf16 v[68:71], a[132:135], v[164:167], v[68:71]
    v_mul_f32 v122, v122, v170
    v_mul_f32 v123, v123, v171
    v_mfma_f32_16x16x32_bf16 v[72:75], a[136:139], v[160:163], v[72:75]
    v_mul_f32 v128, v128, v172
    v_mul_f32 v129, v129, v173
    v_mfma_f32_16x16x32_bf16 v[76:79], a[136:139], v[164:167], v[76:79]
    v_mul_f32 v130, v130, v174
    v_mul_f32 v131, v131, v175
    v_mfma_f32_16x16x32_bf16 v[80:83], a[140:143], v[160:163], v[80:83]
    s_cmp_lg_u32 s67, 0
    s_cbranch_scc0 kb_nd6
    v_fmac_f32 v120, v176, v36
    v_fmac_f32 v121, v177, v36
    v_fmac_f32 v122, v178, v36
    v_fmac_f32 v123, v179, v36
    v_fmac_f32 v128, v180, v36
    v_fmac_f32 v129, v181, v36
    v_fmac_f32 v130, v182, v36
    v_fmac_f32 v131, v183, v36
kb_nd6:
    v_cvt_pk_bf16_f32 v152, v120, v121
    v_mfma_f32_16x16x32_bf16 v[84:87], a[140:143], v[164:167], v[84:87]
    v_cvt_pk_bf16_f32 v153, v122, v123
    v_cvt_pk_bf16_f32 v154, v128, v129
    v_cvt_pk_bf16_f32 v155, v130, v131
    s_waitcnt lgkmcnt(0)
    v_mfma_f32_16x16x32_bf16 v[136:139], v[104:107], v[20:23], 0
    ds_read_b64_tr_b16 v[88:89], v8 offset:512
    ds_read_b64_tr_b16 v[90:91], v8 offset:18944
    v_mfma_f32_16x16x32_bf16 v[140:143], v[104:107], v[24:27], 0
    ds_read_b64_tr_b16 v[92:93], v8 offset:37376
    ds_read_b64_tr_b16 v[94:95], v8 offset:55808
    v_mfma_f32_16x16x32_bf16 v[144:147], v[112:115], v[20:23], 0
    ds_read_b64_tr_b16 v[96:97], v9 offset:512
    ds_read_b64_tr_b16 v[98:99], v9 offset:18944
    v_mfma_f32_16x16x32_bf16 v[148:151], v[112:115], v[24:27], 0
    ds_read_b64_tr_b16 v[100:101], v9 offset:37376
    ds_read_b64_tr_b16 v[102:103], v9 offset:55808
    v_mfma_f32_16x16x32_bf16 v[136:139], v[108:111], v[28:31], v[136:139]
    ds_read_b128 v[168:171], v18 offset:3328
    ds_read_b128 v[176:179], v18 offset:1024
    v_mfma_f32_16x16x32_bf16 v[140:143], v[108:111], v[32:35], v[140:143]
    ds_read_b128 v[172:175], v18 offset:3344
    ds_read_b128 v[180:183], v18 offset:1040
    v_mfma_f32_16x16x32_bf16 v[144:147], v[116:119], v[28:31], v[144:147]
    s_add_u32 m0, s40, 36864
    s_nop 0
    buffer_load_dwordx4 v224, s[8:11], s12 offen lds
    s_add_u32 m0, s40, 37888
    s_nop 0
    buffer_load_dwordx4 v225, s[8:11], s12 offen lds
    v_mfma_f32_16x16x32_bf16 v[148:151], v[116:119], v[32:35], v[148:151]
    s_add_u32 m0, s40, 38912
    s_nop 0
    buffer_load_dwordx4 v226, s[8:11], s12 offen lds
    s_add_u32 m0, s40, 39936
    s_nop 0
    buffer_load_dwordx4 v227, s[8:11], s12 offen lds
    s_add_u32 m0, s40, 40960
    s_nop 0
    buffer_load_dwordx4 v228, s[8:11], s12 offen lds
    s_add_u32 m0, s40, 41984
    s_nop 0
    buffer_load_dwordx4 v229, s[8:11], s12 offen lds
    s_add_u32 m0, s40, 43008
    s_nop 0
    buffer_load_dwordx4 v230, s[8:11], s12 offen lds
    s_add_u32 m0, s40, 44032
    s_nop 0
    buffer_load_dwordx4 v231, s[8:11], s12 offen lds
    s_add_u32 m0, s40, 45056
    s_nop 0
    buffer_load_dwordx4 v232, s[8:11], s12 offen lds
    s_waitcnt vmcnt(24)
    v_mfma_f32_16x16x32_bf16 v[40:43], a[144:147], v[152:155], v[40:43]
    v_mul_f32 v140, v140, v184
    v_mul_f32 v141, v141, v185
    v_mfma_f32_16x16x32_bf16 v[44:47], a[144:147], v[156:159], v[44:47]
    v_mul_f32 v142, v142, v186
    v_mul_f32 v143, v143, v187
    v_mfma_f32_16x16x32_bf16 v[48:51], a[148:151], v[152:155], v[48:51]
    v_mul_f32 v148, v148, v188
    v_mul_f32 v149, v149, v189
    v_mfma_f32_16x16x32_bf16 v[52:55], a[148:151], v[156:159], v[52:55]
    v_mul_f32 v150, v150, v190
    v_mul_f32 v151, v151, v191
    v_mfma_f32_16x16x32_bf16 v[56:59], a[152:155], v[152:155], v[56:59]
    v_cvt_pk_bf16_f32 v164, v140, v141
    v_cvt_pk_bf16_f32 v165, v142, v143
    v_mfma_f32_16x16x32_bf16 v[60:63], a[152:155], v[156:159], v[60:63]
    v_cvt_pk_bf16_f32 v166, v148, v149
    v_cvt_pk_bf16_f32 v167, v150, v151
    v_mfma_f32_16x16x32_bf16 v[64:67], a[156:159], v[152:155], v[64:67]
    v_mul_f32 v136, v136, v184
    v_mul_f32 v137, v137, v185
    v_mfma_f32_16x16x32_bf16 v[68:71], a[156:159], v[156:159], v[68:71]
    v_mul_f32 v138, v138, v186
    v_mul_f32 v139, v139, v187
    v_mfma_f32_16x16x32_bf16 v[72:75], a[160:163], v[152:155], v[72:75]
    v_mul_f32 v144, v144, v188
    v_mul_f32 v145, v145, v189
    v_mfma_f32_16x16x32_bf16 v[76:79], a[160:163], v[156:159], v[76:79]
    v_mul_f32 v146, v146, v190
    v_mul_f32 v147, v147, v191
    v_mfma_f32_16x16x32_bf16 v[80:83], a[164:167], v[152:155], v[80:83]
    s_cmp_lg_u32 s67, 0
    s_cbranch_scc0 kb_nd7
    v_fmac_f32 v136, v192, v36
    v_fmac_f32 v137, v193, v36
    v_fmac_f32 v138, v194, v36
    v_fmac_f32 v139, v195, v36
    v_fmac_f32 v144, v196, v36
    v_fmac_f32 v145, v197, v36
    v_fmac_f32 v146, v198, v36
    v_fmac_f32 v147, v199, v36
kb_nd7:
    v_cvt_pk_bf16_f32 v160, v136, v137
    v_mfma_f32_16x16x32_bf16 v[84:87], a[164:167], v[156:159], v[84:87]
    v_cvt_pk_bf16_f32 v161, v138, v139
    v_cvt_pk_bf16_f32 v162, v144, v145
    v_cvt_pk_bf16_f32 v163, v146, v147
    s_waitcnt lgkmcnt(0)
    v_mfma_f32_16x16x32_bf16 v[120:123], v[88:91], v[20:23], 0
    v_mfma_f32_16x16x32_bf16 v[124:127], v[88:91], v[24:27], 0
    v_mfma_f32_16x16x32_bf16 v[128:131], v[96:99], v[20:23], 0
    v_mfma_f32_16x16x32_bf16 v[132:135], v[96:99], v[24:27], 0
    v_mfma_f32_16x16x32_bf16 v[120:123], v[92:95], v[28:31], v[120:123]
    v_mfma_f32_16x16x32_bf16 v[124:127], v[92:95], v[32:35], v[124:127]
    v_mfma_f32_16x16x32_bf16 v[128:131], v[100:103], v[28:31], v[128:131]
    v_mfma_f32_16x16x32_bf16 v[132:135], v[100:103], v[32:35], v[132:135]
    s_barrier
    s_waitcnt vmcnt(18)
    v_mfma_f32_16x16x32_bf16 v[40:43], a[168:171], v[160:163], v[40:43]
    s_nop 2
    v_mul_f32 v124, v124, v168
    v_mul_f32 v125, v125, v169
    v_mfma_f32_16x16x32_bf16 v[44:47], a[168:171], v[164:167], v[44:47]
    v_mul_f32 v126, v126, v170
    v_mul_f32 v127, v127, v171
    v_mfma_f32_16x16x32_bf16 v[48:51], a[172:175], v[160:163], v[48:51]
    v_mul_f32 v132, v132, v172
    v_mul_f32 v133, v133, v173
    v_mfma_f32_16x16x32_bf16 v[52:55], a[172:175], v[164:167], v[52:55]
    v_mul_f32 v134, v134, v174
    v_mul_f32 v135, v135, v175
    v_mfma_f32_16x16x32_bf16 v[56:59], a[176:179], v[160:163], v[56:59]
    v_cvt_pk_bf16_f32 v156, v124, v125
    v_cvt_pk_bf16_f32 v157, v126, v127
    v_mfma_f32_16x16x32_bf16 v[60:63], a[176:179], v[164:167], v[60:63]
    v_cvt_pk_bf16_f32 v158, v132, v133
    v_cvt_pk_bf16_f32 v159, v134, v135
    v_mfma_f32_16x16x32_bf16 v[64:67], a[180:183], v[160:163], v[64:67]
    v_mul_f32 v120, v120, v168
    v_mul_f32 v121, v121, v169
    v_mfma_f32_16x16x32_bf16 v[68:71], a[180:183], v[164:167], v[68:71]
    v_mul_f32 v122, v122, v170
    v_mul_f32 v123, v123, v171
    v_mfma_f32_16x16x32_bf16 v[72:75], a[184:187], v[160:163], v[72:75]
    v_mul_f32 v128, v128, v172
    v_mul_f32 v129, v129, v173
    v_mfma_f32_16x16x32_bf16 v[76:79], a[184:187], v[164:167], v[76:79]
    v_mul_f32 v130, v130, v174
    v_mul_f32 v131, v131, v175
    v_mfma_f32_16x16x32_bf16 v[80:83], a[188:191], v[160:163], v[80:83]
    s_cmp_lg_u32 s67, 0
    s_cbranch_scc0 kb_nd8
    v_fmac_f32 v120, v176, v36
    v_fmac_f32 v121, v177, v36
    v_fmac_f32 v122, v178, v36
    v_fmac_f32 v123, v179, v36
    v_fmac_f32 v128, v180, v36
    v_fmac_f32 v129, v181, v36
    v_fmac_f32 v130, v182, v36
    v_fmac_f32 v131, v183, v36
kb_nd8:
    v_cvt_pk_bf16_f32 v152, v120, v121
    v_mfma_f32_16x16x32_bf16 v[84:87], a[188:191], v[164:167], v[84:87]
    v_cvt_pk_bf16_f32 v153, v122, v123
    v_cvt_pk_bf16_f32 v154, v128, v129
    v_cvt_pk_bf16_f32 v155, v130, v131
    s_waitcnt vmcnt(12)
    s_nop 0
    v_mfma_f32_16x16x32_bf16 v[40:43], a[192:195], v[152:155], v[40:43]
    ds_read_b128 v[168:171], v2 offset:4608
    ds_read_b128 v[192:195], v2 offset:9216
    v_mfma_f32_16x16x32_bf16 v[44:47], a[192:195], v[156:159], v[44:47]
    ds_read_b128 v[172:175], v2 offset:4672
    ds_read_b128 v[196:199], v2 offset:9280
    v_mfma_f32_16x16x32_bf16 v[48:51], a[196:199], v[152:155], v[48:51]
    ds_read_b128 v[176:179], v2 offset:4736
    ds_read_b128 v[200:203], v2 offset:9344
    v_mfma_f32_16x16x32_bf16 v[52:55], a[196:199], v[156:159], v[52:55]
    ds_read_b128 v[180:183], v2 offset:4800
    ds_read_b128 v[204:207], v2 offset:9408
    v_mfma_f32_16x16x32_bf16 v[56:59], a[200:203], v[152:155], v[56:59]
    ds_read_b128 v[184:187], v2 offset:4864
    ds_read_b128 v[208:211], v2 offset:9472
    v_mfma_f32_16x16x32_bf16 v[60:63], a[200:203], v[156:159], v[60:63]
    ds_read_b128 v[188:191], v2 offset:4928
    ds_read_b128 v[212:215], v2 offset:9536
    v_mfma_f32_16x16x32_bf16 v[64:67], a[204:207], v[152:155], v[64:67]
    v_mov_b32 v12, s48
    v_mov_b32 v17, v244
    v_mfma_f32_16x16x32_bf16 v[68:71], a[204:207], v[156:159], v[68:71]
    v_mov_b32 v9, v245
    v_mov_b32 v18, 0
    v_mfma_f32_16x16x32_bf16 v[72:75], a[208:211], v[152:155], v[72:75]
    v_mov_b32 v19, 0
    s_add_u32 s36, s14, 4784128
    v_mfma_f32_16x16x32_bf16 v[76:79], a[208:211], v[156:159], v[76:79]
    s_addc_u32 s37, s15, 0
    s_and_b32 s37, s37, 0xffff
    v_mfma_f32_16x16x32_bf16 v[80:83], a[212:215], v[152:155], v[80:83]
    s_mov_b32 s38, 2359296
    s_mov_b32 s39, 0x20000
    v_mfma_f32_16x16x32_bf16 v[84:87], a[212:215], v[156:159], v[84:87]
    s_add_u32 s44, s14, 7143424
    s_addc_u32 s45, s15, 0
    s_and_b32 s45, s45, 0xffff
    s_mov_b32 s46, 131072
    s_mov_b32 s47, 0x20000
    s_add_u32 s52, s14, 61575168
    s_addc_u32 s53, s15, 0
    s_and_b32 s53, s53, 0xffff
    s_mov_b32 s54, 84992
    s_mov_b32 s55, 0x20000
    ds_write_b128 v39, v[40:43] offset:0
    ds_write_b128 v39, v[44:47] offset:1024
    ds_write_b128 v39, v[48:51] offset:2048
    ds_write_b128 v39, v[52:55] offset:3072
    ds_write_b128 v39, v[56:59] offset:4096
    ds_write_b128 v39, v[60:63] offset:5120
    ds_write_b128 v39, v[64:67] offset:6144
    ds_write_b128 v39, v[68:71] offset:7168
    ds_write_b128 v39, v[72:75] offset:8192
    ds_write_b128 v39, v[76:79] offset:9216
    ds_write_b128 v39, v[80:83] offset:10240
    ds_write_b128 v39, v[84:87] offset:11264
    s_waitcnt vmcnt(0)
    ds_read_b64 v[232:233], v38 offset:0
    ds_read_b64 v[234:235], v38 offset:32
    ds_read_b64 v[236:237], v38 offset:64
    ds_read_b64 v[238:239], v38 offset:96
    ds_read_b64 v[240:241], v38 offset:128
    ds_read_b64 v[242:243], v38 offset:160
    s_waitcnt lgkmcnt(6)
    s_barrier
    s_cmp_lg_u32 s83, 0x70000000
    s_cbranch_scc0 kb_fin
    ds_read_b128 v[40:43], v9 offset:0
    ds_read_b128 v[64:67], v9 offset:12288
    ds_read_b128 v[88:91], v9 offset:24576
    ds_read_b128 v[112:115], v9 offset:36864
    ds_read_b128 v[44:47], v9 offset:2048
    ds_read_b128 v[68:71], v9 offset:14336
    ds_read_b128 v[92:95], v9 offset:26624
    ds_read_b128 v[116:119], v9 offset:38912
    ds_read_b128 v[48:51], v9 offset:4096
    ds_read_b128 v[72:75], v9 offset:16384
    ds_read_b128 v[96:99], v9 offset:28672
    ds_read_b128 v[120:123], v9 offset:40960
    ds_read_b128 v[52:55], v9 offset:6144
    ds_read_b128 v[76:79], v9 offset:18432
    ds_read_b128 v[100:103], v9 offset:30720
    ds_read_b128 v[124:127], v9 offset:43008
    ds_read_b128 v[56:59], v9 offset:8192
    ds_read_b128 v[80:83], v9 offset:20480
    ds_read_b128 v[104:107], v9 offset:32768
    ds_read_b128 v[128:131], v9 offset:45056
    ds_read_b128 v[60:63], v9 offset:10240
    ds_read_b128 v[84:87], v9 offset:22528
    ds_read_b128 v[108:111], v9 offset:34816
    ds_read_b128 v[132:135], v9 offset:47104
    s_waitcnt lgkmcnt(15)
    v_pk_add_f32 v[40:41], v[40:41], v[64:65]
    v_pk_add_f32 v[88:89], v[88:89], v[112:113]
    v_lshlrev_b32 v20, 16, v232
    v_pk_fma_f32 v[40:41], v[88:89], v[12:13], v[40:41] op_sel_hi:[1,0,1]
    v_and_b32 v21, s81, v232
    v_pk_fma_f32 v[40:41], v[40:41], v[168:169], v[20:21]
    v_cvt_pk_bf16_f32 v232, v40, v41
    v_lshlrev_b32 v22, 16, v232
    v_and_b32 v23, s81, v232
    v_dot2_f32_bf16 v18, v232, s82, v18
    v_dot2_f32_bf16 v19, v232, v232, v19
    v_pk_mul_f32 v[22:23], v[22:23], v[192:193]
    v_cvt_pk_bf16_f32 v24, v22, v23
    v_pk_add_f32 v[42:43], v[42:43], v[66:67]
    v_pk_add_f32 v[90:91], v[90:91], v[114:115]
    v_lshlrev_b32 v20, 16, v233
    v_pk_fma_f32 v[42:43], v[90:91], v[12:13], v[42:43] op_sel_hi:[1,0,1]
    v_and_b32 v21, s81, v233
    v_pk_fma_f32 v[42:43], v[42:43], v[170:171], v[20:21]
    v_cvt_pk_bf16_f32 v233, v42, v43
    v_lshlrev_b32 v22, 16, v233
    v_and_b32 v23, s81, v233
    v_dot2_f32_bf16 v18, v233, s82, v18
    v_dot2_f32_bf16 v19, v233, v233, v19
    v_pk_mul_f32 v[22:23], v[22:23], v[194:195]
    v_cvt_pk_bf16_f32 v25, v22, v23
    s_waitcnt lgkmcnt(15)
    v_pk_add_f32 v[44:45], v[44:45], v[68:69]
    v_pk_add_f32 v[92:93], v[92:93], v[116:117]
    v_lshlrev_b32 v20, 16, v234
    v_pk_fma_f32 v[44:45], v[92:93], v[12:13], v[44:45] op_sel_hi:[1,0,1]
    v_and_b32 v21, s81, v234
    v_pk_fma_f32 v[44:45], v[44:45], v[172:173], v[20:21]
    v_cvt_pk_bf16_f32 v234, v44, v45
    v_lshlrev_b32 v22, 16, v234
    v_and_b32 v23, s81, v234
    v_dot2_f32_bf16 v18, v234, s82, v18
    v_dot2_f32_bf16 v19, v234, v234, v19
    v_pk_mul_f32 v[22:23], v[22:23], v[196:197]
    v_cvt_pk_bf16_f32 v26, v22, v23
    v_pk_add_f32 v[46:47], v[46:47], v[70:71]
    v_pk_add_f32 v[94:95], v[94:95], v[118:119]
    v_lshlrev_b32 v20, 16, v235
    v_pk_fma_f32 v[46:47], v[94:95], v[12:13], v[46:47] op_sel_hi:[1,0,1]
    v_and_b32 v21, s81, v235
    v_pk_fma_f32 v[46:47], v[46:47], v[174:175], v[20:21]
    v_cvt_pk_bf16_f32 v235, v46, v47
    v_lshlrev_b32 v22, 16, v235
    v_and_b32 v23, s81, v235
    v_dot2_f32_bf16 v18, v235, s82, v18
    v_dot2_f32_bf16 v19, v235, v235, v19
    v_pk_mul_f32 v[22:23], v[22:23], v[198:199]
    v_cvt_pk_bf16_f32 v27, v22, v23
    buffer_store_dwordx4 v[24:27], v15, s[36:39], s79 offen offset:0 sc1
    s_waitcnt lgkmcnt(12)
    v_pk_add_f32 v[48:49], v[48:49], v[72:73]
    v_pk_add_f32 v[96:97], v[96:97], v[120:121]
    v_lshlrev_b32 v20, 16, v236
    v_pk_fma_f32 v[48:49], v[96:97], v[12:13], v[48:49] op_sel_hi:[1,0,1]
    v_and_b32 v21, s81, v236
    v_pk_fma_f32 v[48:49], v[48:49], v[176:177], v[20:21]
    v_cvt_pk_bf16_f32 v236, v48, v49
    v_lshlrev_b32 v22, 16, v236
    v_and_b32 v23, s81, v236
    v_dot2_f32_bf16 v18, v236, s82, v18
    v_dot2_f32_bf16 v19, v236, v236, v19
    v_pk_mul_f32 v[22:23], v[22:23], v[200:201]
    v_cvt_pk_bf16_f32 v28, v22, v23
    v_pk_add_f32 v[50:51], v[50:51], v[74:75]
    v_pk_add_f32 v[98:99], v[98:99], v[122:123]
    v_lshlrev_b32 v20, 16, v237
    v_pk_fma_f32 v[50:51], v[98:99], v[12:13], v[50:51] op_sel_hi:[1,0,1]
    v_and_b32 v21, s81, v237
    v_pk_fma_f32 v[50:51], v[50:51], v[178:179], v[20:21]
    v_cvt_pk_bf16_f32 v237, v50, v51
    v_lshlrev_b32 v22, 16, v237
    v_and_b32 v23, s81, v237
    v_dot2_f32_bf16 v18, v237, s82, v18
    v_dot2_f32_bf16 v19, v237, v237, v19
    v_pk_mul_f32 v[22:23], v[22:23], v[202:203]
    v_cvt_pk_bf16_f32 v29, v22, v23
    s_waitcnt lgkmcnt(8)
    v_pk_add_f32 v[52:53], v[52:53], v[76:77]
    v_pk_add_f32 v[100:101], v[100:101], v[124:125]
    v_lshlrev_b32 v20, 16, v238
    v_pk_fma_f32 v[52:53], v[100:101], v[12:13], v[52:53] op_sel_hi:[1,0,1]
    v_and_b32 v21, s81, v238
    v_pk_fma_f32 v[52:53], v[52:53], v[180:181], v[20:21]
    v_cvt_pk_bf16_f32 v238, v52, v53
    v_lshlrev_b32 v22, 16, v238
    v_and_b32 v23, s81, v238
    v_dot2_f32_bf16 v18, v238, s82, v18
    v_dot2_f32_bf16 v19, v238, v238, v19
    v_pk_mul_f32 v[22:23], v[22:23], v[204:205]
    v_cvt_pk_bf16_f32 v30, v22, v23
    v_pk_add_f32 v[54:55], v[54:55], v[78:79]
    v_pk_add_f32 v[102:103], v[102:103], v[126:127]
    v_lshlrev_b32 v20, 16, v239
    v_pk_fma_f32 v[54:55], v[102:103], v[12:13], v[54:55] op_sel_hi:[1,0,1]
    v_and_b32 v21, s81, v239
    v_pk_fma_f32 v[54:55], v[54:55], v[182:183], v[20:21]
    v_cvt_pk_bf16_f32 v239, v54, v55
    v_lshlrev_b32 v22, 16, v239
    v_and_b32 v23, s81, v239
    v_dot2_f32_bf16 v18, v239, s82, v18
    v_dot2_f32_bf16 v19, v239, v239, v19
    v_pk_mul_f32 v[22:23], v[22:23], v[206:207]
    v_cvt_pk_bf16_f32 v31, v22, v23
    buffer_store_dwordx4 v[28:31], v15, s[36:39], s79 offen offset:1024 sc1
    s_waitcnt lgkmcnt(4)
    v_pk_add_f32 v[56:57], v[56:57], v[80:81]
    v_pk_add_f32 v[104:105], v[104:105], v[128:129]
    v_lshlrev_b32 v20, 16, v240
    v_pk_fma_f32 v[56:57], v[104:105], v[12:13], v[56:57] op_sel_hi:[1,0,1]
    v_and_b32 v21, s81, v240
    v_pk_fma_f32 v[56:57], v[56:57], v[184:185], v[20:21]
    v_cvt_pk_bf16_f32 v240, v56, v57
    v_lshlrev_b32 v22, 16, v240
    v_and_b32 v23, s81, v240
    v_dot2_f32_bf16 v18, v240, s82, v18
    v_dot2_f32_bf16 v19, v240, v240, v19
    v_pk_mul_f32 v[22:23], v[22:23], v[208:209]
    v_cvt_pk_bf16_f32 v32, v22, v23
    v_pk_add_f32 v[58:59], v[58:59], v[82:83]
    v_pk_add_f32 v[106:107], v[106:107], v[130:131]
    v_lshlrev_b32 v20, 16, v241
    v_pk_fma_f32 v[58:59], v[106:107], v[12:13], v[58:59] op_sel_hi:[1,0,1]
    v_and_b32 v21, s81, v241
    v_pk_fma_f32 v[58:59], v[58:59], v[186:187], v[20:21]
    v_cvt_pk_bf16_f32 v241, v58, v59
    v_lshlrev_b32 v22, 16, v241
    v_and_b32 v23, s81, v241
    v_dot2_f32_bf16 v18, v241, s82, v18
    v_dot2_f32_bf16 v19, v241, v241, v19
    v_pk_mul_f32 v[22:23], v[22:23], v[210:211]
    v_cvt_pk_bf16_f32 v33, v22, v23
    s_waitcnt lgkmcnt(0)
    v_pk_add_f32 v[60:61], v[60:61], v[84:85]
    v_pk_add_f32 v[108:109], v[108:109], v[132:133]
    v_lshlrev_b32 v20, 16, v242
    v_pk_fma_f32 v[60:61], v[108:109], v[12:13], v[60:61] op_sel_hi:[1,0,1]
    v_and_b32 v21, s81, v242
    v_pk_fma_f32 v[60:61], v[60:61], v[188:189], v[20:21]
    v_cvt_pk_bf16_f32 v242, v60, v61
    v_lshlrev_b32 v22, 16, v242
    v_and_b32 v23, s81, v242
    v_dot2_f32_bf16 v18, v242, s82, v18
    v_dot2_f32_bf16 v19, v242, v242, v19
    v_pk_mul_f32 v[22:23], v[22:23], v[212:213]
    v_cvt_pk_bf16_f32 v34, v22, v23
    v_pk_add_f32 v[62:63], v[62:63], v[86:87]
    v_pk_add_f32 v[110:111], v[110:111], v[134:135]
    v_lshlrev_b32 v20, 16, v243
    v_pk_fma_f32 v[62:63], v[110:111], v[12:13], v[62:63] op_sel_hi:[1,0,1]
    v_and_b32 v21, s81, v243
    v_pk_fma_f32 v[62:63], v[62:63], v[190:191], v[20:21]
    v_cvt_pk_bf16_f32 v243, v62, v63
    v_lshlrev_b32 v22, 16, v243
    v_and_b32 v23, s81, v243
    v_dot2_f32_bf16 v18, v243, s82, v18
    v_dot2_f32_bf16 v19, v243, v243, v19
    v_pk_mul_f32 v[22:23], v[22:23], v[214:215]
    v_cvt_pk_bf16_f32 v35, v22, v23
    buffer_store_dwordx4 v[32:35], v15, s[36:39], s79 offen offset:2048 sc1
    v_mov_b32 v20, v18
    v_mov_b32 v21, v19
    s_nop 0
    v_permlane16_swap_b32 v18, v20
    v_permlane16_swap_b32 v19, v21
    v_add_f32 v18, v18, v20
    v_add_f32 v19, v19, v21
    v_mov_b32 v20, v18
    v_mov_b32 v21, v19
    s_nop 0
    v_permlane32_swap_b32 v18, v20
    v_permlane32_swap_b32 v19, v21
    v_add_f32 v18, v18, v20
    v_add_f32 v19, v19, v21
    v_cmp_gt_u32 vcc, 16, v1
    s_nop 0
    s_and_saveexec_b64 s[48:49], vcc
    buffer_store_dwordx2 v[18:19], v17, s[44:47], s80 offen sc1
    s_mov_b64 exec, s[48:49]
kb_fin:
    ds_read_b64_tr_b16 a[144:145], v6 offset:0
    ds_read_b64_tr_b16 a[146:147], v6 offset:9216
    ds_read_b64_tr_b16 a[148:149], v6 offset:32
    ds_read_b64_tr_b16 a[150:151], v6 offset:9248
    ds_read_b64_tr_b16 a[152:153], v6 offset:64
    ds_read_b64_tr_b16 a[154:155], v6 offset:9280
    ds_read_b64_tr_b16 a[156:157], v6 offset:96
    ds_read_b64_tr_b16 a[158:159], v6 offset:9312
    ds_read_b64_tr_b16 a[160:161], v6 offset:128
    ds_read_b64_tr_b16 a[162:163], v6 offset:9344
    ds_read_b64_tr_b16 a[164:165], v6 offset:160
    ds_read_b64_tr_b16 a[166:167], v6 offset:9376
    ds_read_b64_tr_b16 a[168:169], v6 offset:192
    ds_read_b64_tr_b16 a[170:171], v6 offset:9408
    ds_read_b64_tr_b16 a[172:173], v6 offset:224
    ds_read_b64_tr_b16 a[174:175], v6 offset:9440
    ds_read_b64_tr_b16 a[176:177], v6 offset:256
    ds_read_b64_tr_b16 a[178:179], v6 offset:9472
    s_and_b32 s57, s13, 7
    s_lshl_b32 s57, s57, 1
    s_add_u32 s57, s57, s69
    s_lshr_b32 s58, s13, 3
    s_lshl_b32 s58, s58, 1
    s_add_u32 s58, s58, s68
    s_lshl_b32 s3, s57, 6
    s_add_u32 s3, s3, s58
    s_lshl_b32 s3, s3, 2
    s_add_u32 s3, s3, 73984
    s_mul_i32 s57, s57, 331776
    s_add_u32 s57, s57, 5308416
    s_cmp_lt_u32 s13, 144
    s_cselect_b32 s57, s57, 0x70000000
    s_cselect_b32 s3, s3, 0x70000000
    s_bfe_u32 s59, s13, 0x20001
    s_lshl_b32 s60, s59, 1
    s_add_u32 s60, s60, 2
    s_cmp_eq_u32 s59, 3
    s_cselect_b32 s60, 0, s60
    s_mul_i32 s61, s58, 57
    s_lshr_b32 s61, s61, 9
    s_mul_i32 s62, s61, 9
    s_sub_u32 s62, s58, s62
    s_and_b32 s63, s13, 1
    s_lshl_b32 s63, s63, 1
    s_add_u32 s63, s63, s69
    s_sub_u32 s61, s61, s63
    s_and_b32 s61, s61, 3
    s_cmp_lt_u32 s62, 4
    s_cselect_b32 s63, 4, 3
    s_cselect_b32 s64, 9, 17
    s_cmp_lt_u32 s62, 7
    s_cselect_b32 s63, s63, 2
    s_cselect_b32 s64, s64, 23
    s_sub_u32 s65, s61, 1
    s_mul_i32 s65, s65, s63
    s_add_u32 s64, s64, s65
    s_cmp_eq_u32 s61, 0
    s_cselect_b32 s64, 0, s64
    s_add_u32 s64, s64, s62
    s_mul_i32 s65, s64, 7
    s_add_u32 s66, s64, 156
    s_cmp_lt_u32 s64, 26
    s_cselect_b32 s65, s65, s66
    s_cselect_b32 s66, 1, 10
    s_lshl_b32 s64, s64, 1
    s_add_u32 s64, s64, 245
    s_waitcnt lgkmcnt(0)
    s_barrier
    s_add_u32 s8, s14, 50741248
    s_addc_u32 s9, s15, 0
    s_and_b32 s9, s9, 0xffff
    s_mov_b32 s10, 10616832
    s_mov_b32 s11, 0x20000
    s_and_b32 s76, s2, 6
    s_lshl_b32 s76, s76, 1
    s_bfe_u32 s77, s2, 0x20003
    s_add_u32 s76, s76, s77
    s_mul_i32 s76, s76, 331776
    s_mul_i32 s77, s24, 9216
    s_add_u32 s76, s76, s77
    v_lshlrev_b32 v3, 4, v1
    s_add_u32 s78, s76, 0
    s_add_u32 m0, s77, 0
    s_nop 0
    buffer_load_dwordx4 v3, s[8:11], s78 offen offset:0 lds
    buffer_load_dwordx4 v3, s[8:11], s78 offen offset:1024 lds
    buffer_load_dwordx4 v3, s[8:11], s78 offen offset:2048 lds
    buffer_load_dwordx4 v3, s[8:11], s78 offen offset:3072 lds
    s_add_u32 s78, s76, 4096
    s_add_u32 m0, s77, 4096
    s_nop 0
    buffer_load_dwordx4 v3, s[8:11], s78 offen offset:0 lds
    buffer_load_dwordx4 v3, s[8:11], s78 offen offset:1024 lds
    buffer_load_dwordx4 v3, s[8:11], s78 offen offset:2048 lds
    buffer_load_dwordx4 v3, s[8:11], s78 offen offset:3072 lds
    s_add_u32 s78, s76, 8192
    s_add_u32 m0, s77, 8192
    s_nop 0
    buffer_load_dwordx4 v3, s[8:11], s78 offen offset:0 lds
    s_add_u32 s78, s76, 36864
    s_add_u32 m0, s77, 36864
    s_nop 0
    buffer_load_dwordx4 v3, s[8:11], s78 offen offset:0 lds
    buffer_load_dwordx4 v3, s[8:11], s78 offen offset:1024 lds
    buffer_load_dwordx4 v3, s[8:11], s78 offen offset:2048 lds
    buffer_load_dwordx4 v3, s[8:11], s78 offen offset:3072 lds
    s_add_u32 s78, s76, 40960
    s_add_u32 m0, s77, 40960
    s_nop 0
    buffer_load_dwordx4 v3, s[8:11], s78 offen offset:0 lds
    buffer_load_dwordx4 v3, s[8:11], s78 offen offset:1024 lds
    buffer_load_dwordx4 v3, s[8:11], s78 offen offset:2048 lds
    buffer_load_dwordx4 v3, s[8:11], s78 offen offset:3072 lds
    s_add_u32 s78, s76, 45056
    s_add_u32 m0, s77, 45056
    s_nop 0
    buffer_load_dwordx4 v3, s[8:11], s78 offen offset:0 lds
    v_mov_b32 v3, 1
    s_waitcnt vmcnt(18)
    buffer_store_dword v3, off, s[52:55], s83 sc1
    s_sub_u32 s63, 0, s60
    s_cselect_b32 s61, 9, 0
    s_add_u32 s63, s63, s61
    s_mul_i32 s61, s63, s66
    s_add_u32 s61, s61, s65
    s_add_u32 s62, s63, s64
    s_cmp_lt_u32 s63, 7
    s_cselect_b32 s63, s61, s62
    s_lshl_b32 s63, s63, 10
    s_add_u32 s63, s63, s57
    v_add_u32 v18, s63, v15
    s_sub_u32 s63, 1, s60
    s_cselect_b32 s61, 9, 0
    s_add_u32 s63, s63, s61
    s_mul_i32 s61, s63, s66
    s_add_u32 s61, s61, s65
    s_add_u32 s62, s63, s64
    s_cmp_lt_u32 s63, 7
    s_cselect_b32 s63, s61, s62
    s_lshl_b32 s63, s63, 10
    s_add_u32 s63, s63, s57
    v_add_u32 v19, s63, v15
    s_sub_u32 s63, 2, s60
    s_cselect_b32 s61, 9, 0
    s_add_u32 s63, s63, s61
    s_mul_i32 s61, s63, s66
    s_add_u32 s61, s61, s65
    s_add_u32 s62, s63, s64
    s_cmp_lt_u32 s63, 7
    s_cselect_b32 s63, s61, s62
    s_lshl_b32 s63, s63, 10
    s_add_u32 s63, s63, s57
    v_add_u32 v20, s63, v15
    s_sub_u32 s63, 3, s60
    s_cselect_b32 s61, 9, 0
    s_add_u32 s63, s63, s61
    s_mul_i32 s61, s63, s66
    s_add_u32 s61, s61, s65
    s_add_u32 s62, s63, s64
    s_cmp_lt_u32 s63, 7
    s_cselect_b32 s63, s61, s62
    s_lshl_b32 s63, s63, 10
    s_add_u32 s63, s63, s57
    v_add_u32 v21, s63, v15
    s_sub_u32 s63, 4, s60
    s_cselect_b32 s61, 9, 0
    s_add_u32 s63, s63, s61
    s_mul_i32 s61, s63, s66
    s_add_u32 s61, s61, s65
    s_add_u32 s62, s63, s64
    s_cmp_lt_u32 s63, 7
    s_cselect_b32 s63, s61, s62
    s_lshl_b32 s63, s63, 10
    s_add_u32 s63, s63, s57
    v_add_u32 v22, s63, v15
    s_sub_u32 s63, 5, s60
    s_cselect_b32 s61, 9, 0
    s_add_u32 s63, s63, s61
    s_mul_i32 s61, s63, s66
    s_add_u32 s61, s61, s65
    s_add_u32 s62, s63, s64
    s_cmp_lt_u32 s63, 7
    s_cselect_b32 s63, s61, s62
    s_lshl_b32 s63, s63, 10
    s_add_u32 s63, s63, s57
    v_add_u32 v23, s63, v15
    s_sub_u32 s63, 6, s60
    s_cselect_b32 s61, 9, 0
    s_add_u32 s63, s63, s61
    s_mul_i32 s61, s63, s66
    s_add_u32 s61, s61, s65
    s_add_u32 s62, s63, s64
    s_cmp_lt_u32 s63, 7
    s_cselect_b32 s63, s61, s62
    s_lshl_b32 s63, s63, 10
    s_add_u32 s63, s63, s57
    v_add_u32 v24, s63, v15
    s_sub_u32 s63, 7, s60
    s_cselect_b32 s61, 9, 0
    s_add_u32 s63, s63, s61
    s_mul_i32 s61, s63, s66
    s_add_u32 s61, s61, s65
    s_add_u32 s62, s63, s64
    s_cmp_lt_u32 s63, 7
    s_cselect_b32 s63, s61, s62
    s_lshl_b32 s63, s63, 10
    s_add_u32 s63, s63, s57
    v_add_u32 v254, s63, v15
    s_sub_u32 s63, 8, s60
    s_cselect_b32 s61, 9, 0
    s_add_u32 s63, s63, s61
    s_mul_i32 s61, s63, s66
    s_add_u32 s61, s61, s65
    s_add_u32 s62, s63, s64
    s_cmp_lt_u32 s63, 7
    s_cselect_b32 s63, s61, s62
    s_lshl_b32 s63, s63, 10
    s_add_u32 s63, s63, s57
    v_add_u32 v255, s63, v15
    s_cmp_lg_u32 s83, 0x70000000
    s_cselect_b32 s100, s79, s83
    s_add_u32 s101, s83, 64
    s_branch ffn_start
kb_side:
    s_sub_u32 s25, s21, 24
    s_mul_i32 s26, s25, 7
    s_add_u32 s26, s26, s20
    s_sub_u32 s26, s26, 1
    s_sub_u32 s27, s21, 30
    s_lshl_b32 s27, s27, 3
    s_add_u32 s27, s27, s20
    s_add_u32 s27, s27, 42
    s_cmp_ge_u32 s21, 30
    s_cselect_b32 s26, s27, s26
    v_and_b32 v4, 15, v1
    v_lshrrev_b32 v5, 4, v1
    s_waitcnt lgkmcnt(0)
    s_add_u32 s36, s14, 50741248
    s_addc_u32 s37, s15, 0
    s_and_b32 s37, s37, 0xffff
    s_mov_b32 s38, 10616832
    s_mov_b32 s39, 0x20000
    s_add_u32 s40, s14, 61497344
    s_addc_u32 s41, s15, 0
    s_and_b32 s41, s41, 0xffff
    s_mov_b32 s42, 2304
    s_mov_b32 s43, 0x20000
    s_add_u32 s44, s14, 61501440
    s_addc_u32 s45, s15, 0
    s_and_b32 s45, s45, 0xffff
    s_mov_b32 s46, 73728
    s_mov_b32 s47, 0x20000
    s_add_u32 s52, s14, 61575168
    s_addc_u32 s53, s15, 0
    s_and_b32 s53, s53, 0xffff
    s_mov_b32 s54, 84992
    s_mov_b32 s55, 0x20000
    s_mov_b32 s32, s18
    s_and_b32 s33, s19, 0xffff
    s_mov_b32 s34, 5308416
    s_mov_b32 s35, 0x20000
    s_mov_b32 s3, 0x70000000
    s_mov_b32 s100, s3
    s_mov_b32 s101, s3
    s_lshl_b32 s29, s26, 2
    s_add_u32 s29, s29, s24
    s_mul_i32 s28, s29, 23552
    s_mov_b32 s6, 0xffff0000
    v_mul_u32_u24 v6, 1152, v4
    v_lshl_add_u32 v6, v5, 3, v6
    v_cmp_lt_u32 vcc, 1, v4
    v_mov_b32 v7, 0x7ffffff0
    s_nop 0
    v_cndmask_b32 v6, v6, v7, vcc
    s_add_u32 s68, s29, 0
    s_mul_i32 s30, s68, 3641
    s_lshr_b32 s30, s30, 16
    s_mul_i32 s31, s30, 18
    s_sub_u32 s31, s68, s31
    s_and_b32 s62, s30, 3
    s_mul_i32 s62, s62, 9
    s_lshr_b32 s62, s62, 1
    s_cmp_lt_u32 s31, 8
    s_cselect_b32 s63, 8, 6
    s_cselect_b32 s64, 0, 136
    s_cmp_lt_u32 s31, 14
    s_cselect_b32 s63, s63, 4
    s_cselect_b32 s64, s64, 238
    s_add_u32 s64, s64, s31
    s_mul_i32 s65, s30, 324
    s_add_u32 s64, s64, s65
    s_lshl_b32 s64, s64, 10
    s_cmp_lt_u32 s68, 288
    s_cselect_b32 s64, s64, 0x70000000
    s_lshl_b32 s63, s63, 10
    s_sub_u32 s65, 18, s62
    s_mul_i32 s65, s65, s63
    s_add_u32 s65, s65, s64
    s_mul_i32 s66, s63, 18
    s_add_u32 s66, s66, s64
    s_cmp_eq_u32 s65, s66
    s_cselect_b32 s65, s64, s65
    buffer_load_dwordx4 a[72:75], v15, s[36:39], s65 offen
    s_add_u32 s65, s65, s63
    s_cmp_eq_u32 s65, s66
    s_cselect_b32 s65, s64, s65
    buffer_load_dwordx4 a[76:79], v15, s[36:39], s65 offen
    s_add_u32 s65, s65, s63
    s_cmp_eq_u32 s65, s66
    s_cselect_b32 s65, s64, s65
    buffer_load_dwordx4 a[80:83], v15, s[36:39], s65 offen
    s_add_u32 s65, s65, s63
    s_cmp_eq_u32 s65, s66
    s_cselect_b32 s65, s64, s65
    buffer_load_dwordx4 a[84:87], v15, s[36:39], s65 offen
    s_add_u32 s65, s65, s63
    s_cmp_eq_u32 s65, s66
    s_cselect_b32 s65, s64, s65
    buffer_load_dwordx4 a[88:91], v15, s[36:39], s65 offen
    s_add_u32 s65, s65, s63
    s_cmp_eq_u32 s65, s66
    s_cselect_b32 s65, s64, s65
    buffer_load_dwordx4 a[92:95], v15, s[36:39], s65 offen
    s_add_u32 s65, s65, s63
    s_cmp_eq_u32 s65, s66
    s_cselect_b32 s65, s64, s65
    buffer_load_dwordx4 a[96:99], v15, s[36:39], s65 offen
    s_add_u32 s65, s65, s63
    s_cmp_eq_u32 s65, s66
    s_cselect_b32 s65, s64, s65
    buffer_load_dwordx4 a[100:103], v15, s[36:39], s65 offen
    s_add_u32 s65, s65, s63
    s_cmp_eq_u32 s65, s66
    s_cselect_b32 s65, s64, s65
    buffer_load_dwordx4 a[104:107], v15, s[36:39], s65 offen
    s_add_u32 s65, s65, s63
    s_cmp_eq_u32 s65, s66
    s_cselect_b32 s65, s64, s65
    buffer_load_dwordx4 a[108:111], v15, s[36:39], s65 offen
    s_add_u32 s65, s65, s63
    s_cmp_eq_u32 s65, s66
    s_cselect_b32 s65, s64, s65
    buffer_load_dwordx4 a[112:115], v15, s[36:39], s65 offen
    s_add_u32 s65, s65, s63
    s_cmp_eq_u32 s65, s66
    s_cselect_b32 s65, s64, s65
    buffer_load_dwordx4 a[116:119], v15, s[36:39], s65 offen
    s_add_u32 s65, s65, s63
    s_cmp_eq_u32 s65, s66
    s_cselect_b32 s65, s64, s65
    buffer_load_dwordx4 a[120:123], v15, s[36:39], s65 offen
    s_add_u32 s65, s65, s63
    s_cmp_eq_u32 s65, s66
    s_cselect_b32 s65, s64, s65
    buffer_load_dwordx4 a[124:127], v15, s[36:39], s65 offen
    s_add_u32 s65, s65, s63
    s_cmp_eq_u32 s65, s66
    s_cselect_b32 s65, s64, s65
    buffer_load_dwordx4 a[128:131], v15, s[36:39], s65 offen
    s_add_u32 s65, s65, s63
    s_cmp_eq_u32 s65, s66
    s_cselect_b32 s65, s64, s65
    buffer_load_dwordx4 a[132:135], v15, s[36:39], s65 offen
    s_add_u32 s65, s65, s63
    s_cmp_eq_u32 s65, s66
    s_cselect_b32 s65, s64, s65
    buffer_load_dwordx4 a[136:139], v15, s[36:39], s65 offen
    s_add_u32 s65, s65, s63
    s_cmp_eq_u32 s65, s66
    s_cselect_b32 s65, s64, s65
    buffer_load_dwordx4 a[140:143], v15, s[36:39], s65 offen
    s_add_u32 s65, s65, s63
    buffer_load_dwordx2 a[0:1], v6, s[40:43], 0 offen offset:0
    buffer_load_dwordx2 a[2:3], v6, s[40:43], 0 offen offset:32
    buffer_load_dwordx2 a[4:5], v6, s[40:43], 0 offen offset:64
    buffer_load_dwordx2 a[6:7], v6, s[40:43], 0 offen offset:96
    buffer_load_dwordx2 a[8:9], v6, s[40:43], 0 offen offset:128
    buffer_load_dwordx2 a[10:11], v6, s[40:43], 0 offen offset:160
    buffer_load_dwordx2 a[12:13], v6, s[40:43], 0 offen offset:192
    buffer_load_dwordx2 a[14:15], v6, s[40:43], 0 offen offset:224
    buffer_load_dwordx2 a[16:17], v6, s[40:43], 0 offen offset:256
    buffer_load_dwordx2 a[18:19], v6, s[40:43], 0 offen offset:288
    buffer_load_dwordx2 a[20:21], v6, s[40:43], 0 offen offset:320
    buffer_load_dwordx2 a[22:23], v6, s[40:43], 0 offen offset:352
    buffer_load_dwordx2 a[24:25], v6, s[40:43], 0 offen offset:384
    buffer_load_dwordx2 a[26:27], v6, s[40:43], 0 offen offset:416
    buffer_load_dwordx2 a[28:29], v6, s[40:43], 0 offen offset:448
    buffer_load_dwordx2 a[30:31], v6, s[40:43], 0 offen offset:480
    buffer_load_dwordx2 a[32:33], v6, s[40:43], 0 offen offset:512
    buffer_load_dwordx2 a[34:35], v6, s[40:43], 0 offen offset:544
    buffer_load_dwordx2 a[36:37], v6, s[40:43], 0 offen offset:576
    buffer_load_dwordx2 a[38:39], v6, s[40:43], 0 offen offset:608
    buffer_load_dwordx2 a[40:41], v6, s[40:43], 0 offen offset:640
    buffer_load_dwordx2 a[42:43], v6, s[40:43], 0 offen offset:672
    buffer_load_dwordx2 a[44:45], v6, s[40:43], 0 offen offset:704
    buffer_load_dwordx2 a[46:47], v6, s[40:43], 0 offen offset:736
    buffer_load_dwordx2 a[48:49], v6, s[40:43], 0 offen offset:768
    buffer_load_dwordx2 a[50:51], v6, s[40:43], 0 offen offset:800
    buffer_load_dwordx2 a[52:53], v6, s[40:43], 0 offen offset:832
    buffer_load_dwordx2 a[54:55], v6, s[40:43], 0 offen offset:864
    buffer_load_dwordx2 a[56:57], v6, s[40:43], 0 offen offset:896
    buffer_load_dwordx2 a[58:59], v6, s[40:43], 0 offen offset:928
    buffer_load_dwordx2 a[60:61], v6, s[40:43], 0 offen offset:960
    buffer_load_dwordx2 a[62:63], v6, s[40:43], 0 offen offset:992
    buffer_load_dwordx2 a[64:65], v6, s[40:43], 0 offen offset:1024
    buffer_load_dwordx2 a[66:67], v6, s[40:43], 0 offen offset:1056
    buffer_load_dwordx2 a[68:69], v6, s[40:43], 0 offen offset:1088
    buffer_load_dwordx2 a[70:71], v6, s[40:43], 0 offen offset:1120
    s_add_u32 s68, s29, 232
    s_mul_i32 s30, s68, 3641
    s_lshr_b32 s30, s30, 16
    s_mul_i32 s31, s30, 18
    s_sub_u32 s31, s68, s31
    s_and_b32 s62, s30, 3
    s_mul_i32 s62, s62, 9
    s_lshr_b32 s62, s62, 1
    s_cmp_lt_u32 s31, 8
    s_cselect_b32 s63, 8, 6
    s_cselect_b32 s64, 0, 136
    s_cmp_lt_u32 s31, 14
    s_cselect_b32 s63, s63, 4
    s_cselect_b32 s64, s64, 238
    s_add_u32 s64, s64, s31
    s_mul_i32 s65, s30, 324
    s_add_u32 s64, s64, s65
    s_lshl_b32 s64, s64, 10
    s_cmp_lt_u32 s68, 288
    s_cselect_b32 s64, s64, 0x70000000
    s_lshl_b32 s63, s63, 10
    s_sub_u32 s65, 18, s62
    s_mul_i32 s65, s65, s63
    s_add_u32 s65, s65, s64
    s_mul_i32 s66, s63, 18
    s_add_u32 s66, s66, s64
    s_cmp_eq_u32 s65, s66
    s_cselect_b32 s65, s64, s65
    buffer_load_dwordx4 a[144:147], v15, s[36:39], s65 offen
    s_add_u32 s65, s65, s63
    s_cmp_eq_u32 s65, s66
    s_cselect_b32 s65, s64, s65
    buffer_load_dwordx4 a[148:151], v15, s[36:39], s65 offen
    s_add_u32 s65, s65, s63
    s_cmp_eq_u32 s65, s66
    s_cselect_b32 s65, s64, s65
    buffer_load_dwordx4 a[152:155], v15, s[36:39], s65 offen
    s_add_u32 s65, s65, s63
    s_cmp_eq_u32 s65, s66
    s_cselect_b32 s65, s64, s65
    buffer_load_dwordx4 a[156:159], v15, s[36:39], s65 offen
    s_add_u32 s65, s65, s63
    s_cmp_eq_u32 s65, s66
    s_cselect_b32 s65, s64, s65
    buffer_load_dwordx4 a[160:163], v15, s[36:39], s65 offen
    s_add_u32 s65, s65, s63
    s_cmp_eq_u32 s65, s66
    s_cselect_b32 s65, s64, s65
    buffer_load_dwordx4 a[164:167], v15, s[36:39], s65 offen
    s_add_u32 s65, s65, s63
    s_cmp_eq_u32 s65, s66
    s_cselect_b32 s65, s64, s65
    buffer_load_dwordx4 a[168:171], v15, s[36:39], s65 offen
    s_add_u32 s65, s65, s63
    s_cmp_eq_u32 s65, s66
    s_cselect_b32 s65, s64, s65
    buffer_load_dwordx4 a[172:175], v15, s[36:39], s65 offen
    s_add_u32 s65, s65, s63
    s_cmp_eq_u32 s65, s66
    s_cselect_b32 s65, s64, s65
    buffer_load_dwordx4 a[176:179], v15, s[36:39], s65 offen
    s_add_u32 s65, s65, s63
    s_cmp_eq_u32 s65, s66
    s_cselect_b32 s65, s64, s65
    buffer_load_dwordx4 a[180:183], v15, s[36:39], s65 offen
    s_add_u32 s65, s65, s63
    s_cmp_eq_u32 s65, s66
    s_cselect_b32 s65, s64, s65
    buffer_load_dwordx4 a[184:187], v15, s[36:39], s65 offen
    s_add_u32 s65, s65, s63
    s_cmp_eq_u32 s65, s66
    s_cselect_b32 s65, s64, s65
    buffer_load_dwordx4 a[188:191], v15, s[36:39], s65 offen
    s_add_u32 s65, s65, s63
    s_cmp_eq_u32 s65, s66
    s_cselect_b32 s65, s64, s65
    buffer_load_dwordx4 a[192:195], v15, s[36:39], s65 offen
    s_add_u32 s65, s65, s63
    s_cmp_eq_u32 s65, s66
    s_cselect_b32 s65, s64, s65
    buffer_load_dwordx4 a[196:199], v15, s[36:39], s65 offen
    s_add_u32 s65, s65, s63
    s_cmp_eq_u32 s65, s66
    s_cselect_b32 s65, s64, s65
    buffer_load_dwordx4 a[200:203], v15, s[36:39], s65 offen
    s_add_u32 s65, s65, s63
    s_cmp_eq_u32 s65, s66
    s_cselect_b32 s65, s64, s65
    buffer_load_dwordx4 a[204:207], v15, s[36:39], s65 offen
    s_add_u32 s65, s65, s63
    s_cmp_eq_u32 s65, s66
    s_cselect_b32 s65, s64, s65
    buffer_load_dwordx4 a[208:211], v15, s[36:39], s65 offen
    s_add_u32 s65, s65, s63
    s_cmp_eq_u32 s65, s66
    s_cselect_b32 s65, s64, s65
    buffer_load_dwordx4 a[212:215], v15, s[36:39], s65 offen
    s_add_u32 s65, s65, s63
    buffer_load_dwordx4 v[160:163], v15, s[32:35], s28 offen offset:0
    buffer_load_dwordx4 v[164:167], v15, s[32:35], s28 offen offset:1024
    buffer_load_dwordx4 v[168:171], v15, s[32:35], s28 offen offset:2048
    buffer_load_dwordx4 v[172:175], v15, s[32:35], s28 offen offset:3072
    s_add_u32 s28, s28, 4096
    buffer_load_dwordx4 v[176:179], v15, s[32:35], s28 offen offset:0
    buffer_load_dwordx4 v[180:183], v15, s[32:35], s28 offen offset:1024
    buffer_load_dwordx4 v[184:187], v15, s[32:35], s28 offen offset:2048
    buffer_load_dwordx4 v[188:191], v15, s[32:35], s28 offen offset:3072
    s_add_u32 s28, s28, 4096
    buffer_load_dwordx4 v[192:195], v15, s[32:35], s28 offen offset:0
    buffer_load_dwordx4 v[196:199], v15, s[32:35], s28 offen offset:1024
    buffer_load_dwordx4 v[200:203], v15, s[32:35], s28 offen offset:2048
    buffer_load_dwordx4 v[204:207], v15, s[32:35], s28 offen offset:3072
    s_add_u32 s28, s28, 4096
    buffer_load_dwordx4 v[208:211], v15, s[32:35], s28 offen offset:0
    buffer_load_dwordx4 v[212:215], v15, s[32:35], s28 offen offset:1024
    buffer_load_dwordx4 v[216:219], v15, s[32:35], s28 offen offset:2048
    buffer_load_dwordx4 v[220:223], v15, s[32:35], s28 offen offset:3072
    s_add_u32 s28, s28, 4096
    buffer_load_dwordx4 v[224:227], v15, s[32:35], s28 offen offset:0
    buffer_load_dwordx4 v[228:231], v15, s[32:35], s28 offen offset:1024
    buffer_load_dwordx4 v[232:235], v15, s[32:35], s28 offen offset:2048
    buffer_load_dwordx4 v[236:239], v15, s[32:35], s28 offen offset:3072
    s_add_u32 s28, s28, 4096
    buffer_load_dwordx4 v[240:243], v15, s[32:35], s28 offen offset:0
    buffer_load_dwordx4 v[244:247], v15, s[32:35], s28 offen offset:1024
    buffer_load_dwordx4 v[248:251], v15, s[32:35], s28 offen offset:2048
    v_lshlrev_b32 v29, 6, v5
    s_waitcnt vmcnt(41)
    v_mfma_f32_16x16x32_bf16 v[20:23], a[72:75], a[0:3], 0
    v_mfma_f32_16x16x32_bf16 v[20:23], a[76:79], a[4:7], v[20:23]
    v_mfma_f32_16x16x32_bf16 v[20:23], a[80:83], a[8:11], v[20:23]
    v_mfma_f32_16x16x32_bf16 v[20:23], a[84:87], a[12:15], v[20:23]
    v_mfma_f32_16x16x32_bf16 v[20:23], a[88:91], a[16:19], v[20:23]
    v_mfma_f32_16x16x32_bf16 v[20:23], a[92:95], a[20:23], v[20:23]
    v_mfma_f32_16x16x32_bf16 v[20:23], a[96:99], a[24:27], v[20:23]
    v_mfma_f32_16x16x32_bf16 v[20:23], a[100:103], a[28:31], v[20:23]
    v_mfma_f32_16x16x32_bf16 v[20:23], a[104:107], a[32:35], v[20:23]
    v_mfma_f32_16x16x32_bf16 v[20:23], a[108:111], a[36:39], v[20:23]
    v_mfma_f32_16x16x32_bf16 v[20:23], a[112:115], a[40:43], v[20:23]
    v_mfma_f32_16x16x32_bf16 v[20:23], a[116:119], a[44:47], v[20:23]
    v_mfma_f32_16x16x32_bf16 v[20:23], a[120:123], a[48:51], v[20:23]
    v_mfma_f32_16x16x32_bf16 v[20:23], a[124:127], a[52:55], v[20:23]
    v_mfma_f32_16x16x32_bf16 v[20:23], a[128:131], a[56:59], v[20:23]
    v_mfma_f32_16x16x32_bf16 v[20:23], a[132:135], a[60:63], v[20:23]
    v_mfma_f32_16x16x32_bf16 v[20:23], a[136:139], a[64:67], v[20:23]
    v_mfma_f32_16x16x32_bf16 v[20:23], a[140:143], a[68:71], v[20:23]
    s_nop 7
    v_mov_b32_dpp v24, v20 row_shl:1 row_mask:0xf bank_mask:0xf
    v_mov_b32_dpp v25, v21 row_shl:1 row_mask:0xf bank_mask:0xf
    v_mov_b32_dpp v26, v22 row_shl:1 row_mask:0xf bank_mask:0xf
    v_mov_b32_dpp v27, v23 row_shl:1 row_mask:0xf bank_mask:0xf
    v_cvt_pk_bf16_f32 v64, v20, v20
    v_cvt_pk_bf16_f32 v28, v24, v24
    v_and_b32 v67, s6, v64
    v_and_b32 v28, s6, v28
    v_sub_f32 v67, v20, v67
    v_sub_f32 v28, v24, v28
    v_cvt_pk_bf16_f32 v65, v67, v24
    v_cvt_pk_bf16_f32 v66, v24, v28
    v_mov_b32 v67, 0
    v_cvt_pk_bf16_f32 v68, v21, v21
    v_cvt_pk_bf16_f32 v28, v25, v25
    v_and_b32 v71, s6, v68
    v_and_b32 v28, s6, v28
    v_sub_f32 v71, v21, v71
    v_sub_f32 v28, v25, v28
    v_cvt_pk_bf16_f32 v69, v71, v25
    v_cvt_pk_bf16_f32 v70, v25, v28
    v_mov_b32 v71, 0
    v_cvt_pk_bf16_f32 v72, v22, v22
    v_cvt_pk_bf16_f32 v28, v26, v26
    v_and_b32 v75, s6, v72
    v_and_b32 v28, s6, v28
    v_sub_f32 v75, v22, v75
    v_sub_f32 v28, v26, v28
    v_cvt_pk_bf16_f32 v73, v75, v26
    v_cvt_pk_bf16_f32 v74, v26, v28
    v_mov_b32 v75, 0
    v_cvt_pk_bf16_f32 v76, v23, v23
    v_cvt_pk_bf16_f32 v28, v27, v27
    v_and_b32 v79, s6, v76
    v_and_b32 v28, s6, v28
    v_sub_f32 v79, v23, v79
    v_sub_f32 v28, v27, v28
    v_cvt_pk_bf16_f32 v77, v79, v27
    v_cvt_pk_bf16_f32 v78, v27, v28
    v_mov_b32 v79, 0
    s_add_u32 s67, s29, 0
    s_lshl_b32 s67, s67, 8
    v_cmp_eq_u32 vcc, 0, v4
    s_nop 0
    s_and_saveexec_b64 s[48:49], vcc
    buffer_store_dwordx4 v[64:67], v29, s[44:47], s67 offen offset:0 sc1
    buffer_store_dwordx4 v[68:71], v29, s[44:47], s67 offen offset:16 sc1
    buffer_store_dwordx4 v[72:75], v29, s[44:47], s67 offen offset:32 sc1
    buffer_store_dwordx4 v[76:79], v29, s[44:47], s67 offen offset:48 sc1
    s_mov_b64 exec, s[48:49]
    s_waitcnt vmcnt(27)
    v_mfma_f32_16x16x32_bf16 v[20:23], a[144:147], a[0:3], 0
    v_mfma_f32_16x16x32_bf16 v[20:23], a[148:151], a[4:7], v[20:23]
    v_mfma_f32_16x16x32_bf16 v[20:23], a[152:155], a[8:11], v[20:23]
    v_mfma_f32_16x16x32_bf16 v[20:23], a[156:159], a[12:15], v[20:23]
    v_mfma_f32_16x16x32_bf16 v[20:23], a[160:163], a[16:19], v[20:23]
    v_mfma_f32_16x16x32_bf16 v[20:23], a[164:167], a[20:23], v[20:23]
    v_mfma_f32_16x16x32_bf16 v[20:23], a[168:171], a[24:27], v[20:23]
    v_mfma_f32_16x16x32_bf16 v[20:23], a[172:175], a[28:31], v[20:23]
    v_mfma_f32_16x16x32_bf16 v[20:23], a[176:179], a[32:35], v[20:23]
    v_mfma_f32_16x16x32_bf16 v[20:23], a[180:183], a[36:39], v[20:23]
    v_mfma_f32_16x16x32_bf16 v[20:23], a[184:187], a[40:43], v[20:23]
    v_mfma_f32_16x16x32_bf16 v[20:23], a[188:191], a[44:47], v[20:23]
    v_mfma_f32_16x16x32_bf16 v[20:23], a[192:195], a[48:51], v[20:23]
    v_mfma_f32_16x16x32_bf16 v[20:23], a[196:199], a[52:55], v[20:23]
    v_mfma_f32_16x16x32_bf16 v[20:23], a[200:203], a[56:59], v[20:23]
    v_mfma_f32_16x16x32_bf16 v[20:23], a[204:207], a[60:63], v[20:23]
    v_mfma_f32_16x16x32_bf16 v[20:23], a[208:211], a[64:67], v[20:23]
    v_mfma_f32_16x16x32_bf16 v[20:23], a[212:215], a[68:71], v[20:23]
    s_nop 7
    v_mov_b32_dpp v24, v20 row_shl:1 row_mask:0xf bank_mask:0xf
    v_mov_b32_dpp v25, v21 row_shl:1 row_mask:0xf bank_mask:0xf
    v_mov_b32_dpp v26, v22 row_shl:1 row_mask:0xf bank_mask:0xf
    v_mov_b32_dpp v27, v23 row_shl:1 row_mask:0xf bank_mask:0xf
    v_cvt_pk_bf16_f32 v80, v20, v20
    v_cvt_pk_bf16_f32 v28, v24, v24
    v_and_b32 v83, s6, v80
    v_and_b32 v28, s6, v28
    v_sub_f32 v83, v20, v83
    v_sub_f32 v28, v24, v28
    v_cvt_pk_bf16_f32 v81, v83, v24
    v_cvt_pk_bf16_f32 v82, v24, v28
    v_mov_b32 v83, 0
    v_cvt_pk_bf16_f32 v84, v21, v21
    v_cvt_pk_bf16_f32 v28, v25, v25
    v_and_b32 v87, s6, v84
    v_and_b32 v28, s6, v28
    v_sub_f32 v87, v21, v87
    v_sub_f32 v28, v25, v28
    v_cvt_pk_bf16_f32 v85, v87, v25
    v_cvt_pk_bf16_f32 v86, v25, v28
    v_mov_b32 v87, 0
    v_cvt_pk_bf16_f32 v88, v22, v22
    v_cvt_pk_bf16_f32 v28, v26, v26
    v_and_b32 v91, s6, v88
    v_and_b32 v28, s6, v28
    v_sub_f32 v91, v22, v91
    v_sub_f32 v28, v26, v28
    v_cvt_pk_bf16_f32 v89, v91, v26
    v_cvt_pk_bf16_f32 v90, v26, v28
    v_mov_b32 v91, 0
    v_cvt_pk_bf16_f32 v92, v23, v23
    v_cvt_pk_bf16_f32 v28, v27, v27
    v_and_b32 v95, s6, v92
    v_and_b32 v28, s6, v28
    v_sub_f32 v95, v23, v95
    v_sub_f32 v28, v27, v28
    v_cvt_pk_bf16_f32 v93, v95, v27
    v_cvt_pk_bf16_f32 v94, v27, v28
    v_mov_b32 v95, 0
    s_add_u32 s67, s29, 232
    s_lshl_b32 s67, s67, 8
    v_cmp_eq_u32 vcc, 0, v4
    s_nop 0
    s_and_saveexec_b64 s[48:49], vcc
    buffer_store_dwordx4 v[80:83], v29, s[44:47], s67 offen offset:0 sc1
    buffer_store_dwordx4 v[84:87], v29, s[44:47], s67 offen offset:16 sc1
    buffer_store_dwordx4 v[88:91], v29, s[44:47], s67 offen offset:32 sc1
    buffer_store_dwordx4 v[92:95], v29, s[44:47], s67 offen offset:48 sc1
    s_mov_b64 exec, s[48:49]
    s_add_u32 s80, s14, 50741248
    s_addc_u32 s81, s15, 0
    s_and_b32 s81, s81, 0xffff
    s_mov_b32 s82, 10616832
    s_mov_b32 s83, 0x20000
    s_and_b32 s76, s2, 6
    s_lshl_b32 s76, s76, 1
    s_bfe_u32 s77, s2, 0x20003
    s_add_u32 s76, s76, s77
    s_mul_i32 s76, s76, 331776
    s_mul_i32 s77, s24, 9216
    s_add_u32 s76, s76, s77
    v_lshlrev_b32 v3, 4, v1
    s_add_u32 s78, s76, 0
    s_add_u32 m0, s77, 0
    s_nop 0
    buffer_load_dwordx4 v3, s[80:83], s78 offen offset:0 lds
    buffer_load_dwordx4 v3, s[80:83], s78 offen offset:1024 lds
    buffer_load_dwordx4 v3, s[80:83], s78 offen offset:2048 lds
    buffer_load_dwordx4 v3, s[80:83], s78 offen offset:3072 lds
    s_add_u32 s78, s76, 4096
    s_add_u32 m0, s77, 4096
    s_nop 0
    buffer_load_dwordx4 v3, s[80:83], s78 offen offset:0 lds
    buffer_load_dwordx4 v3, s[80:83], s78 offen offset:1024 lds
    buffer_load_dwordx4 v3, s[80:83], s78 offen offset:2048 lds
    buffer_load_dwordx4 v3, s[80:83], s78 offen offset:3072 lds
    s_add_u32 s78, s76, 8192
    s_add_u32 m0, s77, 8192
    s_nop 0
    buffer_load_dwordx4 v3, s[80:83], s78 offen offset:0 lds
    s_add_u32 s78, s76, 36864
    s_add_u32 m0, s77, 36864
    s_nop 0
    buffer_load_dwordx4 v3, s[80:83], s78 offen offset:0 lds
    buffer_load_dwordx4 v3, s[80:83], s78 offen offset:1024 lds
    buffer_load_dwordx4 v3, s[80:83], s78 offen offset:2048 lds
    buffer_load_dwordx4 v3, s[80:83], s78 offen offset:3072 lds
    s_add_u32 s78, s76, 40960
    s_add_u32 m0, s77, 40960
    s_nop 0
    buffer_load_dwordx4 v3, s[80:83], s78 offen offset:0 lds
    buffer_load_dwordx4 v3, s[80:83], s78 offen offset:1024 lds
    buffer_load_dwordx4 v3, s[80:83], s78 offen offset:2048 lds
    buffer_load_dwordx4 v3, s[80:83], s78 offen offset:3072 lds
    s_add_u32 s78, s76, 45056
    s_add_u32 m0, s77, 45056
    s_nop 0
    buffer_load_dwordx4 v3, s[80:83], s78 offen offset:0 lds
    s_waitcnt vmcnt(18)
    s_barrier
    v_mov_b32 v20, 1
    v_mov_b32 v21, 0
    s_lshl_b32 s67, s26, 2
    s_add_u32 s67, s67, 73728
    buffer_store_dword v20, v21, s[52:55], s67 offen sc1
    v_mov_b32 v18, 0x7ffffff0
    v_mov_b32 v19, 0x7ffffff0
    v_mov_b32 v20, 0x7ffffff0
    v_mov_b32 v21, 0x7ffffff0
    v_mov_b32 v22, 0x7ffffff0
    v_mov_b32 v23, 0x7ffffff0
    v_mov_b32 v24, 0x7ffffff0
    v_mov_b32 v254, 0x7ffffff0
    v_mov_b32 v255, 0x7ffffff0
ffn_start:
    s_mov_b32 s60, s14
    s_mov_b32 s61, s15
    s_load_dwordx2 s[62:63], s[0:1], 80
    s_and_b32 s20, s2, 7
    s_lshr_b32 s21, s2, 3
    s_and_b32 s22, s20, 1
    s_lshl_b32 s22, s22, 3
    s_lshr_b32 s23, s21, 2
    s_add_u32 s22, s22, s23
    s_lshr_b32 s23, s20, 1
    s_and_b32 s21, s21, 3
    s_lshl_b32 s25, s23, 2
    s_add_u32 s25, s25, s21
    s_mul_i32 s29, s21, 9
    s_lshr_b32 s29, s29, 1
    v_and_b32 v1, 63, v0
    v_lshrrev_b32 v2, 6, v0
    v_lshlrev_b32 v26, 4, v1
    v_readfirstlane_b32 s24, v2
    v_mov_b32 v30, 0x7ffffff0
    v_add_u32 v25, 18432, v26
    s_mul_i32 s30, s25, 331776
    s_mul_i32 s26, s24, 9216
    s_add_u32 s30, s30, s26
    s_add_u32 s31, s30, 5308416
    s_lshl_b32 s27, s22, 2
    s_add_u32 s27, s27, s24
    s_mul_i32 s28, s27, 36864
    s_add_u32 s28, s28, 2359296
    s_add_u32 s5, s28, 18432
    s_lshl_b32 s4, s29, 10
    s_add_u32 s4, s4, s28
    s_lshl_b32 s65, s24, 3
    v_and_b32 v6, 15, v1
    v_lshrrev_b32 v7, 4, v1
    s_add_u32 s8, s60, 50741248
    s_addc_u32 s9, s61, 0
    s_and_b32 s9, s9, 0xffff
    s_mov_b32 s10, 10616832
    s_mov_b32 s11, 0x20000
    s_add_u32 s16, s60, 2424832
    s_addc_u32 s17, s61, 0
    s_and_b32 s17, s17, 0xffff
    s_mov_b32 s18, 4718592
    s_mov_b32 s19, 0x20000
    s_add_u32 s36, s60, 61575168
    s_addc_u32 s37, s61, 0
    s_and_b32 s37, s37, 0xffff
    s_mov_b32 s38, 84992
    s_mov_b32 s39, 0x20000
    v_min_u32 v16, 11, v1
    v_lshlrev_b32 v16, 2, v16
    s_lshl_b32 s66, s27, 7
    s_add_u32 s66, s66, 65536
    buffer_load_dword v252, v16, s[36:39], s66 offen offset:0 sc1
    v_min_u32 v5, 3, v1
    v_lshlrev_b32 v5, 2, v5
    v_min_u32 v17, 57, v1
    v_lshlrev_b32 v17, 2, v17
    s_mov_b32 s7, 73728
    s_add_u32 s32, s60, 7405568
    s_addc_u32 s33, s61, 0
    s_and_b32 s33, s33, 0xffff
    s_mov_b32 s34, 18874368
    s_mov_b32 s35, 0x20000
    s_add_u32 s40, s60, 7143424
    s_addc_u32 s41, s61, 0
    s_and_b32 s41, s41, 0xffff
    s_mov_b32 s42, 131072
    s_mov_b32 s43, 0x20000
    s_add_u32 s44, s60, 61501440
    s_addc_u32 s45, s61, 0
    s_and_b32 s45, s45, 0xffff
    s_mov_b32 s46, 73728
    s_mov_b32 s47, 0x20000
    s_add_u32 s12, s60, 26279936
    s_addc_u32 s13, s61, 0
    s_and_b32 s13, s13, 0xffff
    s_mov_b32 s14, 18874368
    s_mov_b32 s15, 0x20000
    s_lshl_b32 s64, s27, 5
    v_add_u32 v253, s64, v6
    v_lshlrev_b32 v253, 6, v253
    v_add_u32 v27, 36864, v26
    v_add_u32 v28, 73728, v26
    v_add_u32 v29, 110592, v26
    v_lshlrev_b32 v31, 4, v6
    v_add_u32 v31, 147456, v31
    s_mul_i32 s48, s27, 294912
    s_mul_i32 s64, s25, 9216
    s_add_u32 s50, s48, s64
    s_add_u32 s51, s50, 147456
    s_add_u32 s52, s50, 4096
    s_add_u32 s53, s51, 4096
    s_add_u32 s54, s50, 8192
    s_add_u32 s55, s51, 8192
    s_mul_i32 s64, s23, 36864
    s_add_u32 s48, s48, s64
    s_lshl_b32 s56, s27, 2
    s_add_u32 s57, s56, s23
    s_lshl_b32 s57, s57, 7
    s_add_u32 s58, s56, s21
    s_mul_i32 s56, s58, 36864
    s_lshl_b32 s58, s58, 7
    s_add_u32 s58, s58, 32768
    s_lshl_b32 s59, s21, 2
    v_mov_b32 v2, s59
    v_mov_b32 v3, 1
    s_mov_b32 s6, 0xffff0000
    s_mul_i32 s64, s25, 4608
    s_mul_i32 s49, s24, 1152
    s_add_u32 s64, s64, s49
    s_add_u32 s49, s49, 147456
    s_waitcnt vmcnt(0) lgkmcnt(0)
    s_mov_b32 s67, 400000
ffn_pc0:
    v_cmp_eq_u32 vcc, 1, v252
    s_nop 0
    s_cmp_eq_u64 vcc, exec
    s_cbranch_scc1 ffn_ok0
    s_sub_u32 s67, s67, 1
    s_cbranch_scc1 ffn_ok0
    buffer_load_dword v252, v16, s[36:39], s66 offen offset:0 sc1
    s_waitcnt vmcnt(0)
    s_branch ffn_pc0
ffn_ok0:
    buffer_load_dwordx4 a[0:3], v26, s[16:19], s4 offen sc1
    buffer_load_dwordx4 a[4:7], v25, s[16:19], s4 offen sc1
    s_add_u32 s4, s4, 1024
    s_cmp_eq_u32 s4, s5
    s_cselect_b32 s4, s28, s4
    buffer_load_dwordx4 a[8:11], v26, s[16:19], s4 offen sc1
    buffer_load_dwordx4 a[12:15], v25, s[16:19], s4 offen sc1
    s_add_u32 s4, s4, 1024
    s_cmp_eq_u32 s4, s5
    s_cselect_b32 s4, s28, s4
    buffer_load_dwordx4 a[16:19], v26, s[16:19], s4 offen sc1
    buffer_load_dwordx4 a[20:23], v25, s[16:19], s4 offen sc1
    s_add_u32 s4, s4, 1024
    s_cmp_eq_u32 s4, s5
    s_cselect_b32 s4, s28, s4
    buffer_load_dwordx4 a[24:27], v26, s[16:19], s4 offen sc1
    buffer_load_dwordx4 a[28:31], v25, s[16:19], s4 offen sc1
    s_add_u32 s4, s4, 1024
    s_cmp_eq_u32 s4, s5
    s_cselect_b32 s4, s28, s4
    buffer_load_dwordx4 a[32:35], v26, s[16:19], s4 offen sc1
    buffer_load_dwordx4 a[36:39], v25, s[16:19], s4 offen sc1
    s_add_u32 s4, s4, 1024
    s_cmp_eq_u32 s4, s5
    s_cselect_b32 s4, s28, s4
    buffer_load_dwordx4 a[40:43], v26, s[16:19], s4 offen sc1
    buffer_load_dwordx4 a[44:47], v25, s[16:19], s4 offen sc1
    s_add_u32 s4, s4, 1024
    s_cmp_eq_u32 s4, s5
    s_cselect_b32 s4, s28, s4
    buffer_load_dwordx4 a[48:51], v26, s[16:19], s4 offen sc1
    buffer_load_dwordx4 a[52:55], v25, s[16:19], s4 offen sc1
    s_add_u32 s4, s4, 1024
    s_cmp_eq_u32 s4, s5
    s_cselect_b32 s4, s28, s4
    buffer_load_dwordx4 a[56:59], v26, s[16:19], s4 offen sc1
    buffer_load_dwordx4 a[60:63], v25, s[16:19], s4 offen sc1
    s_add_u32 s4, s4, 1024
    s_cmp_eq_u32 s4, s5
    s_cselect_b32 s4, s28, s4
    s_barrier
    ds_read_b128 v[176:179], v26 offset:0
    ds_read_b128 v[180:183], v26 offset:1024
    ds_read_b128 v[184:187], v26 offset:2048
    ds_read_b128 v[188:191], v26 offset:3072
    ds_read_b128 v[192:195], v26 offset:4096
    ds_read_b128 v[196:199], v26 offset:5120
    ds_read_b128 v[200:203], v26 offset:6144
    ds_read_b128 v[204:207], v26 offset:7168
    ds_read_b128 v[244:247], v26 offset:8192
    ds_read_b128 a[240:243], v26 offset:9216
    s_waitcnt vmcnt(14)
    s_waitcnt lgkmcnt(6)
    v_mfma_f32_16x16x32_bf16 v[32:35], v[176:179], a[0:3], 0
    ds_read_b128 a[244:247], v26 offset:10240
    v_mfma_f32_16x16x32_bf16 v[36:39], v[176:179], a[4:7], 0
    v_mfma_f32_16x16x32_bf16 v[40:43], v[180:183], a[0:3], 0
    ds_read_b128 a[248:251], v26 offset:11264
    v_mfma_f32_16x16x32_bf16 v[44:47], v[180:183], a[4:7], 0
    v_mfma_f32_16x16x32_bf16 v[48:51], v[184:187], a[0:3], 0
    ds_read_b128 a[252:255], v26 offset:12288
    v_mfma_f32_16x16x32_bf16 v[52:55], v[184:187], a[4:7], 0
    s_add_u32 s68, s30, 73728
    s_add_u32 m0, s26, 73728
    v_mfma_f32_16x16x32_bf16 v[56:59], v[188:191], a[0:3], 0
    ds_read_b128 v[176:179], v26 offset:13312
    v_mfma_f32_16x16x32_bf16 v[60:63], v[188:191], a[4:7], 0
    buffer_load_dwordx4 v26, s[8:11], s68 offen offset:0 lds
    s_waitcnt lgkmcnt(6)
    v_mfma_f32_16x16x32_bf16 v[64:67], v[192:195], a[0:3], 0
    ds_read_b128 v[180:183], v26 offset:14336
    v_mfma_f32_16x16x32_bf16 v[68:71], v[192:195], a[4:7], 0
    buffer_load_dwordx4 a[64:67], v26, s[16:19], s4 offen sc1
    buffer_load_dwordx4 v26, s[8:11], s68 offen offset:1024 lds
    v_mfma_f32_16x16x32_bf16 v[72:75], v[196:199], a[0:3], 0
    ds_read_b128 v[184:187], v26 offset:15360
    v_mfma_f32_16x16x32_bf16 v[76:79], v[196:199], a[4:7], 0
    v_mfma_f32_16x16x32_bf16 v[80:83], v[200:203], a[0:3], 0
    ds_read_b128 v[188:191], v26 offset:16384
    v_mfma_f32_16x16x32_bf16 v[84:87], v[200:203], a[4:7], 0
    buffer_load_dwordx4 v26, s[8:11], s68 offen offset:2048 lds
    v_mfma_f32_16x16x32_bf16 v[88:91], v[204:207], a[0:3], 0
    ds_read_b128 v[192:195], v26 offset:17408
    v_mfma_f32_16x16x32_bf16 v[92:95], v[204:207], a[4:7], 0
    buffer_load_dwordx4 a[68:71], v25, s[16:19], s4 offen sc1
    s_waitcnt vmcnt(17)
    s_waitcnt lgkmcnt(6)
    v_mfma_f32_16x16x32_bf16 v[32:35], v[244:247], a[8:11], v[32:35]
    ds_read_b128 v[196:199], v26 offset:18432
    v_mfma_f32_16x16x32_bf16 v[36:39], v[244:247], a[12:15], v[36:39]
    s_add_u32 s4, s4, 1024
    s_cmp_eq_u32 s4, s5
    v_mfma_f32_16x16x32_bf16 v[40:43], a[240:243], a[8:11], v[40:43]
    ds_read_b128 v[200:203], v26 offset:19456
    v_mfma_f32_16x16x32_bf16 v[44:47], a[240:243], a[12:15], v[44:47]
    s_cselect_b32 s4, s28, s4
    buffer_load_dwordx4 v26, s[8:11], s68 offen offset:3072 lds
    v_mfma_f32_16x16x32_bf16 v[48:51], a[244:247], a[8:11], v[48:51]
    ds_read_b128 v[204:207], v26 offset:20480
    v_mfma_f32_16x16x32_bf16 v[52:55], a[244:247], a[12:15], v[52:55]
    v_mfma_f32_16x16x32_bf16 v[56:59], a[248:251], a[8:11], v[56:59]
    ds_read_b128 v[244:247], v26 offset:21504
    v_mfma_f32_16x16x32_bf16 v[60:63], a[248:251], a[12:15], v[60:63]
    s_add_u32 s68, s68, 4096
    s_waitcnt lgkmcnt(6)
    v_mfma_f32_16x16x32_bf16 v[64:67], a[252:255], a[8:11], v[64:67]
    ds_read_b128 a[240:243], v26 offset:22528
    v_mfma_f32_16x16x32_bf16 v[68:71], a[252:255], a[12:15], v[68:71]
    s_add_u32 m0, s26, 77824
    s_nop 0
    buffer_load_dwordx4 v26, s[8:11], s68 offen offset:0 lds
    v_mfma_f32_16x16x32_bf16 v[72:75], v[176:179], a[8:11], v[72:75]
    ds_read_b128 a[244:247], v26 offset:23552
    v_mfma_f32_16x16x32_bf16 v[76:79], v[176:179], a[12:15], v[76:79]
    buffer_load_dwordx4 a[72:75], v26, s[16:19], s4 offen sc1
    v_mfma_f32_16x16x32_bf16 v[80:83], v[180:183], a[8:11], v[80:83]
    ds_read_b128 a[248:251], v26 offset:24576
    v_mfma_f32_16x16x32_bf16 v[84:87], v[180:183], a[12:15], v[84:87]
    buffer_load_dwordx4 v26, s[8:11], s68 offen offset:1024 lds
    v_mfma_f32_16x16x32_bf16 v[88:91], v[184:187], a[8:11], v[88:91]
    ds_read_b128 a[252:255], v26 offset:25600
    v_mfma_f32_16x16x32_bf16 v[92:95], v[184:187], a[12:15], v[92:95]
    buffer_load_dwordx4 a[76:79], v25, s[16:19], s4 offen sc1
    s_waitcnt vmcnt(20)
    s_waitcnt lgkmcnt(6)
    v_mfma_f32_16x16x32_bf16 v[32:35], v[188:191], a[16:19], v[32:35]
    ds_read_b128 v[176:179], v26 offset:26624
    v_mfma_f32_16x16x32_bf16 v[36:39], v[188:191], a[20:23], v[36:39]
    s_add_u32 s4, s4, 1024
    s_cmp_eq_u32 s4, s5
    v_mfma_f32_16x16x32_bf16 v[40:43], v[192:195], a[16:19], v[40:43]
    ds_read_b128 v[180:183], v26 offset:27648
    v_mfma_f32_16x16x32_bf16 v[44:47], v[192:195], a[20:23], v[44:47]
    s_cselect_b32 s4, s28, s4
    buffer_load_dwordx4 v26, s[8:11], s68 offen offset:2048 lds
    v_mfma_f32_16x16x32_bf16 v[48:51], v[196:199], a[16:19], v[48:51]
    ds_read_b128 v[184:187], v26 offset:28672
    v_mfma_f32_16x16x32_bf16 v[52:55], v[196:199], a[20:23], v[52:55]
    v_mfma_f32_16x16x32_bf16 v[56:59], v[200:203], a[16:19], v[56:59]
    ds_read_b128 v[188:191], v26 offset:29696
    v_mfma_f32_16x16x32_bf16 v[60:63], v[200:203], a[20:23], v[60:63]
    buffer_load_dwordx4 v26, s[8:11], s68 offen offset:3072 lds
    s_waitcnt lgkmcnt(6)
    v_mfma_f32_16x16x32_bf16 v[64:67], v[204:207], a[16:19], v[64:67]
    ds_read_b128 v[192:195], v26 offset:30720
    v_mfma_f32_16x16x32_bf16 v[68:71], v[204:207], a[20:23], v[68:71]
    buffer_load_dwordx4 a[80:83], v26, s[16:19], s4 offen sc1
    v_mfma_f32_16x16x32_bf16 v[72:75], v[244:247], a[16:19], v[72:75]
    ds_read_b128 v[196:199], v26 offset:31744
    v_mfma_f32_16x16x32_bf16 v[76:79], v[244:247], a[20:23], v[76:79]
    s_add_u32 s68, s68, 4096
    s_add_u32 m0, s26, 81920
    v_mfma_f32_16x16x32_bf16 v[80:83], a[240:243], a[16:19], v[80:83]
    ds_read_b128 v[200:203], v26 offset:32768
    v_mfma_f32_16x16x32_bf16 v[84:87], a[240:243], a[20:23], v[84:87]
    buffer_load_dwordx4 v26, s[8:11], s68 offen offset:0 lds
    v_mfma_f32_16x16x32_bf16 v[88:91], a[244:247], a[16:19], v[88:91]
    ds_read_b128 v[204:207], v26 offset:33792
    v_mfma_f32_16x16x32_bf16 v[92:95], a[244:247], a[20:23], v[92:95]
    buffer_load_dwordx4 a[84:87], v25, s[16:19], s4 offen sc1
    s_waitcnt vmcnt(23)
    s_waitcnt lgkmcnt(6)
    v_mfma_f32_16x16x32_bf16 v[32:35], a[248:251], a[24:27], v[32:35]
    ds_read_b128 v[244:247], v26 offset:34816
    v_mfma_f32_16x16x32_bf16 v[36:39], a[248:251], a[28:31], v[36:39]
    s_add_u32 s4, s4, 1024
    s_cmp_eq_u32 s4, s5
    v_mfma_f32_16x16x32_bf16 v[40:43], a[252:255], a[24:27], v[40:43]
    ds_read_b128 a[240:243], v26 offset:35840
    v_mfma_f32_16x16x32_bf16 v[44:47], a[252:255], a[28:31], v[44:47]
    s_cselect_b32 s4, s28, s4
    buffer_load_dwordx4 v[208:211], v253, s[40:43], 0 offen offset:0 sc1
    v_mfma_f32_16x16x32_bf16 v[48:51], v[176:179], a[24:27], v[48:51]
    s_barrier
    ds_read_b128 a[244:247], v27 offset:0
    v_mfma_f32_16x16x32_bf16 v[52:55], v[176:179], a[28:31], v[52:55]
    v_mfma_f32_16x16x32_bf16 v[56:59], v[180:183], a[24:27], v[56:59]
    ds_read_b128 a[248:251], v27 offset:1024
    v_mfma_f32_16x16x32_bf16 v[60:63], v[180:183], a[28:31], v[60:63]
    s_add_u32 s69, s30, 110592
    s_waitcnt lgkmcnt(6)
    v_mfma_f32_16x16x32_bf16 v[64:67], v[184:187], a[24:27], v[64:67]
    ds_read_b128 a[252:255], v27 offset:2048
    v_mfma_f32_16x16x32_bf16 v[68:71], v[184:187], a[28:31], v[68:71]
    s_add_u32 m0, s26, 110592
    s_nop 0
    buffer_load_dwordx4 v26, s[8:11], s69 offen offset:0 lds
    v_mfma_f32_16x16x32_bf16 v[72:75], v[188:191], a[24:27], v[72:75]
    ds_read_b128 v[176:179], v27 offset:3072
    v_mfma_f32_16x16x32_bf16 v[76:79], v[188:191], a[28:31], v[76:79]
    buffer_load_dwordx4 a[88:91], v26, s[16:19], s4 offen sc1
    v_mfma_f32_16x16x32_bf16 v[80:83], v[192:195], a[24:27], v[80:83]
    ds_read_b128 v[180:183], v27 offset:4096
    v_mfma_f32_16x16x32_bf16 v[84:87], v[192:195], a[28:31], v[84:87]
    buffer_load_dwordx4 v[212:215], v253, s[40:43], 0 offen offset:16 sc1
    buffer_load_dwordx4 v26, s[8:11], s69 offen offset:1024 lds
    v_mfma_f32_16x16x32_bf16 v[88:91], v[196:199], a[24:27], v[88:91]
    ds_read_b128 v[184:187], v27 offset:5120
    v_mfma_f32_16x16x32_bf16 v[92:95], v[196:199], a[28:31], v[92:95]
    buffer_store_dwordx4 v[232:235], v26, s[16:19], s100 offen offset:0 sc1
    s_waitcnt vmcnt(27)
    s_waitcnt lgkmcnt(6)
    v_mfma_f32_16x16x32_bf16 v[32:35], v[200:203], a[32:35], v[32:35]
    ds_read_b128 v[188:191], v27 offset:6144
    v_mfma_f32_16x16x32_bf16 v[36:39], v[200:203], a[36:39], v[36:39]
    buffer_load_dword v252, v17, s[36:39], s7 offen offset:0 sc1
    buffer_load_dwordx4 a[92:95], v25, s[16:19], s4 offen sc1
    v_mfma_f32_16x16x32_bf16 v[40:43], v[204:207], a[32:35], v[40:43]
    ds_read_b128 v[192:195], v27 offset:7168
    v_mfma_f32_16x16x32_bf16 v[44:47], v[204:207], a[36:39], v[44:47]
    s_add_u32 s4, s4, 1024
    s_cmp_eq_u32 s4, s5
    v_mfma_f32_16x16x32_bf16 v[48:51], v[244:247], a[32:35], v[48:51]
    ds_read_b128 v[196:199], v27 offset:8192
    v_mfma_f32_16x16x32_bf16 v[52:55], v[244:247], a[36:39], v[52:55]
    s_cselect_b32 s4, s28, s4
    buffer_load_dwordx4 v26, s[8:11], s69 offen offset:2048 lds
    v_mfma_f32_16x16x32_bf16 v[56:59], a[240:243], a[32:35], v[56:59]
    ds_read_b128 v[200:203], v27 offset:9216
    v_mfma_f32_16x16x32_bf16 v[60:63], a[240:243], a[36:39], v[60:63]
    s_waitcnt lgkmcnt(6)
    v_mfma_f32_16x16x32_bf16 v[64:67], a[244:247], a[32:35], v[64:67]
    ds_read_b128 v[204:207], v27 offset:10240
    v_mfma_f32_16x16x32_bf16 v[68:71], a[244:247], a[36:39], v[68:71]
    buffer_load_dwordx4 a[96:99], v26, s[16:19], s4 offen sc1
    buffer_load_dwordx4 v[216:219], v253, s[40:43], 0 offen offset:32 sc1
    v_mfma_f32_16x16x32_bf16 v[72:75], a[248:251], a[32:35], v[72:75]
    ds_read_b128 v[244:247], v27 offset:11264
    v_mfma_f32_16x16x32_bf16 v[76:79], a[248:251], a[36:39], v[76:79]
    buffer_load_dwordx4 v26, s[8:11], s69 offen offset:3072 lds
    buffer_store_dwordx4 v[236:239], v26, s[16:19], s100 offen offset:1024 sc1
    v_mfma_f32_16x16x32_bf16 v[80:83], a[252:255], a[32:35], v[80:83]
    ds_read_b128 a[240:243], v27 offset:12288
    v_mfma_f32_16x16x32_bf16 v[84:87], a[252:255], a[36:39], v[84:87]
    v_mfma_f32_16x16x32_bf16 v[88:91], v[176:179], a[32:35], v[88:91]
    ds_read_b128 a[244:247], v27 offset:13312
    v_mfma_f32_16x16x32_bf16 v[92:95], v[176:179], a[36:39], v[92:95]
    buffer_load_dwordx4 a[100:103], v25, s[16:19], s4 offen sc1
    s_waitcnt vmcnt(33)
    s_waitcnt lgkmcnt(6)
    v_mfma_f32_16x16x32_bf16 v[32:35], v[180:183], a[40:43], v[32:35]
    ds_read_b128 a[248:251], v27 offset:14336
    v_mfma_f32_16x16x32_bf16 v[36:39], v[180:183], a[44:47], v[36:39]
    s_add_u32 s4, s4, 1024
    s_cmp_eq_u32 s4, s5
    v_mfma_f32_16x16x32_bf16 v[40:43], v[184:187], a[40:43], v[40:43]
    ds_read_b128 a[252:255], v27 offset:15360
    v_mfma_f32_16x16x32_bf16 v[44:47], v[184:187], a[44:47], v[44:47]
    s_cselect_b32 s4, s28, s4
    s_add_u32 s69, s69, 4096
    v_mfma_f32_16x16x32_bf16 v[48:51], v[188:191], a[40:43], v[48:51]
    ds_read_b128 v[176:179], v27 offset:16384
    v_mfma_f32_16x16x32_bf16 v[52:55], v[188:191], a[44:47], v[52:55]
    s_add_u32 m0, s26, 114688
    s_nop 0
    buffer_load_dwordx4 v26, s[8:11], s69 offen offset:0 lds
    v_mfma_f32_16x16x32_bf16 v[56:59], v[192:195], a[40:43], v[56:59]
    ds_read_b128 v[180:183], v27 offset:17408
    v_mfma_f32_16x16x32_bf16 v[60:63], v[192:195], a[44:47], v[60:63]
    buffer_load_dwordx4 v[220:223], v253, s[40:43], 0 offen offset:1024 sc1
    s_waitcnt lgkmcnt(6)
    v_mfma_f32_16x16x32_bf16 v[64:67], v[196:199], a[40:43], v[64:67]
    ds_read_b128 v[184:187], v27 offset:18432
    v_mfma_f32_16x16x32_bf16 v[68:71], v[196:199], a[44:47], v[68:71]
    buffer_load_dwordx4 v26, s[8:11], s69 offen offset:1024 lds
    buffer_load_dwordx4 a[104:107], v26, s[16:19], s4 offen sc1
    v_mfma_f32_16x16x32_bf16 v[72:75], v[200:203], a[40:43], v[72:75]
    ds_read_b128 v[188:191], v27 offset:19456
    v_mfma_f32_16x16x32_bf16 v[76:79], v[200:203], a[44:47], v[76:79]
    buffer_store_dwordx4 v[240:243], v26, s[16:19], s100 offen offset:2048 sc1
    v_mfma_f32_16x16x32_bf16 v[80:83], v[204:207], a[40:43], v[80:83]
    ds_read_b128 v[192:195], v27 offset:20480
    v_mfma_f32_16x16x32_bf16 v[84:87], v[204:207], a[44:47], v[84:87]
    v_mfma_f32_16x16x32_bf16 v[88:91], v[244:247], a[40:43], v[88:91]
    ds_read_b128 v[196:199], v27 offset:21504
    v_mfma_f32_16x16x32_bf16 v[92:95], v[244:247], a[44:47], v[92:95]
    buffer_load_dwordx4 a[108:111], v25, s[16:19], s4 offen sc1
    s_waitcnt vmcnt(37)
    s_waitcnt lgkmcnt(6)
    v_mfma_f32_16x16x32_bf16 v[32:35], a[240:243], a[48:51], v[32:35]
    ds_read_b128 v[200:203], v27 offset:22528
    v_mfma_f32_16x16x32_bf16 v[36:39], a[240:243], a[52:55], v[36:39]
    s_add_u32 s4, s4, 1024
    s_cmp_eq_u32 s4, s5
    v_mfma_f32_16x16x32_bf16 v[40:43], a[244:247], a[48:51], v[40:43]
    ds_read_b128 v[204:207], v27 offset:23552
    v_mfma_f32_16x16x32_bf16 v[44:47], a[244:247], a[52:55], v[44:47]
    s_cselect_b32 s4, s28, s4
    buffer_load_dwordx4 v26, s[8:11], s69 offen offset:2048 lds
    v_mfma_f32_16x16x32_bf16 v[48:51], a[248:251], a[48:51], v[48:51]
    ds_read_b128 v[244:247], v27 offset:24576
    v_mfma_f32_16x16x32_bf16 v[52:55], a[248:251], a[52:55], v[52:55]
    buffer_load_dwordx4 v[224:227], v253, s[40:43], 0 offen offset:1040 sc1
    buffer_load_dwordx4 v26, s[8:11], s69 offen offset:3072 lds
    v_mfma_f32_16x16x32_bf16 v[56:59], a[252:255], a[48:51], v[56:59]
    ds_read_b128 a[240:243], v27 offset:25600
    v_mfma_f32_16x16x32_bf16 v[60:63], a[252:255], a[52:55], v[60:63]
    s_waitcnt lgkmcnt(6)
    v_mfma_f32_16x16x32_bf16 v[64:67], v[176:179], a[48:51], v[64:67]
    ds_read_b128 a[244:247], v27 offset:26624
    v_mfma_f32_16x16x32_bf16 v[68:71], v[176:179], a[52:55], v[68:71]
    buffer_load_dwordx4 a[112:115], v26, s[16:19], s4 offen sc1
    buffer_store_dwordx4 a[144:147], v18, s[8:11], 0 offen sc1
    v_mfma_f32_16x16x32_bf16 v[72:75], v[180:183], a[48:51], v[72:75]
    ds_read_b128 a[248:251], v27 offset:27648
    v_mfma_f32_16x16x32_bf16 v[76:79], v[180:183], a[52:55], v[76:79]
    s_add_u32 s69, s69, 4096
    s_add_u32 m0, s26, 118784
    v_mfma_f32_16x16x32_bf16 v[80:83], v[184:187], a[48:51], v[80:83]
    ds_read_b128 a[252:255], v27 offset:28672
    v_mfma_f32_16x16x32_bf16 v[84:87], v[184:187], a[52:55], v[84:87]
    buffer_load_dwordx4 v26, s[8:11], s69 offen offset:0 lds
    buffer_load_dwordx4 v[228:231], v253, s[40:43], 0 offen offset:1056 sc1
    v_mfma_f32_16x16x32_bf16 v[88:91], v[188:191], a[48:51], v[88:91]
    ds_read_b128 v[176:179], v27 offset:29696
    v_mfma_f32_16x16x32_bf16 v[92:95], v[188:191], a[52:55], v[92:95]
    buffer_load_dwordx4 a[116:119], v25, s[16:19], s4 offen sc1
    s_waitcnt vmcnt(43)
    s_waitcnt lgkmcnt(6)
    v_mfma_f32_16x16x32_bf16 v[32:35], v[192:195], a[56:59], v[32:35]
    ds_read_b128 v[180:183], v27 offset:30720
    v_mfma_f32_16x16x32_bf16 v[36:39], v[192:195], a[60:63], v[36:39]
    s_add_u32 s4, s4, 1024
    s_cmp_eq_u32 s4, s5
    v_mfma_f32_16x16x32_bf16 v[40:43], v[196:199], a[56:59], v[40:43]
    ds_read_b128 v[184:187], v27 offset:31744
    v_mfma_f32_16x16x32_bf16 v[44:47], v[196:199], a[60:63], v[44:47]
    s_cselect_b32 s4, s28, s4
    s_waitcnt vmcnt(21)
    s_mov_b32 s67, 400000
ffn_pc1:
    v_cmp_eq_u32 vcc, 1, v252
    s_nop 0
    s_cmp_eq_u64 vcc, exec
    s_cbranch_scc1 ffn_ok1
    s_sub_u32 s67, s67, 1
    s_cbranch_scc1 ffn_ok1
    s_sleep 1
    buffer_load_dword v252, v17, s[36:39], s7 offen offset:0 sc1
    s_waitcnt vmcnt(0)
    s_branch ffn_pc1
ffn_ok1:
    s_mov_b32 s67, m0
    s_mov_b32 m0, s49
    s_nop 0
    buffer_load_dwordx4 v26, s[44:47], s64 offen sc1 lds
    buffer_load_dwordx4 v26, s[44:47], s64 offen offset:128 sc1 lds
    s_mov_b32 m0, s67
    v_mfma_f32_16x16x32_bf16 v[48:51], v[200:203], a[56:59], v[48:51]
    ds_read_b128 v[188:191], v27 offset:32768
    v_mfma_f32_16x16x32_bf16 v[52:55], v[200:203], a[60:63], v[52:55]
    v_mfma_f32_16x16x32_bf16 v[56:59], v[204:207], a[56:59], v[56:59]
    ds_read_b128 v[192:195], v27 offset:33792
    v_mfma_f32_16x16x32_bf16 v[60:63], v[204:207], a[60:63], v[60:63]
    s_waitcnt lgkmcnt(6)
    v_mfma_f32_16x16x32_bf16 v[64:67], v[244:247], a[56:59], v[64:67]
    ds_read_b128 v[196:199], v27 offset:34816
    v_mfma_f32_16x16x32_bf16 v[68:71], v[244:247], a[60:63], v[68:71]
    buffer_load_dwordx4 a[120:123], v26, s[16:19], s4 offen sc1
    buffer_store_dwordx4 a[148:151], v19, s[8:11], 0 offen sc1
    v_mfma_f32_16x16x32_bf16 v[72:75], a[240:243], a[56:59], v[72:75]
    ds_read_b128 v[200:203], v27 offset:35840
    v_mfma_f32_16x16x32_bf16 v[76:79], a[240:243], a[60:63], v[76:79]
    v_mfma_f32_16x16x32_bf16 v[80:83], a[244:247], a[56:59], v[80:83]
    s_barrier
    ds_read_b128 v[204:207], v28 offset:0
    v_mfma_f32_16x16x32_bf16 v[84:87], a[244:247], a[60:63], v[84:87]
    v_mfma_f32_16x16x32_bf16 v[88:91], a[248:251], a[56:59], v[88:91]
    ds_read_b128 v[244:247], v28 offset:1024
    v_mfma_f32_16x16x32_bf16 v[92:95], a[248:251], a[60:63], v[92:95]
    buffer_load_dwordx4 a[124:127], v25, s[16:19], s4 offen sc1
    s_waitcnt lgkmcnt(6)
    v_mfma_f32_16x16x32_bf16 v[32:35], a[252:255], a[64:67], v[32:35]
    ds_read_b128 a[240:243], v28 offset:2048
    v_mfma_f32_16x16x32_bf16 v[36:39], a[252:255], a[68:71], v[36:39]
    s_add_u32 s4, s4, 1024
    s_cmp_eq_u32 s4, s5
    v_mfma_f32_16x16x32_bf16 v[40:43], v[176:179], a[64:67], v[40:43]
    ds_read_b128 a[244:247], v28 offset:3072
    v_mfma_f32_16x16x32_bf16 v[44:47], v[176:179], a[68:71], v[44:47]
    s_cselect_b32 s4, s28, s4
    s_add_u32 s68, s30, 147456
    v_mfma_f32_16x16x32_bf16 v[48:51], v[180:183], a[64:67], v[48:51]
    ds_read_b128 a[248:251], v28 offset:4096
    v_mfma_f32_16x16x32_bf16 v[52:55], v[180:183], a[68:71], v[52:55]
    s_add_u32 m0, s26, 0
    s_nop 0
    buffer_load_dwordx4 v26, s[8:11], s68 offen offset:0 lds
    v_mfma_f32_16x16x32_bf16 v[56:59], v[184:187], a[64:67], v[56:59]
    ds_read_b128 a[252:255], v28 offset:5120
    v_mfma_f32_16x16x32_bf16 v[60:63], v[184:187], a[68:71], v[60:63]
    buffer_load_dwordx4 v26, s[8:11], s68 offen offset:1024 lds
    s_waitcnt lgkmcnt(6)
    v_mfma_f32_16x16x32_bf16 v[64:67], v[188:191], a[64:67], v[64:67]
    ds_read_b128 v[176:179], v28 offset:6144
    v_mfma_f32_16x16x32_bf16 v[68:71], v[188:191], a[68:71], v[68:71]
    buffer_store_dwordx4 a[152:155], v20, s[8:11], 0 offen sc1
    buffer_load_dwordx4 a[128:131], v26, s[16:19], s4 offen sc1
    v_mfma_f32_16x16x32_bf16 v[72:75], v[192:195], a[64:67], v[72:75]
    ds_read_b128 v[180:183], v28 offset:7168
    v_mfma_f32_16x16x32_bf16 v[76:79], v[192:195], a[68:71], v[76:79]
    buffer_load_dwordx4 v26, s[8:11], s68 offen offset:2048 lds
    v_mfma_f32_16x16x32_bf16 v[80:83], v[196:199], a[64:67], v[80:83]
    ds_read_b128 v[184:187], v28 offset:8192
    v_mfma_f32_16x16x32_bf16 v[84:87], v[196:199], a[68:71], v[84:87]
    v_mfma_f32_16x16x32_bf16 v[88:91], v[200:203], a[64:67], v[88:91]
    ds_read_b128 v[188:191], v28 offset:9216
    v_mfma_f32_16x16x32_bf16 v[92:95], v[200:203], a[68:71], v[92:95]
    buffer_load_dwordx4 a[132:135], v25, s[16:19], s4 offen sc1
    s_waitcnt lgkmcnt(6)
    v_mfma_f32_16x16x32_bf16 v[32:35], v[204:207], a[72:75], v[32:35]
    ds_read_b128 v[192:195], v28 offset:10240
    v_mfma_f32_16x16x32_bf16 v[36:39], v[204:207], a[76:79], v[36:39]
    s_add_u32 s4, s4, 1024
    s_cmp_eq_u32 s4, s5
    v_mfma_f32_16x16x32_bf16 v[40:43], v[244:247], a[72:75], v[40:43]
    ds_read_b128 v[196:199], v28 offset:11264
    v_mfma_f32_16x16x32_bf16 v[44:47], v[244:247], a[76:79], v[44:47]
    s_cselect_b32 s4, s28, s4
    buffer_load_dwordx4 v26, s[8:11], s68 offen offset:3072 lds
    v_mfma_f32_16x16x32_bf16 v[48:51], a[240:243], a[72:75], v[48:51]
    ds_read_b128 v[200:203], v28 offset:12288
    v_mfma_f32_16x16x32_bf16 v[52:55], a[240:243], a[76:79], v[52:55]
    v_mfma_f32_16x16x32_bf16 v[56:59], a[244:247], a[72:75], v[56:59]
    ds_read_b128 v[204:207], v28 offset:13312
    v_mfma_f32_16x16x32_bf16 v[60:63], a[244:247], a[76:79], v[60:63]
    buffer_store_dwordx4 a[156:159], v21, s[8:11], 0 offen sc1
    s_waitcnt lgkmcnt(6)
    v_mfma_f32_16x16x32_bf16 v[64:67], a[248:251], a[72:75], v[64:67]
    ds_read_b128 v[244:247], v28 offset:14336
    v_mfma_f32_16x16x32_bf16 v[68:71], a[248:251], a[76:79], v[68:71]
    buffer_load_dwordx4 a[136:139], v26, s[16:19], s4 offen sc1
    s_add_u32 s68, s68, 4096
    v_mfma_f32_16x16x32_bf16 v[72:75], a[252:255], a[72:75], v[72:75]
    ds_read_b128 a[240:243], v28 offset:15360
    v_mfma_f32_16x16x32_bf16 v[76:79], a[252:255], a[76:79], v[76:79]
    s_add_u32 m0, s26, 4096
    s_nop 0
    buffer_load_dwordx4 v26, s[8:11], s68 offen offset:0 lds
    v_mfma_f32_16x16x32_bf16 v[80:83], v[176:179], a[72:75], v[80:83]
    ds_read_b128 a[244:247], v28 offset:16384
    v_mfma_f32_16x16x32_bf16 v[84:87], v[176:179], a[76:79], v[84:87]
    v_mfma_f32_16x16x32_bf16 v[88:91], v[180:183], a[72:75], v[88:91]
    ds_read_b128 a[248:251], v28 offset:17408
    v_mfma_f32_16x16x32_bf16 v[92:95], v[180:183], a[76:79], v[92:95]
    buffer_load_dwordx4 a[140:143], v25, s[16:19], s4 offen sc1
    s_waitcnt lgkmcnt(6)
    v_mfma_f32_16x16x32_bf16 v[32:35], v[184:187], a[80:83], v[32:35]
    ds_read_b128 a[252:255], v28 offset:18432
    v_mfma_f32_16x16x32_bf16 v[36:39], v[184:187], a[84:87], v[36:39]
    buffer_load_dwordx4 v26, s[8:11], s68 offen offset:1024 lds
    v_mfma_f32_16x16x32_bf16 v[40:43], v[188:191], a[80:83], v[40:43]
    ds_read_b128 v[176:179], v28 offset:19456
    v_mfma_f32_16x16x32_bf16 v[44:47], v[188:191], a[84:87], v[44:47]
    v_mfma_f32_16x16x32_bf16 v[48:51], v[192:195], a[80:83], v[48:51]
    ds_read_b128 v[180:183], v28 offset:20480
    v_mfma_f32_16x16x32_bf16 v[52:55], v[192:195], a[84:87], v[52:55]
    buffer_store_dwordx4 a[160:163], v22, s[8:11], 0 offen sc1
    v_mfma_f32_16x16x32_bf16 v[56:59], v[196:199], a[80:83], v[56:59]
    ds_read_b128 v[184:187], v28 offset:21504
    v_mfma_f32_16x16x32_bf16 v[60:63], v[196:199], a[84:87], v[60:63]
    buffer_load_dwordx4 v26, s[8:11], s68 offen offset:2048 lds
    s_waitcnt lgkmcnt(6)
    v_mfma_f32_16x16x32_bf16 v[64:67], v[200:203], a[80:83], v[64:67]
    ds_read_b128 v[188:191], v28 offset:22528
    v_mfma_f32_16x16x32_bf16 v[68:71], v[200:203], a[84:87], v[68:71]
    v_mfma_f32_16x16x32_bf16 v[72:75], v[204:207], a[80:83], v[72:75]
    ds_read_b128 v[192:195], v28 offset:23552
    v_mfma_f32_16x16x32_bf16 v[76:79], v[204:207], a[84:87], v[76:79]
    v_mfma_f32_16x16x32_bf16 v[80:83], v[244:247], a[80:83], v[80:83]
    ds_read_b128 v[196:199], v28 offset:24576
    v_mfma_f32_16x16x32_bf16 v[84:87], v[244:247], a[84:87], v[84:87]
    buffer_load_dwordx4 v26, s[8:11], s68 offen offset:3072 lds
    v_mfma_f32_16x16x32_bf16 v[88:91], a[240:243], a[80:83], v[88:91]
    ds_read_b128 v[200:203], v28 offset:25600
    v_mfma_f32_16x16x32_bf16 v[92:95], a[240:243], a[84:87], v[92:95]
    s_waitcnt vmcnt(40)
    s_waitcnt lgkmcnt(6)
    v_mfma_f32_16x16x32_bf16 v[32:35], a[244:247], a[88:91], v[32:35]
    ds_read_b128 v[204:207], v28 offset:26624
    v_mfma_f32_16x16x32_bf16 v[36:39], a[244:247], a[92:95], v[36:39]
    v_mfma_f32_16x16x32_bf16 v[40:43], a[248:251], a[88:91], v[40:43]
    ds_read_b128 v[244:247], v28 offset:27648
    v_mfma_f32_16x16x32_bf16 v[44:47], a[248:251], a[92:95], v[44:47]
    s_add_u32 s68, s68, 4096
    s_add_u32 m0, s26, 8192
    v_mfma_f32_16x16x32_bf16 v[48:51], a[252:255], a[88:91], v[48:51]
    ds_read_b128 a[240:243], v28 offset:28672
    v_mfma_f32_16x16x32_bf16 v[52:55], a[252:255], a[92:95], v[52:55]
    buffer_load_dwordx4 v26, s[8:11], s68 offen offset:0 lds
    buffer_store_dwordx4 a[164:167], v23, s[8:11], 0 offen sc1
    v_mfma_f32_16x16x32_bf16 v[56:59], v[176:179], a[88:91], v[56:59]
    ds_read_b128 a[244:247], v28 offset:29696
    v_mfma_f32_16x16x32_bf16 v[60:63], v[176:179], a[92:95], v[60:63]
    s_waitcnt lgkmcnt(6)
    v_mfma_f32_16x16x32_bf16 v[64:67], v[180:183], a[88:91], v[64:67]
    ds_read_b128 a[248:251], v28 offset:30720
    v_mfma_f32_16x16x32_bf16 v[68:71], v[180:183], a[92:95], v[68:71]
    v_mfma_f32_16x16x32_bf16 v[72:75], v[184:187], a[88:91], v[72:75]
    ds_read_b128 a[252:255], v28 offset:31744
    v_mfma_f32_16x16x32_bf16 v[76:79], v[184:187], a[92:95], v[76:79]
    v_mfma_f32_16x16x32_bf16 v[80:83], v[188:191], a[88:91], v[80:83]
    ds_read_b128 v[176:179], v28 offset:32768
    v_mfma_f32_16x16x32_bf16 v[84:87], v[188:191], a[92:95], v[84:87]
    v_mfma_f32_16x16x32_bf16 v[88:91], v[192:195], a[88:91], v[88:91]
    ds_read_b128 v[180:183], v28 offset:33792
    v_mfma_f32_16x16x32_bf16 v[92:95], v[192:195], a[92:95], v[92:95]
    s_waitcnt vmcnt(36)
    s_waitcnt lgkmcnt(6)
    v_mfma_f32_16x16x32_bf16 v[32:35], v[196:199], a[96:99], v[32:35]
    ds_read_b128 v[184:187], v28 offset:34816
    v_mfma_f32_16x16x32_bf16 v[36:39], v[196:199], a[100:103], v[36:39]
    v_mfma_f32_16x16x32_bf16 v[40:43], v[200:203], a[96:99], v[40:43]
    ds_read_b128 v[188:191], v28 offset:35840
    v_mfma_f32_16x16x32_bf16 v[44:47], v[200:203], a[100:103], v[44:47]
    buffer_store_dwordx4 a[168:171], v24, s[8:11], 0 offen sc1
    v_mfma_f32_16x16x32_bf16 v[48:51], v[204:207], a[96:99], v[48:51]
    s_waitcnt vmcnt(21)
    s_barrier
    ds_read_b128 v[192:195], v29 offset:0
    v_mfma_f32_16x16x32_bf16 v[52:55], v[204:207], a[100:103], v[52:55]
    v_mfma_f32_16x16x32_bf16 v[56:59], v[244:247], a[96:99], v[56:59]
    ds_read_b128 v[196:199], v29 offset:1024
    v_mfma_f32_16x16x32_bf16 v[60:63], v[244:247], a[100:103], v[60:63]
    s_add_u32 s69, s30, 184320
    s_waitcnt lgkmcnt(6)
    v_mfma_f32_16x16x32_bf16 v[64:67], a[240:243], a[96:99], v[64:67]
    ds_read_b128 v[200:203], v29 offset:2048
    s_add_u32 m0, s26, 36864
    v_mfma_f32_16x16x32_bf16 v[68:71], a[240:243], a[100:103], v[68:71]
    buffer_load_dwordx4 v26, s[8:11], s69 offen offset:0 lds
    v_mfma_f32_16x16x32_bf16 v[72:75], a[244:247], a[96:99], v[72:75]
    ds_read_b128 v[204:207], v29 offset:3072
    v_add_f32 v208, v208, v210
    v_mfma_f32_16x16x32_bf16 v[76:79], a[244:247], a[100:103], v[76:79]
    v_add_f32 v209, v209, v211
    v_add_f32 v212, v212, v214
    v_mfma_f32_16x16x32_bf16 v[80:83], a[248:251], a[96:99], v[80:83]
    ds_read_b128 v[244:247], v29 offset:4096
    v_add_f32 v213, v213, v215
    v_mfma_f32_16x16x32_bf16 v[84:87], a[248:251], a[100:103], v[84:87]
    v_add_f32 v216, v216, v218
    v_add_f32 v217, v217, v219
    v_mfma_f32_16x16x32_bf16 v[88:91], a[252:255], a[96:99], v[88:91]
    ds_read_b128 a[240:243], v29 offset:5120
    v_add_f32 v208, v208, v212
    v_mfma_f32_16x16x32_bf16 v[92:95], a[252:255], a[100:103], v[92:95]
    v_add_f32 v209, v209, v213
    s_waitcnt lgkmcnt(6)
    v_mfma_f32_16x16x32_bf16 v[32:35], v[176:179], a[104:107], v[32:35]
    ds_read_b128 a[244:247], v29 offset:6144
    v_add_f32 v208, v208, v216
    v_mfma_f32_16x16x32_bf16 v[36:39], v[176:179], a[108:111], v[36:39]
    v_add_f32 v209, v209, v217
    v_mul_f32 v250, 0xbae38e39, v208
    v_mfma_f32_16x16x32_bf16 v[40:43], v[180:183], a[104:107], v[40:43]
    ds_read_b128 a[248:251], v29 offset:7168
    v_mul_f32 v240, 0x3ae38e39, v209
    v_mfma_f32_16x16x32_bf16 v[44:47], v[180:183], a[108:111], v[44:47]
    v_fma_f32 v240, -v250, v250, v240
    v_max_f32 v240, 0, v240
    v_mfma_f32_16x16x32_bf16 v[48:51], v[184:187], a[104:107], v[48:51]
    ds_read_b128 a[252:255], v29 offset:8192
    v_add_f32 v240, 0x3727c5ac, v240
    v_mfma_f32_16x16x32_bf16 v[52:55], v[184:187], a[108:111], v[52:55]
    v_sqrt_f32 v248, v240
    s_nop 0
    v_cvt_pk_bf16_f32 v9, v250, v248
    v_mfma_f32_16x16x32_bf16 v[56:59], v[188:191], a[104:107], v[56:59]
    ds_read_b128 v[176:179], v29 offset:9216
    v_lshlrev_b32 v240, 16, v9
    v_mfma_f32_16x16x32_bf16 v[60:63], v[188:191], a[108:111], v[60:63]
    v_and_b32 v241, s6, v9
    s_waitcnt lgkmcnt(6)
    v_mfma_f32_16x16x32_bf16 v[64:67], v[192:195], a[104:107], v[64:67]
    ds_read_b128 v[180:183], v29 offset:10240
    v_sub_f32 v242, v250, v240
    v_mfma_f32_16x16x32_bf16 v[68:71], v[192:195], a[108:111], v[68:71]
    v_sub_f32 v243, v248, v241
    v_cvt_pk_bf16_f32 v8, v240, v242
    v_mfma_f32_16x16x32_bf16 v[72:75], v[196:199], a[104:107], v[72:75]
    ds_read_b128 v[184:187], v29 offset:11264
    v_mfma_f32_16x16x32_bf16 v[76:79], v[196:199], a[108:111], v[76:79]
    v_cvt_pk_bf16_f32 v10, v243, v241
    v_cmp_eq_u32 vcc, 0, v7
    v_mfma_f32_16x16x32_bf16 v[80:83], v[200:203], a[104:107], v[80:83]
    ds_read_b128 v[188:191], v29 offset:12288
    v_mfma_f32_16x16x32_bf16 v[84:87], v[200:203], a[108:111], v[84:87]
    v_mov_b32 v11, 0
    v_cndmask_b32 v8, 0, v8, vcc
    v_mfma_f32_16x16x32_bf16 v[88:91], v[204:207], a[104:107], v[88:91]
    ds_read_b128 v[192:195], v29 offset:13312
    v_mfma_f32_16x16x32_bf16 v[92:95], v[204:207], a[108:111], v[92:95]
    v_cndmask_b32 v9, 0, v9, vcc
    s_waitcnt lgkmcnt(6)
    v_mfma_f32_16x16x32_bf16 v[32:35], v[244:247], a[112:115], v[32:35]
    ds_read_b128 v[196:199], v29 offset:14336
    v_mfma_f32_16x16x32_bf16 v[36:39], v[244:247], a[116:119], v[36:39]
    v_cndmask_b32 v10, 0, v10, vcc
    buffer_load_dwordx4 v26, s[8:11], s69 offen offset:1024 lds
    v_mfma_f32_16x16x32_bf16 v[40:43], a[240:243], a[112:115], v[40:43]
    ds_read_b128 v[200:203], v29 offset:15360
    v_mfma_f32_16x16x32_bf16 v[44:47], a[240:243], a[116:119], v[44:47]
    buffer_load_dwordx4 v26, s[8:11], s69 offen offset:2048 lds
    buffer_store_dwordx4 a[172:175], v254, s[8:11], 0 offen sc1
    v_mfma_f32_16x16x32_bf16 v[48:51], a[244:247], a[112:115], v[48:51]
    ds_read_b128 v[204:207], v29 offset:16384
    v_mfma_f32_16x16x32_bf16 v[52:55], a[244:247], a[116:119], v[52:55]
    buffer_load_dwordx4 v26, s[8:11], s69 offen offset:3072 lds
    s_add_u32 s69, s69, 4096
    v_mfma_f32_16x16x32_bf16 v[56:59], a[248:251], a[112:115], v[56:59]
    ds_read_b128 v[244:247], v29 offset:17408
    v_mfma_f32_16x16x32_bf16 v[60:63], a[248:251], a[116:119], v[60:63]
    s_add_u32 m0, s26, 40960
    s_waitcnt lgkmcnt(6)
    v_mfma_f32_16x16x32_bf16 v[64:67], a[252:255], a[112:115], v[64:67]
    ds_read_b128 a[240:243], v29 offset:18432
    buffer_load_dwordx4 v26, s[8:11], s69 offen offset:0 lds
    v_mfma_f32_16x16x32_bf16 v[68:71], a[252:255], a[116:119], v[68:71]
    buffer_store_dwordx4 a[176:179], v255, s[8:11], 0 offen sc1
    buffer_load_dwordx4 v26, s[8:11], s69 offen offset:1024 lds
    v_mfma_f32_16x16x32_bf16 v[72:75], v[176:179], a[112:115], v[72:75]
    ds_read_b128 a[244:247], v29 offset:19456
    v_add_f32 v220, v220, v222
    v_mfma_f32_16x16x32_bf16 v[76:79], v[176:179], a[116:119], v[76:79]
    v_add_f32 v221, v221, v223
    v_add_f32 v224, v224, v226
    v_mfma_f32_16x16x32_bf16 v[80:83], v[180:183], a[112:115], v[80:83]
    ds_read_b128 a[248:251], v29 offset:20480
    v_add_f32 v225, v225, v227
    v_mfma_f32_16x16x32_bf16 v[84:87], v[180:183], a[116:119], v[84:87]
    v_add_f32 v228, v228, v230
    v_add_f32 v229, v229, v231
    v_mfma_f32_16x16x32_bf16 v[88:91], v[184:187], a[112:115], v[88:91]
    ds_read_b128 a[252:255], v29 offset:21504
    v_add_f32 v220, v220, v224
    v_mfma_f32_16x16x32_bf16 v[92:95], v[184:187], a[116:119], v[92:95]
    v_add_f32 v221, v221, v225
    s_waitcnt vmcnt(26)
    s_waitcnt lgkmcnt(6)
    v_mfma_f32_16x16x32_bf16 v[32:35], v[188:191], a[120:123], v[32:35]
    ds_read_b128 v[176:179], v29 offset:22528
    v_add_f32 v220, v220, v228
    v_mfma_f32_16x16x32_bf16 v[36:39], v[188:191], a[124:127], v[36:39]
    v_add_f32 v221, v221, v229
    v_mul_f32 v251, 0xbae38e39, v220
    v_mfma_f32_16x16x32_bf16 v[40:43], v[192:195], a[120:123], v[40:43]
    ds_read_b128 v[180:183], v29 offset:23552
    v_mul_f32 v240, 0x3ae38e39, v221
    v_mfma_f32_16x16x32_bf16 v[44:47], v[192:195], a[124:127], v[44:47]
    v_fma_f32 v240, -v251, v251, v240
    v_max_f32 v240, 0, v240
    v_mfma_f32_16x16x32_bf16 v[48:51], v[196:199], a[120:123], v[48:51]
    ds_read_b128 v[184:187], v29 offset:24576
    v_add_f32 v240, 0x3727c5ac, v240
    v_mfma_f32_16x16x32_bf16 v[52:55], v[196:199], a[124:127], v[52:55]
    v_sqrt_f32 v249, v240
    s_nop 0
    v_cvt_pk_bf16_f32 v13, v251, v249
    v_mfma_f32_16x16x32_bf16 v[56:59], v[200:203], a[120:123], v[56:59]
    ds_read_b128 v[188:191], v29 offset:25600
    v_lshlrev_b32 v240, 16, v13
    v_mfma_f32_16x16x32_bf16 v[60:63], v[200:203], a[124:127], v[60:63]
    v_and_b32 v241, s6, v13
    s_waitcnt lgkmcnt(6)
    v_mfma_f32_16x16x32_bf16 v[64:67], v[204:207], a[120:123], v[64:67]
    ds_read_b128 v[192:195], v29 offset:26624
    v_sub_f32 v242, v251, v240
    v_mfma_f32_16x16x32_bf16 v[68:71], v[204:207], a[124:127], v[68:71]
    v_sub_f32 v243, v249, v241
    v_cvt_pk_bf16_f32 v12, v240, v242
    v_mfma_f32_16x16x32_bf16 v[72:75], v[244:247], a[120:123], v[72:75]
    ds_read_b128 v[196:199], v29 offset:27648
    v_cvt_pk_bf16_f32 v14, v243, v241
    v_mfma_f32_16x16x32_bf16 v[76:79], v[244:247], a[124:127], v[76:79]
    v_cmp_eq_u32 vcc, 0, v7
    v_mov_b32 v15, 0
    v_mfma_f32_16x16x32_bf16 v[80:83], a[240:243], a[120:123], v[80:83]
    ds_read_b128 v[200:203], v29 offset:28672
    v_mfma_f32_16x16x32_bf16 v[84:87], a[240:243], a[124:127], v[84:87]
    v_cndmask_b32 v12, 0, v12, vcc
    v_cndmask_b32 v13, 0, v13, vcc
    v_mfma_f32_16x16x32_bf16 v[88:91], a[244:247], a[120:123], v[88:91]
    ds_read_b128 v[204:207], v29 offset:29696
    v_mfma_f32_16x16x32_bf16 v[92:95], a[244:247], a[124:127], v[92:95]
    v_cndmask_b32 v14, 0, v14, vcc
    s_waitcnt vmcnt(20)
    s_waitcnt lgkmcnt(6)
    v_mfma_f32_16x16x32_bf16 v[32:35], a[248:251], a[128:131], v[32:35]
    ds_read_b128 v[244:247], v29 offset:30720
    v_mfma_f32_16x16x32_bf16 v[36:39], a[248:251], a[132:135], v[36:39]
    buffer_load_dwordx4 v26, s[8:11], s69 offen offset:2048 lds
    buffer_load_dwordx4 v26, s[8:11], s69 offen offset:3072 lds
    v_mfma_f32_16x16x32_bf16 v[40:43], a[252:255], a[128:131], v[40:43]
    ds_read_b128 a[240:243], v29 offset:31744
    v_mfma_f32_16x16x32_bf16 v[44:47], a[252:255], a[132:135], v[44:47]
    s_add_u32 s69, s69, 4096
    s_add_u32 m0, s26, 45056
    v_mfma_f32_16x16x32_bf16 v[48:51], v[176:179], a[128:131], v[48:51]
    ds_read_b128 a[244:247], v29 offset:32768
    v_mfma_f32_16x16x32_bf16 v[52:55], v[176:179], a[132:135], v[52:55]
    buffer_load_dwordx4 v26, s[8:11], s69 offen offset:0 lds
    v_mfma_f32_16x16x32_bf16 v[56:59], v[180:183], a[128:131], v[56:59]
    ds_read_b128 a[248:251], v29 offset:33792
    v_mfma_f32_16x16x32_bf16 v[60:63], v[180:183], a[132:135], v[60:63]
    s_waitcnt lgkmcnt(6)
    v_mfma_f32_16x16x32_bf16 v[64:67], v[184:187], a[128:131], v[64:67]
    ds_read_b128 a[252:255], v29 offset:34816
    v_mfma_f32_16x16x32_bf16 v[68:71], v[184:187], a[132:135], v[68:71]
    v_mfma_f32_16x16x32_bf16 v[72:75], v[188:191], a[128:131], v[72:75]
    ds_read_b128 v[176:179], v29 offset:35840
    v_mfma_f32_16x16x32_bf16 v[76:79], v[188:191], a[132:135], v[76:79]
    v_mfma_f32_16x16x32_bf16 v[80:83], v[192:195], a[128:131], v[80:83]
    ds_read_b128 v[180:183], v31 offset:0
    v_mfma_f32_16x16x32_bf16 v[84:87], v[192:195], a[132:135], v[84:87]
    v_mfma_f32_16x16x32_bf16 v[88:91], v[196:199], a[128:131], v[88:91]
    ds_read_b128 v[184:187], v31 offset:256
    v_mfma_f32_16x16x32_bf16 v[92:95], v[196:199], a[132:135], v[92:95]
    s_waitcnt vmcnt(18)
    s_waitcnt lgkmcnt(6)
    v_mfma_f32_16x16x32_bf16 v[32:35], v[200:203], a[136:139], v[32:35]
    ds_read_b128 v[188:191], v31 offset:512
    v_mfma_f32_16x16x32_bf16 v[36:39], v[200:203], a[140:143], v[36:39]
    v_mfma_f32_16x16x32_bf16 v[40:43], v[204:207], a[136:139], v[40:43]
    ds_read_b128 v[192:195], v31 offset:768
    v_mfma_f32_16x16x32_bf16 v[44:47], v[204:207], a[140:143], v[44:47]
    v_mfma_f32_16x16x32_bf16 v[48:51], v[244:247], a[136:139], v[48:51]
    ds_read_b128 v[196:199], v31 offset:1024
    v_mfma_f32_16x16x32_bf16 v[52:55], v[244:247], a[140:143], v[52:55]
    v_mfma_f32_16x16x32_bf16 v[56:59], a[240:243], a[136:139], v[56:59]
    ds_read_b128 v[200:203], v31 offset:1280
    v_mfma_f32_16x16x32_bf16 v[60:63], a[240:243], a[140:143], v[60:63]
    s_waitcnt lgkmcnt(6)
    v_mfma_f32_16x16x32_bf16 v[64:67], a[244:247], a[136:139], v[64:67]
    ds_read_b128 v[204:207], v31 offset:1536
    v_mfma_f32_16x16x32_bf16 v[68:71], a[244:247], a[140:143], v[68:71]
    v_mfma_f32_16x16x32_bf16 v[72:75], a[248:251], a[136:139], v[72:75]
    ds_read_b128 v[244:247], v31 offset:1792
    v_mfma_f32_16x16x32_bf16 v[76:79], a[248:251], a[140:143], v[76:79]
    v_mfma_f32_16x16x32_bf16 v[80:83], a[252:255], a[136:139], v[80:83]
    s_waitcnt vmcnt(13)
    s_barrier
    ds_read_b128 a[240:243], v26 offset:0
    v_mfma_f32_16x16x32_bf16 v[84:87], a[252:255], a[140:143], v[84:87]
    v_mfma_f32_16x16x32_bf16 v[88:91], v[176:179], a[136:139], v[88:91]
    ds_read_b128 a[244:247], v26 offset:1024
    v_mfma_f32_16x16x32_bf16 v[92:95], v[176:179], a[140:143], v[92:95]
    s_add_u32 s68, s30, 221184
    s_waitcnt lgkmcnt(6)
    v_mfma_f32_16x16x32_bf16 v[32:35], v[180:183], v[8:11], v[32:35]
    ds_read_b128 a[248:251], v26 offset:2048
    v_mfma_f32_16x16x32_bf16 v[36:39], v[180:183], v[12:15], v[36:39]
    s_add_u32 m0, s26, 73728
    s_nop 0
    buffer_load_dwordx4 v26, s[8:11], s68 offen offset:0 lds
    v_mfma_f32_16x16x32_bf16 v[40:43], v[184:187], v[8:11], v[40:43]
    ds_read_b128 a[252:255], v26 offset:3072
    v_mfma_f32_16x16x32_bf16 v[44:47], v[184:187], v[12:15], v[44:47]
    v_mfma_f32_16x16x32_bf16 v[48:51], v[188:191], v[8:11], v[48:51]
    ds_read_b128 v[176:179], v26 offset:4096
    v_mfma_f32_16x16x32_bf16 v[52:55], v[188:191], v[12:15], v[52:55]
    buffer_load_dwordx4 v26, s[8:11], s68 offen offset:1024 lds
    v_mfma_f32_16x16x32_bf16 v[56:59], v[192:195], v[8:11], v[56:59]
    ds_read_b128 v[180:183], v26 offset:5120
    v_mfma_f32_16x16x32_bf16 v[60:63], v[192:195], v[12:15], v[60:63]
    s_waitcnt lgkmcnt(6)
    v_mfma_f32_16x16x32_bf16 v[64:67], v[196:199], v[8:11], v[64:67]
    ds_read_b128 v[184:187], v26 offset:6144
    v_mfma_f32_16x16x32_bf16 v[68:71], v[196:199], v[12:15], v[68:71]
    v_mfma_f32_16x16x32_bf16 v[72:75], v[200:203], v[8:11], v[72:75]
    ds_read_b128 v[188:191], v26 offset:7168
    v_mfma_f32_16x16x32_bf16 v[76:79], v[200:203], v[12:15], v[76:79]
    buffer_load_dwordx4 v26, s[8:11], s68 offen offset:2048 lds
    v_mfma_f32_16x16x32_bf16 v[80:83], v[204:207], v[8:11], v[80:83]
    ds_read_b128 v[192:195], v26 offset:8192
    v_mfma_f32_16x16x32_bf16 v[84:87], v[204:207], v[12:15], v[84:87]
    v_cvt_pk_bf16_f32 v32, v32, v33
    v_cvt_pk_bf16_f32 v33, v34, v35
    v_mfma_f32_16x16x32_bf16 v[88:91], v[244:247], v[8:11], v[88:91]
    ds_read_b128 v[196:199], v26 offset:9216
    v_mfma_f32_16x16x32_bf16 v[92:95], v[244:247], v[12:15], v[92:95]
    v_cvt_pk_bf16_f32 v34, v40, v41
    s_waitcnt lgkmcnt(6)
    v_mfma_f32_16x16x32_bf16 v[96:99], a[240:243], a[0:3], 0
    ds_read_b128 v[200:203], v26 offset:10240
    v_mfma_f32_16x16x32_bf16 v[100:103], a[240:243], a[4:7], 0
    v_cvt_pk_bf16_f32 v35, v42, v43
    v_pk_max_i16 v32, v32, 0
    v_mfma_f32_16x16x32_bf16 v[104:107], a[244:247], a[0:3], 0
    ds_read_b128 v[204:207], v26 offset:11264
    v_mfma_f32_16x16x32_bf16 v[108:111], a[244:247], a[4:7], 0
    v_pk_max_i16 v33, v33, 0
    v_pk_max_i16 v34, v34, 0
    v_mfma_f32_16x16x32_bf16 v[112:115], a[248:251], a[0:3], 0
    ds_read_b128 v[244:247], v26 offset:12288
    v_mfma_f32_16x16x32_bf16 v[116:119], a[248:251], a[4:7], 0
    v_pk_max_i16 v35, v35, 0
    buffer_store_dwordx4 v[32:35], v26, s[32:35], s50 offen offset:0 sc1
    v_mfma_f32_16x16x32_bf16 v[120:123], a[252:255], a[0:3], 0
    ds_read_b128 a[240:243], v26 offset:13312
    v_mfma_f32_16x16x32_bf16 v[124:127], a[252:255], a[4:7], 0
    buffer_load_dwordx4 v26, s[8:11], s68 offen offset:3072 lds
    s_waitcnt lgkmcnt(6)
    v_mfma_f32_16x16x32_bf16 v[128:131], v[176:179], a[0:3], 0
    ds_read_b128 a[244:247], v26 offset:14336
    s_add_u32 s68, s68, 4096
    v_mfma_f32_16x16x32_bf16 v[132:135], v[176:179], a[4:7], 0
    s_add_u32 m0, s26, 77824
    s_nop 0
    buffer_load_dwordx4 v26, s[8:11], s68 offen offset:0 lds
    v_mfma_f32_16x16x32_bf16 v[136:139], v[180:183], a[0:3], 0
    ds_read_b128 a[248:251], v26 offset:15360
    v_mfma_f32_16x16x32_bf16 v[140:143], v[180:183], a[4:7], 0
    v_cvt_pk_bf16_f32 v36, v36, v37
    v_cvt_pk_bf16_f32 v37, v38, v39
    v_mfma_f32_16x16x32_bf16 v[96:99], v[184:187], a[8:11], v[96:99]
    ds_read_b128 a[252:255], v26 offset:16384
    v_mfma_f32_16x16x32_bf16 v[100:103], v[184:187], a[12:15], v[100:103]
    v_cvt_pk_bf16_f32 v38, v44, v45
    v_cvt_pk_bf16_f32 v39, v46, v47
    v_mfma_f32_16x16x32_bf16 v[104:107], v[188:191], a[8:11], v[104:107]
    ds_read_b128 v[176:179], v26 offset:17408
    v_mfma_f32_16x16x32_bf16 v[108:111], v[188:191], a[12:15], v[108:111]
    v_pk_max_i16 v36, v36, 0
    s_waitcnt lgkmcnt(6)
    v_mfma_f32_16x16x32_bf16 v[112:115], v[192:195], a[8:11], v[112:115]
    ds_read_b128 v[180:183], v26 offset:18432
    v_mfma_f32_16x16x32_bf16 v[116:119], v[192:195], a[12:15], v[116:119]
    v_pk_max_i16 v37, v37, 0
    v_pk_max_i16 v38, v38, 0
    v_mfma_f32_16x16x32_bf16 v[120:123], v[196:199], a[8:11], v[120:123]
    ds_read_b128 v[184:187], v26 offset:19456
    v_mfma_f32_16x16x32_bf16 v[124:127], v[196:199], a[12:15], v[124:127]
    v_pk_max_i16 v39, v39, 0
    buffer_store_dwordx4 v[36:39], v26, s[32:35], s51 offen offset:0 sc1
    v_mfma_f32_16x16x32_bf16 v[128:131], v[200:203], a[8:11], v[128:131]
    ds_read_b128 v[188:191], v26 offset:20480
    buffer_load_dwordx4 v26, s[8:11], s68 offen offset:1024 lds
    v_mfma_f32_16x16x32_bf16 v[132:135], v[200:203], a[12:15], v[132:135]
    s_waitcnt vmcnt(12)
    buffer_store_dword v3, off, s[36:39], s3 sc1
    v_mfma_f32_16x16x32_bf16 v[136:139], v[204:207], a[8:11], v[136:139]
    ds_read_b128 v[192:195], v26 offset:21504
    buffer_store_dword v3, off, s[36:39], s101 sc1
    v_mfma_f32_16x16x32_bf16 v[140:143], v[204:207], a[12:15], v[140:143]
    v_cvt_pk_bf16_f32 v48, v48, v49
    s_waitcnt lgkmcnt(6)
    v_mfma_f32_16x16x32_bf16 v[96:99], v[244:247], a[16:19], v[96:99]
    ds_read_b128 v[196:199], v26 offset:22528
    v_mfma_f32_16x16x32_bf16 v[100:103], v[244:247], a[20:23], v[100:103]
    v_cvt_pk_bf16_f32 v49, v50, v51
    v_cvt_pk_bf16_f32 v50, v56, v57
    v_mfma_f32_16x16x32_bf16 v[104:107], a[240:243], a[16:19], v[104:107]
    ds_read_b128 v[200:203], v26 offset:23552
    v_mfma_f32_16x16x32_bf16 v[108:111], a[240:243], a[20:23], v[108:111]
    v_cvt_pk_bf16_f32 v51, v58, v59
    v_pk_max_i16 v48, v48, 0
    v_mfma_f32_16x16x32_bf16 v[112:115], a[244:247], a[16:19], v[112:115]
    ds_read_b128 v[204:207], v26 offset:24576
    v_mfma_f32_16x16x32_bf16 v[116:119], a[244:247], a[20:23], v[116:119]
    v_pk_max_i16 v49, v49, 0
    v_pk_max_i16 v50, v50, 0
    v_mfma_f32_16x16x32_bf16 v[120:123], a[248:251], a[16:19], v[120:123]
    ds_read_b128 v[244:247], v26 offset:25600
    v_mfma_f32_16x16x32_bf16 v[124:127], a[248:251], a[20:23], v[124:127]
    v_pk_max_i16 v51, v51, 0
    s_waitcnt lgkmcnt(6)
    v_mfma_f32_16x16x32_bf16 v[128:131], a[252:255], a[16:19], v[128:131]
    ds_read_b128 a[240:243], v26 offset:26624
    buffer_store_dwordx4 v[48:51], v26, s[32:35], s50 offen offset:1024 sc1
    v_mfma_f32_16x16x32_bf16 v[132:135], a[252:255], a[20:23], v[132:135]
    buffer_load_dwordx4 v26, s[8:11], s68 offen offset:2048 lds
    buffer_load_dwordx4 v26, s[8:11], s68 offen offset:3072 lds
    v_mfma_f32_16x16x32_bf16 v[136:139], v[176:179], a[16:19], v[136:139]
    ds_read_b128 a[244:247], v26 offset:27648
    v_cvt_pk_bf16_f32 v52, v52, v53
    v_mfma_f32_16x16x32_bf16 v[140:143], v[176:179], a[20:23], v[140:143]
    v_cvt_pk_bf16_f32 v53, v54, v55
    v_cvt_pk_bf16_f32 v54, v60, v61
    v_mfma_f32_16x16x32_bf16 v[96:99], v[180:183], a[24:27], v[96:99]
    ds_read_b128 a[248:251], v26 offset:28672
    v_mfma_f32_16x16x32_bf16 v[100:103], v[180:183], a[28:31], v[100:103]
    v_cvt_pk_bf16_f32 v55, v62, v63
    v_pk_max_i16 v52, v52, 0
    v_mfma_f32_16x16x32_bf16 v[104:107], v[184:187], a[24:27], v[104:107]
    ds_read_b128 a[252:255], v26 offset:29696
    v_mfma_f32_16x16x32_bf16 v[108:111], v[184:187], a[28:31], v[108:111]
    v_pk_max_i16 v53, v53, 0
    s_waitcnt lgkmcnt(6)
    v_mfma_f32_16x16x32_bf16 v[112:115], v[188:191], a[24:27], v[112:115]
    ds_read_b128 v[176:179], v26 offset:30720
    v_mfma_f32_16x16x32_bf16 v[116:119], v[188:191], a[28:31], v[116:119]
    v_pk_max_i16 v54, v54, 0
    v_pk_max_i16 v55, v55, 0
    v_mfma_f32_16x16x32_bf16 v[120:123], v[192:195], a[24:27], v[120:123]
    ds_read_b128 v[180:183], v26 offset:31744
    v_mfma_f32_16x16x32_bf16 v[124:127], v[192:195], a[28:31], v[124:127]
    buffer_store_dwordx4 v[52:55], v26, s[32:35], s51 offen offset:1024 sc1
    s_add_u32 s68, s68, 4096
    v_mfma_f32_16x16x32_bf16 v[128:131], v[196:199], a[24:27], v[128:131]
    ds_read_b128 v[184:187], v26 offset:32768
    s_add_u32 m0, s26, 81920
    v_mfma_f32_16x16x32_bf16 v[132:135], v[196:199], a[28:31], v[132:135]
    buffer_load_dwordx4 v26, s[8:11], s68 offen offset:0 lds
    v_cvt_pk_bf16_f32 v64, v64, v65
    v_mfma_f32_16x16x32_bf16 v[136:139], v[200:203], a[24:27], v[136:139]
    ds_read_b128 v[188:191], v26 offset:33792
    v_mfma_f32_16x16x32_bf16 v[140:143], v[200:203], a[28:31], v[140:143]
    v_cvt_pk_bf16_f32 v65, v66, v67
    s_waitcnt lgkmcnt(6)
    v_mfma_f32_16x16x32_bf16 v[96:99], v[204:207], a[32:35], v[96:99]
    ds_read_b128 v[192:195], v26 offset:34816
    v_mfma_f32_16x16x32_bf16 v[100:103], v[204:207], a[36:39], v[100:103]
    v_cvt_pk_bf16_f32 v66, v72, v73
    v_cvt_pk_bf16_f32 v67, v74, v75
    v_mfma_f32_16x16x32_bf16 v[104:107], v[244:247], a[32:35], v[104:107]
    ds_read_b128 v[196:199], v26 offset:35840
    v_mfma_f32_16x16x32_bf16 v[108:111], v[244:247], a[36:39], v[108:111]
    v_pk_max_i16 v64, v64, 0
    v_pk_max_i16 v65, v65, 0
    v_mfma_f32_16x16x32_bf16 v[112:115], a[240:243], a[32:35], v[112:115]
    s_waitcnt vmcnt(15)
    s_barrier
    ds_read_b128 v[200:203], v27 offset:0
    v_mfma_f32_16x16x32_bf16 v[116:119], a[240:243], a[36:39], v[116:119]
    v_pk_max_i16 v66, v66, 0
    v_pk_max_i16 v67, v67, 0
    v_mfma_f32_16x16x32_bf16 v[120:123], a[244:247], a[32:35], v[120:123]
    ds_read_b128 v[204:207], v27 offset:1024
    v_mfma_f32_16x16x32_bf16 v[124:127], a[244:247], a[36:39], v[124:127]
    buffer_store_dwordx4 v[64:67], v26, s[32:35], s50 offen offset:2048 sc1
    s_waitcnt lgkmcnt(6)
    v_mfma_f32_16x16x32_bf16 v[128:131], a[248:251], a[32:35], v[128:131]
    ds_read_b128 v[244:247], v27 offset:2048
    s_add_u32 s69, s30, 258048
    v_mfma_f32_16x16x32_bf16 v[132:135], a[248:251], a[36:39], v[132:135]
    s_add_u32 m0, s26, 110592
    s_nop 0
    buffer_load_dwordx4 v26, s[8:11], s69 offen offset:0 lds
    v_mfma_f32_16x16x32_bf16 v[136:139], a[252:255], a[32:35], v[136:139]
    ds_read_b128 a[240:243], v27 offset:3072
    v_mfma_f32_16x16x32_bf16 v[140:143], a[252:255], a[36:39], v[140:143]
    v_cvt_pk_bf16_f32 v68, v68, v69
    v_cvt_pk_bf16_f32 v69, v70, v71
    v_mfma_f32_16x16x32_bf16 v[96:99], v[176:179], a[40:43], v[96:99]
    ds_read_b128 a[244:247], v27 offset:4096
    v_mfma_f32_16x16x32_bf16 v[100:103], v[176:179], a[44:47], v[100:103]
    v_cvt_pk_bf16_f32 v70, v76, v77
    v_cvt_pk_bf16_f32 v71, v78, v79
    v_mfma_f32_16x16x32_bf16 v[104:107], v[180:183], a[40:43], v[104:107]
    ds_read_b128 a[248:251], v27 offset:5120
    v_mfma_f32_16x16x32_bf16 v[108:111], v[180:183], a[44:47], v[108:111]
    v_pk_max_i16 v68, v68, 0
    s_waitcnt lgkmcnt(6)
    v_mfma_f32_16x16x32_bf16 v[112:115], v[184:187], a[40:43], v[112:115]
    ds_read_b128 a[252:255], v27 offset:6144
    v_mfma_f32_16x16x32_bf16 v[116:119], v[184:187], a[44:47], v[116:119]
    v_pk_max_i16 v69, v69, 0
    v_pk_max_i16 v70, v70, 0
    v_mfma_f32_16x16x32_bf16 v[120:123], v[188:191], a[40:43], v[120:123]
    ds_read_b128 v[176:179], v27 offset:7168
    v_mfma_f32_16x16x32_bf16 v[124:127], v[188:191], a[44:47], v[124:127]
    v_pk_max_i16 v71, v71, 0
    buffer_store_dwordx4 v[68:71], v26, s[32:35], s51 offen offset:2048 sc1
    v_mfma_f32_16x16x32_bf16 v[128:131], v[192:195], a[40:43], v[128:131]
    ds_read_b128 v[180:183], v27 offset:8192
    buffer_load_dwordx4 v26, s[8:11], s69 offen offset:1024 lds
    v_mfma_f32_16x16x32_bf16 v[132:135], v[192:195], a[44:47], v[132:135]
    buffer_load_dwordx4 v26, s[8:11], s69 offen offset:2048 lds
    v_cvt_pk_bf16_f32 v80, v80, v81
    v_mfma_f32_16x16x32_bf16 v[136:139], v[196:199], a[40:43], v[136:139]
    ds_read_b128 v[184:187], v27 offset:9216
    v_mfma_f32_16x16x32_bf16 v[140:143], v[196:199], a[44:47], v[140:143]
    v_cvt_pk_bf16_f32 v81, v82, v83
    s_waitcnt lgkmcnt(6)
    v_mfma_f32_16x16x32_bf16 v[96:99], v[200:203], a[48:51], v[96:99]
    ds_read_b128 v[188:191], v27 offset:10240
    v_mfma_f32_16x16x32_bf16 v[100:103], v[200:203], a[52:55], v[100:103]
    v_cvt_pk_bf16_f32 v82, v88, v89
    v_cvt_pk_bf16_f32 v83, v90, v91
    v_mfma_f32_16x16x32_bf16 v[104:107], v[204:207], a[48:51], v[104:107]
    ds_read_b128 v[192:195], v27 offset:11264
    v_mfma_f32_16x16x32_bf16 v[108:111], v[204:207], a[52:55], v[108:111]
    v_pk_max_i16 v80, v80, 0
    v_pk_max_i16 v81, v81, 0
    v_mfma_f32_16x16x32_bf16 v[112:115], v[244:247], a[48:51], v[112:115]
    ds_read_b128 v[196:199], v27 offset:12288
    v_mfma_f32_16x16x32_bf16 v[116:119], v[244:247], a[52:55], v[116:119]
    v_pk_max_i16 v82, v82, 0
    v_pk_max_i16 v83, v83, 0
    v_mfma_f32_16x16x32_bf16 v[120:123], a[240:243], a[48:51], v[120:123]
    ds_read_b128 v[200:203], v27 offset:13312
    v_mfma_f32_16x16x32_bf16 v[124:127], a[240:243], a[52:55], v[124:127]
    buffer_store_dwordx4 v[80:83], v26, s[32:35], s50 offen offset:3072 sc1
    s_waitcnt lgkmcnt(6)
    v_mfma_f32_16x16x32_bf16 v[128:131], a[244:247], a[48:51], v[128:131]
    ds_read_b128 v[204:207], v27 offset:14336
    buffer_load_dwordx4 v26, s[8:11], s69 offen offset:3072 lds
    v_mfma_f32_16x16x32_bf16 v[132:135], a[244:247], a[52:55], v[132:135]
    s_add_u32 s69, s69, 4096
    s_add_u32 m0, s26, 114688
    v_mfma_f32_16x16x32_bf16 v[136:139], a[248:251], a[48:51], v[136:139]
    ds_read_b128 v[244:247], v27 offset:15360
    v_mfma_f32_16x16x32_bf16 v[140:143], a[248:251], a[52:55], v[140:143]
    buffer_load_dwordx4 v26, s[8:11], s69 offen offset:0 lds
    v_cvt_pk_bf16_f32 v84, v84, v85
    v_mfma_f32_16x16x32_bf16 v[96:99], a[252:255], a[56:59], v[96:99]
    ds_read_b128 a[240:243], v27 offset:16384
    v_mfma_f32_16x16x32_bf16 v[100:103], a[252:255], a[60:63], v[100:103]
    v_cvt_pk_bf16_f32 v85, v86, v87
    v_cvt_pk_bf16_f32 v86, v92, v93
    v_mfma_f32_16x16x32_bf16 v[104:107], v[176:179], a[56:59], v[104:107]
    ds_read_b128 a[244:247], v27 offset:17408
    v_mfma_f32_16x16x32_bf16 v[108:111], v[176:179], a[60:63], v[108:111]
    v_cvt_pk_bf16_f32 v87, v94, v95
    s_waitcnt lgkmcnt(6)
    v_mfma_f32_16x16x32_bf16 v[112:115], v[180:183], a[56:59], v[112:115]
    ds_read_b128 a[248:251], v27 offset:18432
    v_pk_max_i16 v84, v84, 0
    v_mfma_f32_16x16x32_bf16 v[116:119], v[180:183], a[60:63], v[116:119]
    v_pk_max_i16 v85, v85, 0
    v_pk_max_i16 v86, v86, 0
    v_mfma_f32_16x16x32_bf16 v[120:123], v[184:187], a[56:59], v[120:123]
    ds_read_b128 a[252:255], v27 offset:19456
    v_mfma_f32_16x16x32_bf16 v[124:127], v[184:187], a[60:63], v[124:127]
    v_pk_max_i16 v87, v87, 0
    buffer_store_dwordx4 v[84:87], v26, s[32:35], s51 offen offset:3072 sc1
    v_mfma_f32_16x16x32_bf16 v[128:131], v[188:191], a[56:59], v[128:131]
    ds_read_b128 v[176:179], v27 offset:20480
    v_mfma_f32_16x16x32_bf16 v[132:135], v[188:191], a[60:63], v[132:135]
    buffer_load_dwordx4 v26, s[8:11], s69 offen offset:1024 lds
    v_min_u32 v16, 35, v1
    v_mfma_f32_16x16x32_bf16 v[136:139], v[192:195], a[56:59], v[136:139]
    ds_read_b128 v[180:183], v27 offset:21504
    v_mfma_f32_16x16x32_bf16 v[140:143], v[192:195], a[60:63], v[140:143]
    v_lshlrev_b32 v16, 2, v16
    s_waitcnt lgkmcnt(6)
    v_mfma_f32_16x16x32_bf16 v[96:99], v[196:199], a[64:67], v[96:99]
    ds_read_b128 v[184:187], v27 offset:22528
    v_mfma_f32_16x16x32_bf16 v[100:103], v[196:199], a[68:71], v[100:103]
    s_lshl_b32 s3, s25, 8
    s_add_u32 s3, s3, 73984
    v_mfma_f32_16x16x32_bf16 v[104:107], v[200:203], a[64:67], v[104:107]
    ds_read_b128 v[188:191], v27 offset:23552
    v_mfma_f32_16x16x32_bf16 v[108:111], v[200:203], a[68:71], v[108:111]
    buffer_load_dword v252, v16, s[36:39], s3 offen offset:0 sc1
    buffer_load_dwordx4 v26, s[8:11], s69 offen offset:2048 lds
    v_mfma_f32_16x16x32_bf16 v[112:115], v[204:207], a[64:67], v[112:115]
    ds_read_b128 v[192:195], v27 offset:24576
    v_mfma_f32_16x16x32_bf16 v[116:119], v[204:207], a[68:71], v[116:119]
    buffer_load_dwordx4 v26, s[8:11], s69 offen offset:3072 lds
    v_mfma_f32_16x16x32_bf16 v[120:123], v[244:247], a[64:67], v[120:123]
    ds_read_b128 v[196:199], v27 offset:25600
    v_mfma_f32_16x16x32_bf16 v[124:127], v[244:247], a[68:71], v[124:127]
    s_waitcnt lgkmcnt(6)
    v_mfma_f32_16x16x32_bf16 v[128:131], a[240:243], a[64:67], v[128:131]
    ds_read_b128 v[200:203], v27 offset:26624
    v_mfma_f32_16x16x32_bf16 v[132:135], a[240:243], a[68:71], v[132:135]
    v_mfma_f32_16x16x32_bf16 v[136:139], a[244:247], a[64:67], v[136:139]
    ds_read_b128 v[204:207], v27 offset:27648
    v_mfma_f32_16x16x32_bf16 v[140:143], a[244:247], a[68:71], v[140:143]
    s_add_u32 s69, s69, 4096
    s_add_u32 m0, s26, 118784
    v_mfma_f32_16x16x32_bf16 v[96:99], a[248:251], a[72:75], v[96:99]
    ds_read_b128 v[244:247], v27 offset:28672
    v_mfma_f32_16x16x32_bf16 v[100:103], a[248:251], a[76:79], v[100:103]
    buffer_load_dwordx4 v26, s[8:11], s69 offen offset:0 lds
    v_mfma_f32_16x16x32_bf16 v[104:107], a[252:255], a[72:75], v[104:107]
    ds_read_b128 a[240:243], v27 offset:29696
    v_mfma_f32_16x16x32_bf16 v[108:111], a[252:255], a[76:79], v[108:111]
    s_waitcnt lgkmcnt(6)
    v_mfma_f32_16x16x32_bf16 v[112:115], v[176:179], a[72:75], v[112:115]
    ds_read_b128 a[244:247], v27 offset:30720
    v_mfma_f32_16x16x32_bf16 v[116:119], v[176:179], a[76:79], v[116:119]
    v_mfma_f32_16x16x32_bf16 v[120:123], v[180:183], a[72:75], v[120:123]
    ds_read_b128 a[248:251], v27 offset:31744
    v_mfma_f32_16x16x32_bf16 v[124:127], v[180:183], a[76:79], v[124:127]
    v_mfma_f32_16x16x32_bf16 v[128:131], v[184:187], a[72:75], v[128:131]
    ds_read_b128 a[252:255], v27 offset:32768
    v_mfma_f32_16x16x32_bf16 v[132:135], v[184:187], a[76:79], v[132:135]
    v_mfma_f32_16x16x32_bf16 v[136:139], v[188:191], a[72:75], v[136:139]
    ds_read_b128 v[176:179], v27 offset:33792
    v_mfma_f32_16x16x32_bf16 v[140:143], v[188:191], a[76:79], v[140:143]
    s_waitcnt lgkmcnt(6)
    v_mfma_f32_16x16x32_bf16 v[96:99], v[192:195], a[80:83], v[96:99]
    ds_read_b128 v[180:183], v27 offset:34816
    v_mfma_f32_16x16x32_bf16 v[100:103], v[192:195], a[84:87], v[100:103]
    v_mfma_f32_16x16x32_bf16 v[104:107], v[196:199], a[80:83], v[104:107]
    ds_read_b128 v[184:187], v27 offset:35840
    v_mfma_f32_16x16x32_bf16 v[108:111], v[196:199], a[84:87], v[108:111]
    v_mfma_f32_16x16x32_bf16 v[112:115], v[200:203], a[80:83], v[112:115]
    s_waitcnt vmcnt(14)
    s_barrier
    ds_read_b128 v[188:191], v28 offset:0
    v_mfma_f32_16x16x32_bf16 v[116:119], v[200:203], a[84:87], v[116:119]
    v_mfma_f32_16x16x32_bf16 v[120:123], v[204:207], a[80:83], v[120:123]
    ds_read_b128 v[192:195], v28 offset:1024
    v_mfma_f32_16x16x32_bf16 v[124:127], v[204:207], a[84:87], v[124:127]
    s_add_u32 s68, s30, 294912
    s_waitcnt lgkmcnt(6)
    v_mfma_f32_16x16x32_bf16 v[128:131], v[244:247], a[80:83], v[128:131]
    ds_read_b128 v[196:199], v28 offset:2048
    v_mfma_f32_16x16x32_bf16 v[132:135], v[244:247], a[84:87], v[132:135]
    s_add_u32 m0, s26, 0
    s_nop 0
    buffer_load_dwordx4 v26, s[8:11], s68 offen offset:0 lds
    v_mfma_f32_16x16x32_bf16 v[136:139], a[240:243], a[80:83], v[136:139]
    ds_read_b128 v[200:203], v28 offset:3072
    v_mfma_f32_16x16x32_bf16 v[140:143], a[240:243], a[84:87], v[140:143]
    v_mfma_f32_16x16x32_bf16 v[96:99], a[244:247], a[88:91], v[96:99]
    ds_read_b128 v[204:207], v28 offset:4096
    v_mfma_f32_16x16x32_bf16 v[100:103], a[244:247], a[92:95], v[100:103]
    buffer_load_dwordx4 v26, s[8:11], s68 offen offset:1024 lds
    v_mfma_f32_16x16x32_bf16 v[104:107], a[248:251], a[88:91], v[104:107]
    ds_read_b128 v[244:247], v28 offset:5120
    v_mfma_f32_16x16x32_bf16 v[108:111], a[248:251], a[92:95], v[108:111]
    s_waitcnt lgkmcnt(6)
    v_mfma_f32_16x16x32_bf16 v[112:115], a[252:255], a[88:91], v[112:115]
    ds_read_b128 a[240:243], v28 offset:6144
    v_mfma_f32_16x16x32_bf16 v[116:119], a[252:255], a[92:95], v[116:119]
    v_mfma_f32_16x16x32_bf16 v[120:123], v[176:179], a[88:91], v[120:123]
    ds_read_b128 a[244:247], v28 offset:7168
    v_mfma_f32_16x16x32_bf16 v[124:127], v[176:179], a[92:95], v[124:127]
    buffer_load_dwordx4 v26, s[8:11], s68 offen offset:2048 lds
    v_mfma_f32_16x16x32_bf16 v[128:131], v[180:183], a[88:91], v[128:131]
    ds_read_b128 a[248:251], v28 offset:8192
    v_mfma_f32_16x16x32_bf16 v[132:135], v[180:183], a[92:95], v[132:135]
    v_mfma_f32_16x16x32_bf16 v[136:139], v[184:187], a[88:91], v[136:139]
    ds_read_b128 a[252:255], v28 offset:9216
    v_mfma_f32_16x16x32_bf16 v[140:143], v[184:187], a[92:95], v[140:143]
    s_waitcnt lgkmcnt(6)
    v_mfma_f32_16x16x32_bf16 v[96:99], v[188:191], a[96:99], v[96:99]
    ds_read_b128 v[176:179], v28 offset:10240
    v_mfma_f32_16x16x32_bf16 v[100:103], v[188:191], a[100:103], v[100:103]
    v_mfma_f32_16x16x32_bf16 v[104:107], v[192:195], a[96:99], v[104:107]
    ds_read_b128 v[180:183], v28 offset:11264
    v_mfma_f32_16x16x32_bf16 v[108:111], v[192:195], a[100:103], v[108:111]
    buffer_load_dwordx4 v26, s[8:11], s68 offen offset:3072 lds
    v_mfma_f32_16x16x32_bf16 v[112:115], v[196:199], a[96:99], v[112:115]
    ds_read_b128 v[184:187], v28 offset:12288
    v_mfma_f32_16x16x32_bf16 v[116:119], v[196:199], a[100:103], v[116:119]
    s_waitcnt vmcnt(7)
    s_mov_b32 s67, 400000
ffn_pc2:
    v_cmp_eq_u32 vcc, 1, v252
    s_nop 0
    s_cmp_eq_u64 vcc, exec
    s_cbranch_scc1 ffn_ok2
    s_sub_u32 s67, s67, 1
    s_cbranch_scc1 ffn_ok2
    s_sleep 1
    buffer_load_dword v252, v16, s[36:39], s3 offen offset:0 sc1
    s_waitcnt vmcnt(0)
    s_branch ffn_pc2
ffn_ok2:
    v_mfma_f32_16x16x32_bf16 v[120:123], v[200:203], a[96:99], v[120:123]
    ds_read_b128 v[188:191], v28 offset:13312
    v_mfma_f32_16x16x32_bf16 v[124:127], v[200:203], a[100:103], v[124:127]
    s_waitcnt lgkmcnt(6)
    v_mfma_f32_16x16x32_bf16 v[128:131], v[204:207], a[96:99], v[128:131]
    ds_read_b128 v[192:195], v28 offset:14336
    v_mfma_f32_16x16x32_bf16 v[132:135], v[204:207], a[100:103], v[132:135]
    s_add_u32 s68, s68, 4096
    s_add_u32 m0, s26, 4096
    v_mfma_f32_16x16x32_bf16 v[136:139], v[244:247], a[96:99], v[136:139]
    ds_read_b128 v[196:199], v28 offset:15360
    v_mfma_f32_16x16x32_bf16 v[140:143], v[244:247], a[100:103], v[140:143]
    buffer_load_dwordx4 v26, s[8:11], s68 offen offset:0 lds
    v_mfma_f32_16x16x32_bf16 v[96:99], a[240:243], a[104:107], v[96:99]
    ds_read_b128 v[200:203], v28 offset:16384
    v_mfma_f32_16x16x32_bf16 v[100:103], a[240:243], a[108:111], v[100:103]
    v_mfma_f32_16x16x32_bf16 v[104:107], a[244:247], a[104:107], v[104:107]
    ds_read_b128 v[204:207], v28 offset:17408
    v_mfma_f32_16x16x32_bf16 v[108:111], a[244:247], a[108:111], v[108:111]
    buffer_load_dwordx4 v26, s[8:11], s68 offen offset:1024 lds
    s_waitcnt lgkmcnt(6)
    v_mfma_f32_16x16x32_bf16 v[112:115], a[248:251], a[104:107], v[112:115]
    ds_read_b128 v[244:247], v28 offset:18432
    v_mfma_f32_16x16x32_bf16 v[116:119], a[248:251], a[108:111], v[116:119]
    buffer_store_dword v3, v2, s[36:39], s57 offen offset:0 sc1
    v_mfma_f32_16x16x32_bf16 v[120:123], a[252:255], a[104:107], v[120:123]
    ds_read_b128 a[240:243], v28 offset:19456
    v_mfma_f32_16x16x32_bf16 v[124:127], a[252:255], a[108:111], v[124:127]
    v_mfma_f32_16x16x32_bf16 v[128:131], v[176:179], a[104:107], v[128:131]
    ds_read_b128 a[244:247], v28 offset:20480
    v_mfma_f32_16x16x32_bf16 v[132:135], v[176:179], a[108:111], v[132:135]
    v_mfma_f32_16x16x32_bf16 v[136:139], v[180:183], a[104:107], v[136:139]
    ds_read_b128 a[248:251], v28 offset:21504
    v_mfma_f32_16x16x32_bf16 v[140:143], v[180:183], a[108:111], v[140:143]
    buffer_load_dwordx4 v26, s[8:11], s68 offen offset:2048 lds
    s_waitcnt lgkmcnt(6)
    v_mfma_f32_16x16x32_bf16 v[96:99], v[184:187], a[112:115], v[96:99]
    ds_read_b128 a[252:255], v28 offset:22528
    v_mfma_f32_16x16x32_bf16 v[100:103], v[184:187], a[116:119], v[100:103]
    v_mfma_f32_16x16x32_bf16 v[104:107], v[188:191], a[112:115], v[104:107]
    ds_read_b128 v[176:179], v28 offset:23552
    v_mfma_f32_16x16x32_bf16 v[108:111], v[188:191], a[116:119], v[108:111]
    v_mfma_f32_16x16x32_bf16 v[112:115], v[192:195], a[112:115], v[112:115]
    ds_read_b128 v[180:183], v28 offset:24576
    v_mfma_f32_16x16x32_bf16 v[116:119], v[192:195], a[116:119], v[116:119]
    buffer_load_dwordx4 v26, s[8:11], s68 offen offset:3072 lds
    v_mfma_f32_16x16x32_bf16 v[120:123], v[196:199], a[112:115], v[120:123]
    ds_read_b128 v[184:187], v28 offset:25600
    v_mfma_f32_16x16x32_bf16 v[124:127], v[196:199], a[116:119], v[124:127]
    s_waitcnt lgkmcnt(6)
    v_mfma_f32_16x16x32_bf16 v[128:131], v[200:203], a[112:115], v[128:131]
    ds_read_b128 v[188:191], v28 offset:26624
    v_mfma_f32_16x16x32_bf16 v[132:135], v[200:203], a[116:119], v[132:135]
    v_mfma_f32_16x16x32_bf16 v[136:139], v[204:207], a[112:115], v[136:139]
    ds_read_b128 v[192:195], v28 offset:27648
    v_mfma_f32_16x16x32_bf16 v[140:143], v[204:207], a[116:119], v[140:143]
    s_add_u32 s68, s68, 4096
    s_add_u32 m0, s26, 8192
    v_mfma_f32_16x16x32_bf16 v[96:99], v[244:247], a[120:123], v[96:99]
    ds_read_b128 v[196:199], v28 offset:28672
    v_mfma_f32_16x16x32_bf16 v[100:103], v[244:247], a[124:127], v[100:103]
    buffer_load_dwordx4 v26, s[8:11], s68 offen offset:0 lds
    v_mfma_f32_16x16x32_bf16 v[104:107], a[240:243], a[120:123], v[104:107]
    ds_read_b128 v[200:203], v28 offset:29696
    v_mfma_f32_16x16x32_bf16 v[108:111], a[240:243], a[124:127], v[108:111]
    s_waitcnt lgkmcnt(6)
    v_mfma_f32_16x16x32_bf16 v[112:115], a[244:247], a[120:123], v[112:115]
    ds_read_b128 v[204:207], v28 offset:30720
    v_mfma_f32_16x16x32_bf16 v[116:119], a[244:247], a[124:127], v[116:119]
    v_mfma_f32_16x16x32_bf16 v[120:123], a[248:251], a[120:123], v[120:123]
    ds_read_b128 v[244:247], v28 offset:31744
    v_mfma_f32_16x16x32_bf16 v[124:127], a[248:251], a[124:127], v[124:127]
    v_mfma_f32_16x16x32_bf16 v[128:131], a[252:255], a[120:123], v[128:131]
    ds_read_b128 a[240:243], v28 offset:32768
    v_mfma_f32_16x16x32_bf16 v[132:135], a[252:255], a[124:127], v[132:135]
    v_mfma_f32_16x16x32_bf16 v[136:139], v[176:179], a[120:123], v[136:139]
    ds_read_b128 a[244:247], v28 offset:33792
    v_mfma_f32_16x16x32_bf16 v[140:143], v[176:179], a[124:127], v[140:143]
    s_waitcnt lgkmcnt(6)
    v_mfma_f32_16x16x32_bf16 v[96:99], v[180:183], a[128:131], v[96:99]
    ds_read_b128 a[248:251], v28 offset:34816
    v_mfma_f32_16x16x32_bf16 v[100:103], v[180:183], a[132:135], v[100:103]
    buffer_load_dword v252, v5, s[36:39], s57 offen offset:0 sc1
    v_mfma_f32_16x16x32_bf16 v[104:107], v[184:187], a[128:131], v[104:107]
    ds_read_b128 a[252:255], v28 offset:35840
    v_mfma_f32_16x16x32_bf16 v[108:111], v[184:187], a[132:135], v[108:111]
    v_mfma_f32_16x16x32_bf16 v[112:115], v[188:191], a[128:131], v[112:115]
    ds_read_b128 v[176:179], v31 offset:2048
    v_mfma_f32_16x16x32_bf16 v[116:119], v[188:191], a[132:135], v[116:119]
    v_mfma_f32_16x16x32_bf16 v[120:123], v[192:195], a[128:131], v[120:123]
    ds_read_b128 v[180:183], v31 offset:2304
    v_mfma_f32_16x16x32_bf16 v[124:127], v[192:195], a[132:135], v[124:127]
    s_waitcnt lgkmcnt(6)
    v_mfma_f32_16x16x32_bf16 v[128:131], v[196:199], a[128:131], v[128:131]
    ds_read_b128 v[184:187], v31 offset:2560
    v_mfma_f32_16x16x32_bf16 v[132:135], v[196:199], a[132:135], v[132:135]
    v_mfma_f32_16x16x32_bf16 v[136:139], v[200:203], a[128:131], v[136:139]
    ds_read_b128 v[188:191], v31 offset:2816
    v_mfma_f32_16x16x32_bf16 v[140:143], v[200:203], a[132:135], v[140:143]
    v_mfma_f32_16x16x32_bf16 v[96:99], v[204:207], a[136:139], v[96:99]
    ds_read_b128 v[192:195], v31 offset:3072
    v_mfma_f32_16x16x32_bf16 v[100:103], v[204:207], a[140:143], v[100:103]
    v_mfma_f32_16x16x32_bf16 v[104:107], v[244:247], a[136:139], v[104:107]
    ds_read_b128 v[196:199], v31 offset:3328
    v_mfma_f32_16x16x32_bf16 v[108:111], v[244:247], a[140:143], v[108:111]
    s_waitcnt lgkmcnt(6)
    v_mfma_f32_16x16x32_bf16 v[112:115], a[240:243], a[136:139], v[112:115]
    s_waitcnt vmcnt(11)
    s_barrier
    ds_read_b128 v[200:203], v29 offset:0
    v_mfma_f32_16x16x32_bf16 v[116:119], a[240:243], a[140:143], v[116:119]
    v_mfma_f32_16x16x32_bf16 v[120:123], a[244:247], a[136:139], v[120:123]
    ds_read_b128 v[204:207], v29 offset:1024
    v_mfma_f32_16x16x32_bf16 v[124:127], a[244:247], a[140:143], v[124:127]
    s_add_u32 s69, s31, 0
    s_add_u32 m0, s26, 36864
    v_mfma_f32_16x16x32_bf16 v[128:131], a[248:251], a[136:139], v[128:131]
    ds_read_b128 v[244:247], v29 offset:2048
    v_mfma_f32_16x16x32_bf16 v[132:135], a[248:251], a[140:143], v[132:135]
    buffer_load_dwordx4 v26, s[8:11], s69 offen offset:0 sc1 lds
    v_mfma_f32_16x16x32_bf16 v[136:139], a[252:255], a[136:139], v[136:139]
    ds_read_b128 a[240:243], v29 offset:3072
    v_mfma_f32_16x16x32_bf16 v[140:143], a[252:255], a[140:143], v[140:143]
    s_waitcnt lgkmcnt(6)
    v_mfma_f32_16x16x32_bf16 v[96:99], v[176:179], v[8:11], v[96:99]
    ds_read_b128 a[244:247], v29 offset:4096
    v_mfma_f32_16x16x32_bf16 v[100:103], v[176:179], v[12:15], v[100:103]
    buffer_load_dwordx4 v26, s[8:11], s69 offen offset:1024 sc1 lds
    v_mfma_f32_16x16x32_bf16 v[104:107], v[180:183], v[8:11], v[104:107]
    ds_read_b128 a[248:251], v29 offset:5120
    v_mfma_f32_16x16x32_bf16 v[108:111], v[180:183], v[12:15], v[108:111]
    v_mfma_f32_16x16x32_bf16 v[112:115], v[184:187], v[8:11], v[112:115]
    ds_read_b128 a[252:255], v29 offset:6144
    v_mfma_f32_16x16x32_bf16 v[116:119], v[184:187], v[12:15], v[116:119]
    v_mfma_f32_16x16x32_bf16 v[120:123], v[188:191], v[8:11], v[120:123]
    ds_read_b128 v[176:179], v29 offset:7168
    v_mfma_f32_16x16x32_bf16 v[124:127], v[188:191], v[12:15], v[124:127]
    buffer_load_dwordx4 v26, s[8:11], s69 offen offset:2048 sc1 lds
    s_waitcnt lgkmcnt(6)
    v_mfma_f32_16x16x32_bf16 v[128:131], v[192:195], v[8:11], v[128:131]
    ds_read_b128 v[180:183], v29 offset:8192
    v_mfma_f32_16x16x32_bf16 v[132:135], v[192:195], v[12:15], v[132:135]
    v_cvt_pk_bf16_f32 v96, v96, v97
    v_cvt_pk_bf16_f32 v97, v98, v99
    v_mfma_f32_16x16x32_bf16 v[136:139], v[196:199], v[8:11], v[136:139]
    ds_read_b128 v[184:187], v29 offset:9216
    v_mfma_f32_16x16x32_bf16 v[140:143], v[196:199], v[12:15], v[140:143]
    v_cvt_pk_bf16_f32 v98, v104, v105
    v_cvt_pk_bf16_f32 v99, v106, v107
    v_mfma_f32_16x16x32_bf16 v[144:147], v[200:203], a[0:3], 0
    ds_read_b128 v[188:191], v29 offset:10240
    v_mfma_f32_16x16x32_bf16 v[148:151], v[200:203], a[4:7], 0
    v_pk_max_i16 v96, v96, 0
    v_pk_max_i16 v97, v97, 0
    v_mfma_f32_16x16x32_bf16 v[152:155], v[204:207], a[0:3], 0
    ds_read_b128 v[192:195], v29 offset:11264
    v_mfma_f32_16x16x32_bf16 v[156:159], v[204:207], a[4:7], 0
    v_pk_max_i16 v98, v98, 0
    s_waitcnt lgkmcnt(6)
    v_mfma_f32_16x16x32_bf16 v[160:163], v[244:247], a[0:3], 0
    ds_read_b128 v[196:199], v29 offset:12288
    v_mfma_f32_16x16x32_bf16 v[164:167], v[244:247], a[4:7], 0
    v_pk_max_i16 v99, v99, 0
    buffer_store_dwordx4 v[96:99], v26, s[32:35], s52 offen offset:0 sc1
    v_mfma_f32_16x16x32_bf16 v[168:171], a[240:243], a[0:3], 0
    ds_read_b128 v[200:203], v29 offset:13312
    v_mfma_f32_16x16x32_bf16 v[172:175], a[240:243], a[4:7], 0
    buffer_load_dwordx4 v26, s[8:11], s69 offen offset:3072 sc1 lds
    v_mfma_f32_16x16x32_bf16 v[144:147], a[244:247], a[8:11], v[144:147]
    ds_read_b128 v[204:207], v29 offset:14336
    s_add_u32 s69, s69, 4096
    v_mfma_f32_16x16x32_bf16 v[148:151], a[244:247], a[12:15], v[148:151]
    s_add_u32 m0, s26, 40960
    s_nop 0
    buffer_load_dwordx4 v26, s[8:11], s69 offen offset:0 sc1 lds
    v_mfma_f32_16x16x32_bf16 v[152:155], a[248:251], a[8:11], v[152:155]
    ds_read_b128 v[244:247], v29 offset:15360
    v_mfma_f32_16x16x32_bf16 v[156:159], a[248:251], a[12:15], v[156:159]
    v_cvt_pk_bf16_f32 v100, v100, v101
    s_waitcnt lgkmcnt(6)
    v_mfma_f32_16x16x32_bf16 v[160:163], a[252:255], a[8:11], v[160:163]
    ds_read_b128 a[240:243], v29 offset:16384
    v_mfma_f32_16x16x32_bf16 v[164:167], a[252:255], a[12:15], v[164:167]
    v_cvt_pk_bf16_f32 v101, v102, v103
    v_cvt_pk_bf16_f32 v102, v108, v109
    v_mfma_f32_16x16x32_bf16 v[168:171], v[176:179], a[8:11], v[168:171]
    ds_read_b128 a[244:247], v29 offset:17408
    v_cvt_pk_bf16_f32 v103, v110, v111
    v_mfma_f32_16x16x32_bf16 v[172:175], v[176:179], a[12:15], v[172:175]
    v_pk_max_i16 v100, v100, 0
    v_pk_max_i16 v101, v101, 0
    v_mfma_f32_16x16x32_bf16 v[144:147], v[180:183], a[16:19], v[144:147]
    ds_read_b128 a[248:251], v29 offset:18432
    v_pk_max_i16 v102, v102, 0
    v_mfma_f32_16x16x32_bf16 v[148:151], v[180:183], a[20:23], v[148:151]
    v_pk_max_i16 v103, v103, 0
    buffer_store_dwordx4 v[100:103], v26, s[32:35], s53 offen offset:0 sc1
    v_mfma_f32_16x16x32_bf16 v[152:155], v[184:187], a[16:19], v[152:155]
    ds_read_b128 a[252:255], v29 offset:19456
    v_mfma_f32_16x16x32_bf16 v[156:159], v[184:187], a[20:23], v[156:159]
    s_waitcnt vmcnt(7)
    s_mov_b32 s67, 400000
ffn_pc3:
    v_cmp_eq_u32 vcc, 1, v252
    s_nop 0
    s_cmp_eq_u64 vcc, exec
    s_cbranch_scc1 ffn_ok3
    s_sub_u32 s67, s67, 1
    s_cbranch_scc1 ffn_ok3
    s_sleep 1
    buffer_load_dword v252, v5, s[36:39], s57 offen offset:0 sc1
    s_waitcnt vmcnt(0)
    s_branch ffn_pc3
ffn_ok3:
    s_waitcnt lgkmcnt(6)
    v_mfma_f32_16x16x32_bf16 v[160:163], v[188:191], a[16:19], v[160:163]
    ds_read_b128 v[176:179], v29 offset:20480
    buffer_load_dwordx4 v26, s[8:11], s69 offen offset:1024 sc1 lds
    v_mfma_f32_16x16x32_bf16 v[164:167], v[188:191], a[20:23], v[164:167]
    s_add_u32 s64, s21, 1
    s_and_b32 s64, s64, 3
    v_mfma_f32_16x16x32_bf16 v[168:171], v[192:195], a[16:19], v[168:171]
    ds_read_b128 v[180:183], v29 offset:21504
    s_mul_i32 s64, s64, 9216
    v_mfma_f32_16x16x32_bf16 v[172:175], v[192:195], a[20:23], v[172:175]
    s_add_u32 s64, s64, s48
    s_add_u32 s64, s64, 0
    v_mfma_f32_16x16x32_bf16 v[144:147], v[196:199], a[24:27], v[144:147]
    ds_read_b128 v[184:187], v29 offset:22528
    s_add_u32 s49, s64, 147456
    v_mfma_f32_16x16x32_bf16 v[148:151], v[196:199], a[28:31], v[148:151]
    buffer_load_dwordx4 a[144:147], v26, s[32:35], s64 offen offset:0 sc1
    v_cvt_pk_bf16_f32 v112, v112, v113
    v_mfma_f32_16x16x32_bf16 v[152:155], v[200:203], a[24:27], v[152:155]
    ds_read_b128 v[188:191], v29 offset:23552
    v_mfma_f32_16x16x32_bf16 v[156:159], v[200:203], a[28:31], v[156:159]
    v_cvt_pk_bf16_f32 v113, v114, v115
    s_waitcnt lgkmcnt(6)
    v_mfma_f32_16x16x32_bf16 v[160:163], v[204:207], a[24:27], v[160:163]
    ds_read_b128 v[192:195], v29 offset:24576
    v_cvt_pk_bf16_f32 v114, v120, v121
    v_mfma_f32_16x16x32_bf16 v[164:167], v[204:207], a[28:31], v[164:167]
    v_cvt_pk_bf16_f32 v115, v122, v123
    v_pk_max_i16 v112, v112, 0
    v_mfma_f32_16x16x32_bf16 v[168:171], v[244:247], a[24:27], v[168:171]
    ds_read_b128 v[196:199], v29 offset:25600
    v_mfma_f32_16x16x32_bf16 v[172:175], v[244:247], a[28:31], v[172:175]
    v_pk_max_i16 v113, v113, 0
    v_pk_max_i16 v114, v114, 0
    v_mfma_f32_16x16x32_bf16 v[144:147], a[240:243], a[32:35], v[144:147]
    ds_read_b128 v[200:203], v29 offset:26624
    v_pk_max_i16 v115, v115, 0
    v_mfma_f32_16x16x32_bf16 v[148:151], a[240:243], a[36:39], v[148:151]
    buffer_store_dwordx4 v[112:115], v26, s[32:35], s52 offen offset:1024 sc1
    buffer_load_dwordx4 a[148:151], v26, s[32:35], s49 offen offset:0 sc1
    v_mfma_f32_16x16x32_bf16 v[152:155], a[244:247], a[32:35], v[152:155]
    ds_read_b128 v[204:207], v29 offset:27648
    buffer_load_dwordx4 v26, s[8:11], s69 offen offset:2048 sc1 lds
    v_mfma_f32_16x16x32_bf16 v[156:159], a[244:247], a[36:39], v[156:159]
    buffer_load_dwordx4 v26, s[8:11], s69 offen offset:3072 sc1 lds
    s_waitcnt lgkmcnt(6)
    v_mfma_f32_16x16x32_bf16 v[160:163], a[248:251], a[32:35], v[160:163]
    ds_read_b128 v[244:247], v29 offset:28672
    buffer_load_dwordx4 a[152:155], v26, s[32:35], s64 offen offset:1024 sc1
    v_mfma_f32_16x16x32_bf16 v[164:167], a[248:251], a[36:39], v[164:167]
    v_cvt_pk_bf16_f32 v116, v116, v117
    v_cvt_pk_bf16_f32 v117, v118, v119
    v_mfma_f32_16x16x32_bf16 v[168:171], a[252:255], a[32:35], v[168:171]
    ds_read_b128 a[240:243], v29 offset:29696
    v_cvt_pk_bf16_f32 v118, v124, v125
    v_mfma_f32_16x16x32_bf16 v[172:175], a[252:255], a[36:39], v[172:175]
    v_cvt_pk_bf16_f32 v119, v126, v127
    v_pk_max_i16 v116, v116, 0
    v_mfma_f32_16x16x32_bf16 v[144:147], v[176:179], a[40:43], v[144:147]
    ds_read_b128 a[244:247], v29 offset:30720
    v_mfma_f32_16x16x32_bf16 v[148:151], v[176:179], a[44:47], v[148:151]
    v_pk_max_i16 v117, v117, 0
    v_pk_max_i16 v118, v118, 0
    v_mfma_f32_16x16x32_bf16 v[152:155], v[180:183], a[40:43], v[152:155]
    ds_read_b128 a[248:251], v29 offset:31744
    v_mfma_f32_16x16x32_bf16 v[156:159], v[180:183], a[44:47], v[156:159]
    v_pk_max_i16 v119, v119, 0
    s_waitcnt lgkmcnt(6)
    v_mfma_f32_16x16x32_bf16 v[160:163], v[184:187], a[40:43], v[160:163]
    ds_read_b128 a[252:255], v29 offset:32768
    buffer_store_dwordx4 v[116:119], v26, s[32:35], s53 offen offset:1024 sc1
    v_mfma_f32_16x16x32_bf16 v[164:167], v[184:187], a[44:47], v[164:167]
    s_add_u32 s69, s69, 4096
    s_add_u32 m0, s26, 45056
    v_mfma_f32_16x16x32_bf16 v[168:171], v[188:191], a[40:43], v[168:171]
    ds_read_b128 v[176:179], v29 offset:33792
    buffer_load_dwordx4 v26, s[8:11], s69 offen offset:0 sc1 lds
    v_mfma_f32_16x16x32_bf16 v[172:175], v[188:191], a[44:47], v[172:175]
    buffer_load_dwordx4 a[156:159], v26, s[32:35], s49 offen offset:1024 sc1
    v_cvt_pk_bf16_f32 v128, v128, v129
    v_mfma_f32_16x16x32_bf16 v[144:147], v[192:195], a[48:51], v[144:147]
    ds_read_b128 v[180:183], v29 offset:34816
    v_mfma_f32_16x16x32_bf16 v[148:151], v[192:195], a[52:55], v[148:151]
    v_cvt_pk_bf16_f32 v129, v130, v131
    v_cvt_pk_bf16_f32 v130, v136, v137
    v_mfma_f32_16x16x32_bf16 v[152:155], v[196:199], a[48:51], v[152:155]
    ds_read_b128 v[184:187], v29 offset:35840
    v_mfma_f32_16x16x32_bf16 v[156:159], v[196:199], a[52:55], v[156:159]
    v_cvt_pk_bf16_f32 v131, v138, v139
    s_waitcnt lgkmcnt(6)
    v_mfma_f32_16x16x32_bf16 v[160:163], v[200:203], a[48:51], v[160:163]
    s_barrier
    ds_read_b128 v[188:191], v26 offset:0
    v_mfma_f32_16x16x32_bf16 v[164:167], v[200:203], a[52:55], v[164:167]
    v_pk_max_i16 v128, v128, 0
    v_pk_max_i16 v129, v129, 0
    v_mfma_f32_16x16x32_bf16 v[168:171], v[204:207], a[48:51], v[168:171]
    ds_read_b128 v[192:195], v26 offset:1024
    v_mfma_f32_16x16x32_bf16 v[172:175], v[204:207], a[52:55], v[172:175]
    v_pk_max_i16 v130, v130, 0
    v_pk_max_i16 v131, v131, 0
    v_mfma_f32_16x16x32_bf16 v[144:147], v[244:247], a[56:59], v[144:147]
    ds_read_b128 v[196:199], v26 offset:2048
    buffer_store_dwordx4 v[128:131], v26, s[32:35], s52 offen offset:2048 sc1
    v_mfma_f32_16x16x32_bf16 v[148:151], v[244:247], a[60:63], v[148:151]
    buffer_load_dwordx4 a[160:163], v26, s[32:35], s64 offen offset:2048 sc1
    buffer_load_dwordx4 a[164:167], v26, s[32:35], s49 offen offset:2048 sc1
    v_mfma_f32_16x16x32_bf16 v[152:155], a[240:243], a[56:59], v[152:155]
    ds_read_b128 v[200:203], v26 offset:3072
    s_add_u32 s68, s31, 36864
    v_mfma_f32_16x16x32_bf16 v[156:159], a[240:243], a[60:63], v[156:159]
    s_add_u32 m0, s26, 73728
    s_waitcnt lgkmcnt(6)
    v_mfma_f32_16x16x32_bf16 v[160:163], a[244:247], a[56:59], v[160:163]
    ds_read_b128 v[204:207], v26 offset:4096
    buffer_load_dwordx4 v26, s[8:11], s68 offen offset:0 sc1 lds
    v_mfma_f32_16x16x32_bf16 v[164:167], a[244:247], a[60:63], v[164:167]
    v_cvt_pk_bf16_f32 v132, v132, v133
    v_cvt_pk_bf16_f32 v133, v134, v135
    v_mfma_f32_16x16x32_bf16 v[168:171], a[248:251], a[56:59], v[168:171]
    ds_read_b128 v[244:247], v26 offset:5120
    v_mfma_f32_16x16x32_bf16 v[172:175], a[248:251], a[60:63], v[172:175]
    v_cvt_pk_bf16_f32 v134, v140, v141
    v_cvt_pk_bf16_f32 v135, v142, v143
    v_mfma_f32_16x16x32_bf16 v[144:147], a[252:255], a[64:67], v[144:147]
    ds_read_b128 a[240:243], v26 offset:6144
    v_mfma_f32_16x16x32_bf16 v[148:151], a[252:255], a[68:71], v[148:151]
    v_pk_max_i16 v132, v132, 0
    v_pk_max_i16 v133, v133, 0
    v_mfma_f32_16x16x32_bf16 v[152:155], v[176:179], a[64:67], v[152:155]
    ds_read_b128 a[244:247], v26 offset:7168
    v_mfma_f32_16x16x32_bf16 v[156:159], v[176:179], a[68:71], v[156:159]
    v_pk_max_i16 v134, v134, 0
    s_waitcnt lgkmcnt(6)
    v_mfma_f32_16x16x32_bf16 v[160:163], v[180:183], a[64:67], v[160:163]
    ds_read_b128 a[248:251], v26 offset:8192
    v_mfma_f32_16x16x32_bf16 v[164:167], v[180:183], a[68:71], v[164:167]
    v_pk_max_i16 v135, v135, 0
    buffer_store_dwordx4 v[132:135], v26, s[32:35], s53 offen offset:2048 sc1
    v_mfma_f32_16x16x32_bf16 v[168:171], v[184:187], a[64:67], v[168:171]
    ds_read_b128 a[252:255], v26 offset:9216
    v_mfma_f32_16x16x32_bf16 v[172:175], v[184:187], a[68:71], v[172:175]
    buffer_load_dwordx4 v26, s[8:11], s68 offen offset:1024 sc1 lds
    buffer_load_dwordx4 a[168:171], v26, s[32:35], s64 offen offset:3072 sc1
    v_mfma_f32_16x16x32_bf16 v[144:147], v[188:191], a[72:75], v[144:147]
    ds_read_b128 v[176:179], v26 offset:10240
    v_mfma_f32_16x16x32_bf16 v[148:151], v[188:191], a[76:79], v[148:151]
    buffer_load_dwordx4 v26, s[8:11], s68 offen offset:2048 sc1 lds
    buffer_load_dwordx4 a[172:175], v26, s[32:35], s49 offen offset:3072 sc1
    v_mfma_f32_16x16x32_bf16 v[152:155], v[192:195], a[72:75], v[152:155]
    ds_read_b128 v[180:183], v26 offset:11264
    v_mfma_f32_16x16x32_bf16 v[156:159], v[192:195], a[76:79], v[156:159]
    buffer_load_dwordx4 v26, s[8:11], s68 offen offset:3072 sc1 lds
    s_waitcnt lgkmcnt(6)
    v_mfma_f32_16x16x32_bf16 v[160:163], v[196:199], a[72:75], v[160:163]
    ds_read_b128 v[184:187], v26 offset:12288
    v_mfma_f32_16x16x32_bf16 v[164:167], v[196:199], a[76:79], v[164:167]
    s_add_u32 s64, s21, 2
    s_and_b32 s64, s64, 3
    v_mfma_f32_16x16x32_bf16 v[168:171], v[200:203], a[72:75], v[168:171]
    ds_read_b128 v[188:191], v26 offset:13312
    v_mfma_f32_16x16x32_bf16 v[172:175], v[200:203], a[76:79], v[172:175]
    s_mul_i32 s64, s64, 9216
    s_add_u32 s64, s64, s48
    v_mfma_f32_16x16x32_bf16 v[144:147], v[204:207], a[80:83], v[144:147]
    ds_read_b128 v[192:195], v26 offset:14336
    v_mfma_f32_16x16x32_bf16 v[148:151], v[204:207], a[84:87], v[148:151]
    s_add_u32 s64, s64, 0
    s_add_u32 s49, s64, 147456
    v_mfma_f32_16x16x32_bf16 v[152:155], v[244:247], a[80:83], v[152:155]
    ds_read_b128 v[196:199], v26 offset:15360
    v_mfma_f32_16x16x32_bf16 v[156:159], v[244:247], a[84:87], v[156:159]
    buffer_load_dwordx4 a[176:179], v26, s[32:35], s64 offen offset:0 sc1
    s_waitcnt lgkmcnt(6)
    v_mfma_f32_16x16x32_bf16 v[160:163], a[240:243], a[80:83], v[160:163]
    ds_read_b128 v[200:203], v26 offset:16384
    v_mfma_f32_16x16x32_bf16 v[164:167], a[240:243], a[84:87], v[164:167]
    s_add_u32 s68, s68, 4096
    s_add_u32 m0, s26, 77824
    v_mfma_f32_16x16x32_bf16 v[168:171], a[244:247], a[80:83], v[168:171]
    ds_read_b128 v[204:207], v26 offset:17408
    v_mfma_f32_16x16x32_bf16 v[172:175], a[244:247], a[84:87], v[172:175]
    buffer_load_dwordx4 v26, s[8:11], s68 offen offset:0 sc1 lds
    buffer_load_dwordx4 a[180:183], v26, s[32:35], s49 offen offset:0 sc1
    v_mfma_f32_16x16x32_bf16 v[144:147], a[248:251], a[88:91], v[144:147]
    ds_read_b128 v[244:247], v26 offset:18432
    v_mfma_f32_16x16x32_bf16 v[148:151], a[248:251], a[92:95], v[148:151]
    buffer_load_dwordx4 v26, s[8:11], s68 offen offset:1024 sc1 lds
    v_mfma_f32_16x16x32_bf16 v[152:155], a[252:255], a[88:91], v[152:155]
    ds_read_b128 a[240:243], v26 offset:19456
    v_mfma_f32_16x16x32_bf16 v[156:159], a[252:255], a[92:95], v[156:159]
    s_waitcnt lgkmcnt(6)
    v_mfma_f32_16x16x32_bf16 v[160:163], v[176:179], a[88:91], v[160:163]
    ds_read_b128 a[244:247], v26 offset:20480
    v_mfma_f32_16x16x32_bf16 v[164:167], v[176:179], a[92:95], v[164:167]
    buffer_load_dwordx4 a[184:187], v26, s[32:35], s64 offen offset:1024 sc1
    v_mfma_f32_16x16x32_bf16 v[168:171], v[180:183], a[88:91], v[168:171]
    ds_read_b128 a[248:251], v26 offset:21504
    v_mfma_f32_16x16x32_bf16 v[172:175], v[180:183], a[92:95], v[172:175]
    buffer_load_dwordx4 v26, s[8:11], s68 offen offset:2048 sc1 lds
    v_mfma_f32_16x16x32_bf16 v[144:147], v[184:187], a[96:99], v[144:147]
    ds_read_b128 a[252:255], v26 offset:22528
    v_mfma_f32_16x16x32_bf16 v[148:151], v[184:187], a[100:103], v[148:151]
    v_mfma_f32_16x16x32_bf16 v[152:155], v[188:191], a[96:99], v[152:155]
    ds_read_b128 v[176:179], v26 offset:23552
    v_mfma_f32_16x16x32_bf16 v[156:159], v[188:191], a[100:103], v[156:159]
    buffer_load_dwordx4 a[188:191], v26, s[32:35], s49 offen offset:1024 sc1
    s_waitcnt lgkmcnt(6)
    v_mfma_f32_16x16x32_bf16 v[160:163], v[192:195], a[96:99], v[160:163]
    ds_read_b128 v[180:183], v26 offset:24576
    v_mfma_f32_16x16x32_bf16 v[164:167], v[192:195], a[100:103], v[164:167]
    buffer_load_dwordx4 v26, s[8:11], s68 offen offset:3072 sc1 lds
    v_mfma_f32_16x16x32_bf16 v[168:171], v[196:199], a[96:99], v[168:171]
    ds_read_b128 v[184:187], v26 offset:25600
    v_mfma_f32_16x16x32_bf16 v[172:175], v[196:199], a[100:103], v[172:175]
    v_mfma_f32_16x16x32_bf16 v[144:147], v[200:203], a[104:107], v[144:147]
    ds_read_b128 v[188:191], v26 offset:26624
    v_mfma_f32_16x16x32_bf16 v[148:151], v[200:203], a[108:111], v[148:151]
    v_mfma_f32_16x16x32_bf16 v[152:155], v[204:207], a[104:107], v[152:155]
    ds_read_b128 v[192:195], v26 offset:27648
    v_mfma_f32_16x16x32_bf16 v[156:159], v[204:207], a[108:111], v[156:159]
    s_add_u32 s68, s68, 4096
    s_waitcnt lgkmcnt(6)
    v_mfma_f32_16x16x32_bf16 v[160:163], v[244:247], a[104:107], v[160:163]
    ds_read_b128 v[196:199], v26 offset:28672
    v_mfma_f32_16x16x32_bf16 v[164:167], v[244:247], a[108:111], v[164:167]
    s_add_u32 m0, s26, 81920
    s_nop 0
    buffer_load_dwordx4 v26, s[8:11], s68 offen offset:0 sc1 lds
    v_mfma_f32_16x16x32_bf16 v[168:171], a[240:243], a[104:107], v[168:171]
    ds_read_b128 v[200:203], v26 offset:29696
    v_mfma_f32_16x16x32_bf16 v[172:175], a[240:243], a[108:111], v[172:175]
    buffer_load_dwordx4 a[192:195], v26, s[32:35], s64 offen offset:2048 sc1
    v_mfma_f32_16x16x32_bf16 v[144:147], a[244:247], a[112:115], v[144:147]
    ds_read_b128 v[204:207], v26 offset:30720
    v_mfma_f32_16x16x32_bf16 v[148:151], a[244:247], a[116:119], v[148:151]
    v_mfma_f32_16x16x32_bf16 v[152:155], a[248:251], a[112:115], v[152:155]
    ds_read_b128 v[244:247], v26 offset:31744
    v_mfma_f32_16x16x32_bf16 v[156:159], a[248:251], a[116:119], v[156:159]
    buffer_load_dwordx4 a[196:199], v26, s[32:35], s49 offen offset:2048 sc1
    s_waitcnt lgkmcnt(6)
    v_mfma_f32_16x16x32_bf16 v[160:163], a[252:255], a[112:115], v[160:163]
    ds_read_b128 a[240:243], v26 offset:32768
    v_mfma_f32_16x16x32_bf16 v[164:167], a[252:255], a[116:119], v[164:167]
    v_mfma_f32_16x16x32_bf16 v[168:171], v[176:179], a[112:115], v[168:171]
    ds_read_b128 a[244:247], v26 offset:33792
    v_mfma_f32_16x16x32_bf16 v[172:175], v[176:179], a[116:119], v[172:175]
    v_mfma_f32_16x16x32_bf16 v[144:147], v[180:183], a[120:123], v[144:147]
    ds_read_b128 a[248:251], v26 offset:34816
    v_mfma_f32_16x16x32_bf16 v[148:151], v[180:183], a[124:127], v[148:151]
    v_mfma_f32_16x16x32_bf16 v[152:155], v[184:187], a[120:123], v[152:155]
    ds_read_b128 a[252:255], v26 offset:35840
    v_mfma_f32_16x16x32_bf16 v[156:159], v[184:187], a[124:127], v[156:159]
    buffer_load_dwordx4 a[200:203], v26, s[32:35], s64 offen offset:3072 sc1
    s_waitcnt lgkmcnt(6)
    v_mfma_f32_16x16x32_bf16 v[160:163], v[188:191], a[120:123], v[160:163]
    ds_read_b128 v[176:179], v31 offset:3584
    v_mfma_f32_16x16x32_bf16 v[164:167], v[188:191], a[124:127], v[164:167]
    v_mfma_f32_16x16x32_bf16 v[168:171], v[192:195], a[120:123], v[168:171]
    ds_read_b128 v[180:183], v31 offset:3840
    v_mfma_f32_16x16x32_bf16 v[172:175], v[192:195], a[124:127], v[172:175]
    v_mfma_f32_16x16x32_bf16 v[144:147], v[196:199], a[128:131], v[144:147]
    ds_read_b128 v[184:187], v31 offset:4096
    v_mfma_f32_16x16x32_bf16 v[148:151], v[196:199], a[132:135], v[148:151]
    v_mfma_f32_16x16x32_bf16 v[152:155], v[200:203], a[128:131], v[152:155]
    ds_read_b128 v[188:191], v31 offset:4352
    v_mfma_f32_16x16x32_bf16 v[156:159], v[200:203], a[132:135], v[156:159]
    buffer_load_dwordx4 a[204:207], v26, s[32:35], s49 offen offset:3072 sc1
    s_waitcnt lgkmcnt(6)
    v_mfma_f32_16x16x32_bf16 v[160:163], v[204:207], a[128:131], v[160:163]
    s_waitcnt vmcnt(24)
    s_barrier
    ds_read_b128 v[192:195], v27 offset:0
    v_mfma_f32_16x16x32_bf16 v[164:167], v[204:207], a[132:135], v[164:167]
    v_mfma_f32_16x16x32_bf16 v[168:171], v[244:247], a[128:131], v[168:171]
    ds_read_b128 v[196:199], v27 offset:1024
    v_mfma_f32_16x16x32_bf16 v[172:175], v[244:247], a[132:135], v[172:175]
    s_add_u32 s69, s31, 73728
    s_add_u32 m0, s26, 110592
    v_mfma_f32_16x16x32_bf16 v[144:147], a[240:243], a[136:139], v[144:147]
    ds_read_b128 v[200:203], v27 offset:2048
    v_mfma_f32_16x16x32_bf16 v[148:151], a[240:243], a[140:143], v[148:151]
    buffer_load_dwordx4 v26, s[8:11], s69 offen offset:0 sc1 lds
    s_waitcnt vmcnt(19)
    buffer_store_dword v3, v2, s[36:39], s57 offen offset:16 sc1
    v_mfma_f32_16x16x32_bf16 v[152:155], a[244:247], a[136:139], v[152:155]
    ds_read_b128 v[204:207], v27 offset:3072
    v_mfma_f32_16x16x32_bf16 v[156:159], a[244:247], a[140:143], v[156:159]
    s_add_u32 s64, s21, 3
    s_waitcnt lgkmcnt(6)
    v_mfma_f32_16x16x32_bf16 v[160:163], a[248:251], a[136:139], v[160:163]
    ds_read_b128 v[244:247], v27 offset:4096
    v_mfma_f32_16x16x32_bf16 v[164:167], a[248:251], a[140:143], v[164:167]
    s_and_b32 s64, s64, 3
    s_mul_i32 s64, s64, 9216
    v_mfma_f32_16x16x32_bf16 v[168:171], a[252:255], a[136:139], v[168:171]
    ds_read_b128 a[240:243], v27 offset:5120
    v_mfma_f32_16x16x32_bf16 v[172:175], a[252:255], a[140:143], v[172:175]
    s_add_u32 s64, s64, s48
    s_add_u32 s64, s64, 0
    v_mfma_f32_16x16x32_bf16 v[144:147], v[176:179], v[8:11], v[144:147]
    ds_read_b128 a[244:247], v27 offset:6144
    v_mfma_f32_16x16x32_bf16 v[148:151], v[176:179], v[12:15], v[148:151]
    s_add_u32 s49, s64, 147456
    buffer_load_dwordx4 a[208:211], v26, s[32:35], s64 offen offset:0 sc1
    v_mfma_f32_16x16x32_bf16 v[152:155], v[180:183], v[8:11], v[152:155]
    ds_read_b128 a[248:251], v27 offset:7168
    v_mfma_f32_16x16x32_bf16 v[156:159], v[180:183], v[12:15], v[156:159]
    buffer_load_dwordx4 v26, s[8:11], s69 offen offset:1024 sc1 lds
    s_waitcnt lgkmcnt(6)
    v_mfma_f32_16x16x32_bf16 v[160:163], v[184:187], v[8:11], v[160:163]
    ds_read_b128 a[252:255], v27 offset:8192
    v_mfma_f32_16x16x32_bf16 v[164:167], v[184:187], v[12:15], v[164:167]
    buffer_load_dwordx4 v26, s[8:11], s69 offen offset:2048 sc1 lds
    buffer_load_dwordx4 a[212:215], v26, s[32:35], s49 offen offset:0 sc1
    v_mfma_f32_16x16x32_bf16 v[168:171], v[188:191], v[8:11], v[168:171]
    ds_read_b128 v[176:179], v27 offset:9216
    v_cvt_pk_bf16_f32 v144, v144, v145
    v_mfma_f32_16x16x32_bf16 v[172:175], v[188:191], v[12:15], v[172:175]
    v_cvt_pk_bf16_f32 v145, v146, v147
    v_cvt_pk_bf16_f32 v146, v152, v153
    v_mfma_f32_16x16x32_bf16 v[40:43], v[192:195], v[32:35], 0
    ds_read_b128 v[180:183], v27 offset:10240
    v_cvt_pk_bf16_f32 v147, v154, v155
    v_mfma_f32_16x16x32_bf16 v[44:47], v[192:195], v[36:39], 0
    v_pk_max_i16 v144, v144, 0
    v_pk_max_i16 v145, v145, 0
    v_mfma_f32_16x16x32_bf16 v[56:59], v[196:199], v[32:35], 0
    ds_read_b128 v[184:187], v27 offset:11264
    v_pk_max_i16 v146, v146, 0
    v_mfma_f32_16x16x32_bf16 v[60:63], v[196:199], v[36:39], 0
    v_pk_max_i16 v147, v147, 0
    s_waitcnt lgkmcnt(6)
    v_mfma_f32_16x16x32_bf16 v[72:75], v[200:203], v[32:35], 0
    ds_read_b128 v[188:191], v27 offset:12288
    v_cvt_pk_bf16_f32 v148, v148, v149
    v_mfma_f32_16x16x32_bf16 v[76:79], v[200:203], v[36:39], 0
    v_cvt_pk_bf16_f32 v149, v150, v151
    v_cvt_pk_bf16_f32 v150, v156, v157
    v_mfma_f32_16x16x32_bf16 v[88:91], v[204:207], v[32:35], 0
    ds_read_b128 v[192:195], v27 offset:13312
    v_cvt_pk_bf16_f32 v151, v158, v159
    v_mfma_f32_16x16x32_bf16 v[92:95], v[204:207], v[36:39], 0
    v_pk_max_i16 v148, v148, 0
    v_pk_max_i16 v149, v149, 0
    v_mfma_f32_16x16x32_bf16 v[104:107], v[244:247], v[32:35], 0
    ds_read_b128 v[196:199], v27 offset:14336
    v_pk_max_i16 v150, v150, 0
    v_mfma_f32_16x16x32_bf16 v[108:111], v[244:247], v[36:39], 0
    v_pk_max_i16 v151, v151, 0
    buffer_load_dwordx4 v26, s[8:11], s69 offen offset:3072 sc1 lds
    v_mfma_f32_16x16x32_bf16 v[120:123], a[240:243], v[32:35], 0
    ds_read_b128 v[200:203], v27 offset:15360
    v_cvt_pk_bf16_f32 v160, v160, v161
    v_mfma_f32_16x16x32_bf16 v[124:127], a[240:243], v[36:39], 0
    v_cvt_pk_bf16_f32 v161, v162, v163
    s_waitcnt lgkmcnt(6)
    v_mfma_f32_16x16x32_bf16 v[136:139], a[244:247], v[32:35], 0
    ds_read_b128 v[204:207], v27 offset:16384
    v_cvt_pk_bf16_f32 v162, v168, v169
    v_mfma_f32_16x16x32_bf16 v[140:143], a[244:247], v[36:39], 0
    v_cvt_pk_bf16_f32 v163, v170, v171
    v_pk_max_i16 v160, v160, 0
    v_pk_max_i16 v161, v161, 0
    v_pk_max_i16 v162, v162, 0
    v_pk_max_i16 v163, v163, 0
    v_cvt_pk_bf16_f32 v164, v164, v165
    v_cvt_pk_bf16_f32 v165, v166, v167
    v_cvt_pk_bf16_f32 v166, v172, v173
    v_cvt_pk_bf16_f32 v167, v174, v175
    v_pk_max_i16 v164, v164, 0
    v_pk_max_i16 v165, v165, 0
    v_pk_max_i16 v166, v166, 0
    v_pk_max_i16 v167, v167, 0
    v_mfma_f32_16x16x32_bf16 v[40:43], a[248:251], v[48:51], v[40:43]
    ds_read_b128 v[244:247], v27 offset:17408
    v_mfma_f32_16x16x32_bf16 v[44:47], a[248:251], v[52:55], v[44:47]
    buffer_load_dwordx4 a[216:219], v26, s[32:35], s64 offen offset:1024 sc1
    s_add_u32 s69, s69, 4096
    v_mfma_f32_16x16x32_bf16 v[56:59], a[252:255], v[48:51], v[56:59]
    ds_read_b128 a[240:243], v27 offset:18432
    v_mfma_f32_16x16x32_bf16 v[60:63], a[252:255], v[52:55], v[60:63]
    s_add_u32 m0, s26, 114688
    s_nop 0
    buffer_load_dwordx4 v26, s[8:11], s69 offen offset:0 sc1 lds
    v_mfma_f32_16x16x32_bf16 v[72:75], v[176:179], v[48:51], v[72:75]
    ds_read_b128 a[244:247], v27 offset:19456
    v_mfma_f32_16x16x32_bf16 v[76:79], v[176:179], v[52:55], v[76:79]
    buffer_load_dwordx4 a[220:223], v26, s[32:35], s49 offen offset:1024 sc1
    s_waitcnt lgkmcnt(6)
    v_mfma_f32_16x16x32_bf16 v[88:91], v[180:183], v[48:51], v[88:91]
    ds_read_b128 a[248:251], v27 offset:20480
    v_mfma_f32_16x16x32_bf16 v[92:95], v[180:183], v[52:55], v[92:95]
    buffer_load_dwordx4 v26, s[8:11], s69 offen offset:1024 sc1 lds
    buffer_load_dword v252, v5, s[36:39], s57 offen offset:16 sc1
    v_mfma_f32_16x16x32_bf16 v[104:107], v[184:187], v[48:51], v[104:107]
    ds_read_b128 a[252:255], v27 offset:21504
    v_mfma_f32_16x16x32_bf16 v[108:111], v[184:187], v[52:55], v[108:111]
    buffer_store_dwordx4 v[144:147], v26, s[32:35], s52 offen offset:3072 sc1
    buffer_load_dwordx4 a[224:227], v26, s[32:35], s64 offen offset:2048 sc1
    v_mfma_f32_16x16x32_bf16 v[120:123], v[188:191], v[48:51], v[120:123]
    ds_read_b128 v[176:179], v27 offset:22528
    v_mfma_f32_16x16x32_bf16 v[124:127], v[188:191], v[52:55], v[124:127]
    buffer_load_dwordx4 v26, s[8:11], s69 offen offset:2048 sc1 lds
    v_mfma_f32_16x16x32_bf16 v[136:139], v[192:195], v[48:51], v[136:139]
    ds_read_b128 v[180:183], v27 offset:23552
    v_mfma_f32_16x16x32_bf16 v[140:143], v[192:195], v[52:55], v[140:143]
    buffer_load_dwordx4 a[228:231], v26, s[32:35], s49 offen offset:2048 sc1
    s_waitcnt lgkmcnt(6)
    v_mfma_f32_16x16x32_bf16 v[40:43], v[196:199], v[64:67], v[40:43]
    ds_read_b128 v[184:187], v27 offset:24576
    v_mfma_f32_16x16x32_bf16 v[44:47], v[196:199], v[68:71], v[44:47]
    buffer_load_dwordx4 v26, s[8:11], s69 offen offset:3072 sc1 lds
    buffer_store_dwordx4 v[148:151], v26, s[32:35], s53 offen offset:3072 sc1
    v_mfma_f32_16x16x32_bf16 v[56:59], v[200:203], v[64:67], v[56:59]
    ds_read_b128 v[188:191], v27 offset:25600
    v_mfma_f32_16x16x32_bf16 v[60:63], v[200:203], v[68:71], v[60:63]
    v_mfma_f32_16x16x32_bf16 v[72:75], v[204:207], v[64:67], v[72:75]
    ds_read_b128 v[192:195], v27 offset:26624
    v_mfma_f32_16x16x32_bf16 v[76:79], v[204:207], v[68:71], v[76:79]
    buffer_load_dwordx4 a[232:235], v26, s[32:35], s64 offen offset:3072 sc1
    v_mfma_f32_16x16x32_bf16 v[88:91], v[244:247], v[64:67], v[88:91]
    ds_read_b128 v[196:199], v27 offset:27648
    v_mfma_f32_16x16x32_bf16 v[92:95], v[244:247], v[68:71], v[92:95]
    s_add_u32 s69, s69, 4096
    s_waitcnt lgkmcnt(6)
    v_mfma_f32_16x16x32_bf16 v[104:107], a[240:243], v[64:67], v[104:107]
    ds_read_b128 v[200:203], v27 offset:28672
    v_mfma_f32_16x16x32_bf16 v[108:111], a[240:243], v[68:71], v[108:111]
    s_add_u32 m0, s26, 118784
    s_nop 0
    buffer_load_dwordx4 v26, s[8:11], s69 offen offset:0 sc1 lds
    v_mfma_f32_16x16x32_bf16 v[120:123], a[244:247], v[64:67], v[120:123]
    ds_read_b128 v[204:207], v27 offset:29696
    v_mfma_f32_16x16x32_bf16 v[124:127], a[244:247], v[68:71], v[124:127]
    v_mfma_f32_16x16x32_bf16 v[136:139], a[248:251], v[64:67], v[136:139]
    ds_read_b128 v[244:247], v27 offset:30720
    v_mfma_f32_16x16x32_bf16 v[140:143], a[248:251], v[68:71], v[140:143]
    buffer_store_dwordx4 v[160:163], v26, s[32:35], s54 offen offset:0 sc1
    buffer_load_dwordx4 a[236:239], v26, s[32:35], s49 offen offset:3072 sc1
    v_mfma_f32_16x16x32_bf16 v[40:43], a[252:255], v[80:83], v[40:43]
    ds_read_b128 a[240:243], v27 offset:31744
    v_mfma_f32_16x16x32_bf16 v[44:47], a[252:255], v[84:87], v[44:47]
    s_waitcnt lgkmcnt(6)
    v_mfma_f32_16x16x32_bf16 v[56:59], v[176:179], v[80:83], v[56:59]
    ds_read_b128 a[244:247], v27 offset:32768
    v_mfma_f32_16x16x32_bf16 v[60:63], v[176:179], v[84:87], v[60:63]
    v_mfma_f32_16x16x32_bf16 v[72:75], v[180:183], v[80:83], v[72:75]
    ds_read_b128 a[248:251], v27 offset:33792
    v_mfma_f32_16x16x32_bf16 v[76:79], v[180:183], v[84:87], v[76:79]
    v_mfma_f32_16x16x32_bf16 v[88:91], v[184:187], v[80:83], v[88:91]
    ds_read_b128 a[252:255], v27 offset:34816
    v_mfma_f32_16x16x32_bf16 v[92:95], v[184:187], v[84:87], v[92:95]
    v_mfma_f32_16x16x32_bf16 v[104:107], v[188:191], v[80:83], v[104:107]
    ds_read_b128 v[176:179], v27 offset:35840
    v_mfma_f32_16x16x32_bf16 v[108:111], v[188:191], v[84:87], v[108:111]
    s_waitcnt lgkmcnt(6)
    v_mfma_f32_16x16x32_bf16 v[120:123], v[192:195], v[80:83], v[120:123]
    s_waitcnt vmcnt(26)
    s_barrier
    ds_read_b128 v[180:183], v28 offset:0
    v_mfma_f32_16x16x32_bf16 v[124:127], v[192:195], v[84:87], v[124:127]
    buffer_store_dwordx4 v[164:167], v26, s[32:35], s55 offen offset:0 sc1
    v_mfma_f32_16x16x32_bf16 v[136:139], v[196:199], v[80:83], v[136:139]
    ds_read_b128 v[184:187], v28 offset:1024
    v_mfma_f32_16x16x32_bf16 v[140:143], v[196:199], v[84:87], v[140:143]
    s_add_u32 s68, s31, 110592
    s_add_u32 m0, s26, 0
    v_mfma_f32_16x16x32_bf16 v[40:43], v[200:203], v[96:99], v[40:43]
    ds_read_b128 v[188:191], v28 offset:2048
    v_mfma_f32_16x16x32_bf16 v[44:47], v[200:203], v[100:103], v[44:47]
    buffer_load_dwordx4 v26, s[8:11], s68 offen offset:0 sc1 lds
    v_mfma_f32_16x16x32_bf16 v[56:59], v[204:207], v[96:99], v[56:59]
    ds_read_b128 v[192:195], v28 offset:3072
    v_mfma_f32_16x16x32_bf16 v[60:63], v[204:207], v[100:103], v[60:63]
    s_waitcnt lgkmcnt(6)
    v_mfma_f32_16x16x32_bf16 v[72:75], v[244:247], v[96:99], v[72:75]
    ds_read_b128 v[196:199], v28 offset:4096
    v_mfma_f32_16x16x32_bf16 v[76:79], v[244:247], v[100:103], v[76:79]
    buffer_load_dwordx4 v26, s[8:11], s68 offen offset:1024 sc1 lds
    v_mfma_f32_16x16x32_bf16 v[88:91], a[240:243], v[96:99], v[88:91]
    ds_read_b128 v[200:203], v28 offset:5120
    v_mfma_f32_16x16x32_bf16 v[92:95], a[240:243], v[100:103], v[92:95]
    v_mfma_f32_16x16x32_bf16 v[104:107], a[244:247], v[96:99], v[104:107]
    ds_read_b128 v[204:207], v28 offset:6144
    v_mfma_f32_16x16x32_bf16 v[108:111], a[244:247], v[100:103], v[108:111]
    s_waitcnt vmcnt(13)
    s_mov_b32 s67, 400000
ffn_pc4:
    v_cmp_eq_u32 vcc, 1, v252
    s_nop 0
    s_cmp_eq_u64 vcc, exec
    s_cbranch_scc1 ffn_ok4
    s_sub_u32 s67, s67, 1
    s_cbranch_scc1 ffn_ok4
    s_sleep 1
    buffer_load_dword v252, v5, s[36:39], s57 offen offset:16 sc1
    s_waitcnt vmcnt(0)
    s_branch ffn_pc4
ffn_ok4:
    v_mfma_f32_16x16x32_bf16 v[120:123], a[248:251], v[96:99], v[120:123]
    ds_read_b128 v[244:247], v28 offset:7168
    v_mfma_f32_16x16x32_bf16 v[124:127], a[248:251], v[100:103], v[124:127]
    buffer_load_dwordx4 v26, s[8:11], s68 offen offset:2048 sc1 lds
    s_waitcnt lgkmcnt(6)
    v_mfma_f32_16x16x32_bf16 v[136:139], a[252:255], v[96:99], v[136:139]
    ds_read_b128 a[240:243], v28 offset:8192
    v_mfma_f32_16x16x32_bf16 v[140:143], a[252:255], v[100:103], v[140:143]
    s_add_u32 s64, s21, 1
    s_and_b32 s64, s64, 3
    v_mfma_f32_16x16x32_bf16 v[40:43], v[176:179], v[112:115], v[40:43]
    ds_read_b128 a[244:247], v28 offset:9216
    v_mfma_f32_16x16x32_bf16 v[44:47], v[176:179], v[116:119], v[44:47]
    s_mul_i32 s64, s64, 9216
    s_add_u32 s64, s64, s48
    v_mfma_f32_16x16x32_bf16 v[56:59], v[180:183], v[112:115], v[56:59]
    ds_read_b128 a[248:251], v28 offset:10240
    v_mfma_f32_16x16x32_bf16 v[60:63], v[180:183], v[116:119], v[60:63]
    s_add_u32 s64, s64, 4096
    s_add_u32 s49, s64, 147456
    v_mfma_f32_16x16x32_bf16 v[72:75], v[184:187], v[112:115], v[72:75]
    ds_read_b128 a[252:255], v28 offset:11264
    v_mfma_f32_16x16x32_bf16 v[76:79], v[184:187], v[116:119], v[76:79]
    buffer_load_dwordx4 a[0:3], v26, s[32:35], s64 offen offset:0 sc1
    s_waitcnt lgkmcnt(6)
    v_mfma_f32_16x16x32_bf16 v[88:91], v[188:191], v[112:115], v[88:91]
    ds_read_b128 v[176:179], v28 offset:12288
    v_mfma_f32_16x16x32_bf16 v[92:95], v[188:191], v[116:119], v[92:95]
    buffer_load_dwordx4 a[4:7], v26, s[32:35], s49 offen offset:0 sc1
    buffer_load_dwordx4 a[8:11], v26, s[32:35], s64 offen offset:1024 sc1
    v_mfma_f32_16x16x32_bf16 v[104:107], v[192:195], v[112:115], v[104:107]
    ds_read_b128 v[180:183], v28 offset:13312
    v_mfma_f32_16x16x32_bf16 v[108:111], v[192:195], v[116:119], v[108:111]
    buffer_load_dwordx4 a[12:15], v26, s[32:35], s49 offen offset:1024 sc1
    buffer_load_dwordx4 v26, s[8:11], s68 offen offset:3072 sc1 lds
    v_mfma_f32_16x16x32_bf16 v[120:123], v[196:199], v[112:115], v[120:123]
    ds_read_b128 v[184:187], v28 offset:14336
    s_add_u32 s68, s68, 4096
    v_mfma_f32_16x16x32_bf16 v[124:127], v[196:199], v[116:119], v[124:127]
    s_add_u32 m0, s26, 4096
    s_nop 0
    buffer_load_dwordx4 v26, s[8:11], s68 offen offset:0 sc1 lds
    v_mfma_f32_16x16x32_bf16 v[136:139], v[200:203], v[112:115], v[136:139]
    ds_read_b128 v[188:191], v28 offset:15360
    buffer_load_dwordx4 a[16:19], v26, s[32:35], s64 offen offset:2048 sc1
    v_mfma_f32_16x16x32_bf16 v[140:143], v[200:203], v[116:119], v[140:143]
    s_mov_b32 s44, s60
    s_waitcnt lgkmcnt(6)
    v_mfma_f32_16x16x32_bf16 v[40:43], v[204:207], v[128:131], v[40:43]
    ds_read_b128 v[192:195], v28 offset:16384
    s_and_b32 s45, s61, 0xffff
    v_mfma_f32_16x16x32_bf16 v[44:47], v[204:207], v[132:135], v[44:47]
    s_mov_b32 s46, 13824
    s_mov_b32 s47, 0x20000
    v_mfma_f32_16x16x32_bf16 v[56:59], v[244:247], v[128:131], v[56:59]
    ds_read_b128 v[196:199], v28 offset:17408
    s_lshl_b32 s22, s23, 1
    v_mfma_f32_16x16x32_bf16 v[60:63], v[244:247], v[132:135], v[60:63]
    s_add_u32 s20, s22, 2
    s_cmp_eq_u32 s23, 3
    v_mfma_f32_16x16x32_bf16 v[72:75], a[240:243], v[128:131], v[72:75]
    ds_read_b128 v[200:203], v28 offset:18432
    s_cselect_b32 s20, 0, s20
    v_mfma_f32_16x16x32_bf16 v[76:79], a[240:243], v[132:135], v[76:79]
    s_cselect_b32 s22, 7, s22
    s_cselect_b32 s67, 1, 0
    v_mfma_f32_16x16x32_bf16 v[88:91], a[244:247], v[128:131], v[88:91]
    ds_read_b128 v[204:207], v28 offset:19456
    s_mul_i32 s29, s21, 9
    v_mfma_f32_16x16x32_bf16 v[92:95], a[244:247], v[132:135], v[92:95]
    s_add_u32 s29, s29, s22
    s_waitcnt lgkmcnt(6)
    v_mfma_f32_16x16x32_bf16 v[104:107], a[248:251], v[128:131], v[104:107]
    ds_read_b128 v[244:247], v28 offset:20480
    s_sub_u32 s29, s29, s67
    v_mfma_f32_16x16x32_bf16 v[108:111], a[248:251], v[132:135], v[108:111]
    s_mul_i32 s28, s27, 36864
    s_add_u32 s67, s29, 0
    v_mfma_f32_16x16x32_bf16 v[120:123], a[252:255], v[128:131], v[120:123]
    ds_read_b128 a[240:243], v28 offset:21504
    s_lshr_b32 s40, s67, 1
    v_mfma_f32_16x16x32_bf16 v[124:127], a[252:255], v[132:135], v[124:127]
    s_lshl_b32 s40, s40, 10
    s_and_b32 s67, s67, 1
    v_mfma_f32_16x16x32_bf16 v[136:139], v[176:179], v[128:131], v[136:139]
    ds_read_b128 a[244:247], v28 offset:22528
    s_lshl_b32 s67, s67, 3
    v_mfma_f32_16x16x32_bf16 v[140:143], v[176:179], v[132:135], v[140:143]
    s_add_u32 s40, s40, s67
    s_add_u32 s40, s40, s28
    v_mfma_f32_16x16x32_bf16 v[40:43], v[180:183], v[144:147], v[40:43]
    ds_read_b128 a[248:251], v28 offset:23552
    s_add_u32 s67, s29, 1
    v_mfma_f32_16x16x32_bf16 v[44:47], v[180:183], v[148:151], v[44:47]
    s_lshr_b32 s41, s67, 1
    s_waitcnt lgkmcnt(6)
    v_mfma_f32_16x16x32_bf16 v[56:59], v[184:187], v[144:147], v[56:59]
    ds_read_b128 a[252:255], v28 offset:24576
    s_lshl_b32 s41, s41, 10
    v_mfma_f32_16x16x32_bf16 v[60:63], v[184:187], v[148:151], v[60:63]
    s_and_b32 s67, s67, 1
    s_lshl_b32 s67, s67, 3
    v_mfma_f32_16x16x32_bf16 v[72:75], v[188:191], v[144:147], v[72:75]
    ds_read_b128 v[176:179], v28 offset:25600
    s_add_u32 s41, s41, s67
    v_mfma_f32_16x16x32_bf16 v[76:79], v[188:191], v[148:151], v[76:79]
    s_add_u32 s41, s41, s28
    s_add_u32 s67, s29, 2
    v_mfma_f32_16x16x32_bf16 v[88:91], v[192:195], v[144:147], v[88:91]
    ds_read_b128 v[180:183], v28 offset:26624
    s_lshr_b32 s42, s67, 1
    v_mfma_f32_16x16x32_bf16 v[92:95], v[192:195], v[148:151], v[92:95]
    s_lshl_b32 s42, s42, 10
    s_and_b32 s67, s67, 1
    v_mfma_f32_16x16x32_bf16 v[104:107], v[196:199], v[144:147], v[104:107]
    ds_read_b128 v[184:187], v28 offset:27648
    s_lshl_b32 s67, s67, 3
    v_mfma_f32_16x16x32_bf16 v[108:111], v[196:199], v[148:151], v[108:111]
    s_add_u32 s42, s42, s67
    s_waitcnt lgkmcnt(6)
    v_mfma_f32_16x16x32_bf16 v[120:123], v[200:203], v[144:147], v[120:123]
    ds_read_b128 v[188:191], v28 offset:28672
    s_add_u32 s42, s42, s28
    v_mfma_f32_16x16x32_bf16 v[124:127], v[200:203], v[148:151], v[124:127]
    s_lshl_b32 s29, s29, 6
    s_add_u32 s29, s29, 11520
    v_mfma_f32_16x16x32_bf16 v[136:139], v[204:207], v[144:147], v[136:139]
    ds_read_b128 v[192:195], v28 offset:29696
    s_lshl_b32 s67, s23, 10
    v_mfma_f32_16x16x32_bf16 v[140:143], v[204:207], v[148:151], v[140:143]
    s_add_u32 s59, s56, s67
    v_lshlrev_b32 v241, 4, v7
    v_mfma_f32_16x16x32_bf16 v[40:43], v[244:247], v[160:163], v[40:43]
    ds_read_b128 v[196:199], v28 offset:30720
    v_min_u32 v16, 11, v1
    v_mfma_f32_16x16x32_bf16 v[44:47], v[244:247], v[164:167], v[44:47]
    v_lshlrev_b32 v16, 2, v16
    s_lshl_b32 s3, s27, 7
    v_mfma_f32_16x16x32_bf16 v[56:59], a[240:243], v[160:163], v[56:59]
    ds_read_b128 v[200:203], v28 offset:31744
    s_add_u32 s3, s3, 65600
    v_mfma_f32_16x16x32_bf16 v[60:63], a[240:243], v[164:167], v[60:63]
    buffer_load_dwordx4 v26, s[8:11], s68 offen offset:1024 sc1 lds
    s_waitcnt lgkmcnt(6)
    v_mfma_f32_16x16x32_bf16 v[72:75], a[244:247], v[160:163], v[72:75]
    ds_read_b128 v[204:207], v28 offset:32768
    buffer_load_dwordx4 a[20:23], v26, s[32:35], s49 offen offset:2048 sc1
    v_mfma_f32_16x16x32_bf16 v[76:79], a[244:247], v[164:167], v[76:79]
    buffer_load_dwordx4 v26, s[8:11], s68 offen offset:2048 sc1 lds
    s_add_u32 s64, s21, 2
    v_mfma_f32_16x16x32_bf16 v[88:91], a[248:251], v[160:163], v[88:91]
    ds_read_b128 v[244:247], v28 offset:33792
    s_and_b32 s64, s64, 3
    v_mfma_f32_16x16x32_bf16 v[92:95], a[248:251], v[164:167], v[92:95]
    s_mul_i32 s64, s64, 9216
    s_add_u32 s64, s64, s48
    v_mfma_f32_16x16x32_bf16 v[104:107], a[252:255], v[160:163], v[104:107]
    ds_read_b128 a[240:243], v28 offset:34816
    s_add_u32 s64, s64, 4096
    v_mfma_f32_16x16x32_bf16 v[108:111], a[252:255], v[164:167], v[108:111]
    s_add_u32 s49, s64, 147456
    buffer_load_dwordx4 a[24:27], v26, s[32:35], s64 offen offset:0 sc1
    v_mfma_f32_16x16x32_bf16 v[120:123], v[176:179], v[160:163], v[120:123]
    ds_read_b128 a[244:247], v28 offset:35840
    v_mfma_f32_16x16x32_bf16 v[124:127], v[176:179], v[164:167], v[124:127]
    buffer_load_dwordx4 v26, s[8:11], s68 offen offset:3072 sc1 lds
    s_waitcnt lgkmcnt(6)
    v_mfma_f32_16x16x32_bf16 v[136:139], v[180:183], v[160:163], v[136:139]
    s_waitcnt vmcnt(18)
    s_barrier
    ds_read_b128 a[248:251], v29 offset:0
    v_mfma_f32_16x16x32_bf16 v[140:143], v[180:183], v[164:167], v[140:143]
    buffer_load_dwordx4 a[28:31], v26, s[32:35], s49 offen offset:0 sc1
    s_add_u32 s68, s68, 4096
    v_mfma_f32_16x16x32_bf16 v[40:43], v[184:187], a[144:147], v[40:43]
    ds_read_b128 a[252:255], v29 offset:1024
    v_mfma_f32_16x16x32_bf16 v[44:47], v[184:187], a[148:151], v[44:47]
    s_add_u32 m0, s26, 8192
    s_nop 0
    buffer_load_dwordx4 v26, s[8:11], s68 offen offset:0 sc1 lds
    v_mfma_f32_16x16x32_bf16 v[56:59], v[188:191], a[144:147], v[56:59]
    ds_read_b128 v[176:179], v29 offset:2048
    v_mfma_f32_16x16x32_bf16 v[60:63], v[188:191], a[148:151], v[60:63]
    buffer_load_dwordx4 a[32:35], v26, s[32:35], s64 offen offset:1024 sc1
    s_waitcnt vmcnt(18)
    buffer_store_dword v3, v2, s[36:39], s57 offen offset:32 sc1
    v_mfma_f32_16x16x32_bf16 v[72:75], v[192:195], a[144:147], v[72:75]
    ds_read_b128 v[180:183], v29 offset:3072
    v_mfma_f32_16x16x32_bf16 v[76:79], v[192:195], a[148:151], v[76:79]
    buffer_load_dwordx4 a[36:39], v26, s[32:35], s49 offen offset:1024 sc1
    s_waitcnt lgkmcnt(6)
    v_mfma_f32_16x16x32_bf16 v[88:91], v[196:199], a[144:147], v[88:91]
    ds_read_b128 v[184:187], v29 offset:4096
    v_mfma_f32_16x16x32_bf16 v[92:95], v[196:199], a[148:151], v[92:95]
    s_add_u32 s69, s31, 147456
    s_add_u32 m0, s26, 36864
    v_mfma_f32_16x16x32_bf16 v[104:107], v[200:203], a[144:147], v[104:107]
    ds_read_b128 v[188:191], v29 offset:5120
    v_mfma_f32_16x16x32_bf16 v[108:111], v[200:203], a[148:151], v[108:111]
    buffer_load_dwordx4 v26, s[8:11], s69 offen offset:0 sc1 lds
    buffer_load_dwordx4 a[40:43], v26, s[32:35], s64 offen offset:2048 sc1
    v_mfma_f32_16x16x32_bf16 v[120:123], v[204:207], a[144:147], v[120:123]
    ds_read_b128 v[192:195], v29 offset:6144
    v_mfma_f32_16x16x32_bf16 v[124:127], v[204:207], a[148:151], v[124:127]
    buffer_load_dwordx4 v26, s[8:11], s69 offen offset:1024 sc1 lds
    buffer_load_dwordx4 a[44:47], v26, s[32:35], s49 offen offset:2048 sc1
    v_mfma_f32_16x16x32_bf16 v[136:139], v[244:247], a[144:147], v[136:139]
    ds_read_b128 v[196:199], v29 offset:7168
    v_mfma_f32_16x16x32_bf16 v[140:143], v[244:247], a[148:151], v[140:143]
    buffer_load_dwordx4 v26, s[8:11], s69 offen offset:2048 sc1 lds
    s_waitcnt lgkmcnt(6)
    v_mfma_f32_16x16x32_bf16 v[40:43], a[240:243], a[152:155], v[40:43]
    ds_read_b128 v[200:203], v29 offset:8192
    v_mfma_f32_16x16x32_bf16 v[44:47], a[240:243], a[156:159], v[44:47]
    v_mfma_f32_16x16x32_bf16 v[56:59], a[244:247], a[152:155], v[56:59]
    ds_read_b128 v[204:207], v29 offset:9216
    v_mfma_f32_16x16x32_bf16 v[60:63], a[244:247], a[156:159], v[60:63]
    s_add_u32 s64, s21, 3
    s_and_b32 s64, s64, 3
    v_mfma_f32_16x16x32_bf16 v[72:75], a[248:251], a[152:155], v[72:75]
    ds_read_b128 v[244:247], v29 offset:10240
    v_mfma_f32_16x16x32_bf16 v[76:79], a[248:251], a[156:159], v[76:79]
    s_mul_i32 s64, s64, 9216
    s_add_u32 s64, s64, s48
    v_mfma_f32_16x16x32_bf16 v[88:91], a[252:255], a[152:155], v[88:91]
    ds_read_b128 a[240:243], v29 offset:11264
    v_mfma_f32_16x16x32_bf16 v[92:95], a[252:255], a[156:159], v[92:95]
    s_add_u32 s64, s64, 4096
    s_waitcnt lgkmcnt(6)
    v_mfma_f32_16x16x32_bf16 v[104:107], v[176:179], a[152:155], v[104:107]
    ds_read_b128 a[244:247], v29 offset:12288
    v_mfma_f32_16x16x32_bf16 v[108:111], v[176:179], a[156:159], v[108:111]
    s_add_u32 s49, s64, 147456
    buffer_load_dwordx4 a[48:51], v26, s[32:35], s64 offen offset:0 sc1
    v_mfma_f32_16x16x32_bf16 v[120:123], v[180:183], a[152:155], v[120:123]
    ds_read_b128 a[248:251], v29 offset:13312
    v_mfma_f32_16x16x32_bf16 v[124:127], v[180:183], a[156:159], v[124:127]
    buffer_load_dword v252, v5, s[36:39], s57 offen offset:32 sc1
    buffer_load_dwordx4 v26, s[8:11], s69 offen offset:3072 sc1 lds
    v_mfma_f32_16x16x32_bf16 v[136:139], v[184:187], a[152:155], v[136:139]
    ds_read_b128 a[252:255], v29 offset:14336
    v_mfma_f32_16x16x32_bf16 v[140:143], v[184:187], a[156:159], v[140:143]
    buffer_load_dwordx4 a[52:55], v26, s[32:35], s49 offen offset:0 sc1
    s_add_u32 s69, s69, 4096
    v_mfma_f32_16x16x32_bf16 v[40:43], v[188:191], a[160:163], v[40:43]
    ds_read_b128 v[176:179], v29 offset:15360
    v_mfma_f32_16x16x32_bf16 v[44:47], v[188:191], a[164:167], v[44:47]
    s_add_u32 m0, s26, 40960
    s_waitcnt lgkmcnt(6)
    v_mfma_f32_16x16x32_bf16 v[56:59], v[192:195], a[160:163], v[56:59]
    ds_read_b128 v[180:183], v29 offset:16384
    v_mfma_f32_16x16x32_bf16 v[60:63], v[192:195], a[164:167], v[60:63]
    buffer_load_dwordx4 v26, s[8:11], s69 offen offset:0 sc1 lds
    v_mfma_f32_16x16x32_bf16 v[72:75], v[196:199], a[160:163], v[72:75]
    ds_read_b128 v[184:187], v29 offset:17408
    v_mfma_f32_16x16x32_bf16 v[76:79], v[196:199], a[164:167], v[76:79]
    buffer_load_dwordx4 v26, s[8:11], s69 offen offset:1024 sc1 lds
    buffer_load_dwordx4 a[56:59], v26, s[32:35], s64 offen offset:1024 sc1
    v_mfma_f32_16x16x32_bf16 v[88:91], v[200:203], a[160:163], v[88:91]
    ds_read_b128 v[188:191], v29 offset:18432
    v_mfma_f32_16x16x32_bf16 v[92:95], v[200:203], a[164:167], v[92:95]
    v_mfma_f32_16x16x32_bf16 v[104:107], v[204:207], a[160:163], v[104:107]
    ds_read_b128 v[192:195], v29 offset:19456
    v_mfma_f32_16x16x32_bf16 v[108:111], v[204:207], a[164:167], v[108:111]
    s_waitcnt lgkmcnt(6)
    v_mfma_f32_16x16x32_bf16 v[120:123], v[244:247], a[160:163], v[120:123]
    ds_read_b128 v[196:199], v29 offset:20480
    v_mfma_f32_16x16x32_bf16 v[124:127], v[244:247], a[164:167], v[124:127]
    v_mfma_f32_16x16x32_bf16 v[136:139], a[240:243], a[160:163], v[136:139]
    ds_read_b128 v[200:203], v29 offset:21504
    v_mfma_f32_16x16x32_bf16 v[140:143], a[240:243], a[164:167], v[140:143]
    buffer_load_dwordx4 v26, s[8:11], s69 offen offset:2048 sc1 lds
    buffer_load_dwordx4 a[60:63], v26, s[32:35], s49 offen offset:1024 sc1
    v_mfma_f32_16x16x32_bf16 v[40:43], a[244:247], a[168:171], v[40:43]
    ds_read_b128 v[204:207], v29 offset:22528
    v_mfma_f32_16x16x32_bf16 v[44:47], a[244:247], a[172:175], v[44:47]
    v_mfma_f32_16x16x32_bf16 v[56:59], a[248:251], a[168:171], v[56:59]
    ds_read_b128 v[244:247], v29 offset:23552
    v_mfma_f32_16x16x32_bf16 v[60:63], a[248:251], a[172:175], v[60:63]
    s_waitcnt lgkmcnt(6)
    v_mfma_f32_16x16x32_bf16 v[72:75], a[252:255], a[168:171], v[72:75]
    ds_read_b128 a[240:243], v29 offset:24576
    v_mfma_f32_16x16x32_bf16 v[76:79], a[252:255], a[172:175], v[76:79]
    buffer_load_dwordx4 v26, s[8:11], s69 offen offset:3072 sc1 lds
    v_mfma_f32_16x16x32_bf16 v[88:91], v[176:179], a[168:171], v[88:91]
    ds_read_b128 a[244:247], v29 offset:25600
    v_mfma_f32_16x16x32_bf16 v[92:95], v[176:179], a[172:175], v[92:95]
    buffer_load_dwordx4 a[64:67], v26, s[32:35], s64 offen offset:2048 sc1
    v_mfma_f32_16x16x32_bf16 v[104:107], v[180:183], a[168:171], v[104:107]
    ds_read_b128 a[248:251], v29 offset:26624
    v_mfma_f32_16x16x32_bf16 v[108:111], v[180:183], a[172:175], v[108:111]
    v_mfma_f32_16x16x32_bf16 v[120:123], v[184:187], a[168:171], v[120:123]
    ds_read_b128 a[252:255], v29 offset:27648
    v_mfma_f32_16x16x32_bf16 v[124:127], v[184:187], a[172:175], v[124:127]
    s_add_u32 s69, s69, 4096
    s_waitcnt lgkmcnt(6)
    v_mfma_f32_16x16x32_bf16 v[136:139], v[188:191], a[168:171], v[136:139]
    ds_read_b128 v[176:179], v29 offset:28672
    v_mfma_f32_16x16x32_bf16 v[140:143], v[188:191], a[172:175], v[140:143]
    s_add_u32 m0, s26, 45056
    s_nop 0
    buffer_load_dwordx4 v26, s[8:11], s69 offen offset:0 sc1 lds
    v_mfma_f32_16x16x32_bf16 v[40:43], v[192:195], a[176:179], v[40:43]
    ds_read_b128 v[180:183], v29 offset:29696
    v_mfma_f32_16x16x32_bf16 v[44:47], v[192:195], a[180:183], v[44:47]
    buffer_load_dwordx4 a[68:71], v26, s[32:35], s49 offen offset:2048 sc1
    v_mfma_f32_16x16x32_bf16 v[56:59], v[196:199], a[176:179], v[56:59]
    ds_read_b128 v[184:187], v29 offset:30720
    v_mfma_f32_16x16x32_bf16 v[60:63], v[196:199], a[180:183], v[60:63]
    v_mfma_f32_16x16x32_bf16 v[72:75], v[200:203], a[176:179], v[72:75]
    ds_read_b128 v[188:191], v29 offset:31744
    v_mfma_f32_16x16x32_bf16 v[76:79], v[200:203], a[180:183], v[76:79]
    s_waitcnt lgkmcnt(6)
    v_mfma_f32_16x16x32_bf16 v[88:91], v[204:207], a[176:179], v[88:91]
    ds_read_b128 v[192:195], v29 offset:32768
    v_mfma_f32_16x16x32_bf16 v[92:95], v[204:207], a[180:183], v[92:95]
    v_mfma_f32_16x16x32_bf16 v[104:107], v[244:247], a[176:179], v[104:107]
    ds_read_b128 v[196:199], v29 offset:33792
    v_mfma_f32_16x16x32_bf16 v[108:111], v[244:247], a[180:183], v[108:111]
    v_mfma_f32_16x16x32_bf16 v[120:123], a[240:243], a[176:179], v[120:123]
    ds_read_b128 v[200:203], v29 offset:34816
    v_mfma_f32_16x16x32_bf16 v[124:127], a[240:243], a[180:183], v[124:127]
    s_waitcnt vmcnt(11)
    s_mov_b32 s67, 400000
ffn_pc5:
    v_cmp_eq_u32 vcc, 1, v252
    s_nop 0
    s_cmp_eq_u64 vcc, exec
    s_cbranch_scc1 ffn_ok5
    s_sub_u32 s67, s67, 1
    s_cbranch_scc1 ffn_ok5
    s_sleep 1
    buffer_load_dword v252, v5, s[36:39], s57 offen offset:32 sc1
    s_waitcnt vmcnt(0)
    s_branch ffn_pc5
ffn_ok5:
    v_mfma_f32_16x16x32_bf16 v[136:139], a[244:247], a[176:179], v[136:139]
    ds_read_b128 v[204:207], v29 offset:35840
    v_mfma_f32_16x16x32_bf16 v[140:143], a[244:247], a[180:183], v[140:143]
    s_add_u32 s64, s21, 1
    s_waitcnt lgkmcnt(6)
    v_mfma_f32_16x16x32_bf16 v[40:43], a[248:251], a[184:187], v[40:43]
    s_barrier
    ds_read_b128 v[244:247], v26 offset:0
    v_mfma_f32_16x16x32_bf16 v[44:47], a[248:251], a[188:191], v[44:47]
    s_and_b32 s64, s64, 3
    s_mul_i32 s64, s64, 9216
    v_mfma_f32_16x16x32_bf16 v[56:59], a[252:255], a[184:187], v[56:59]
    ds_read_b128 a[240:243], v26 offset:1024
    v_mfma_f32_16x16x32_bf16 v[60:63], a[252:255], a[188:191], v[60:63]
    s_add_u32 s64, s64, s48
    s_add_u32 s64, s64, 4096
    v_mfma_f32_16x16x32_bf16 v[72:75], v[176:179], a[184:187], v[72:75]
    ds_read_b128 a[244:247], v26 offset:2048
    v_mfma_f32_16x16x32_bf16 v[76:79], v[176:179], a[188:191], v[76:79]
    s_add_u32 s49, s64, 147456
    buffer_load_dwordx4 a[72:75], v26, s[32:35], s64 offen offset:3072 sc1
    v_mfma_f32_16x16x32_bf16 v[88:91], v[180:183], a[184:187], v[88:91]
    ds_read_b128 a[248:251], v26 offset:3072
    v_mfma_f32_16x16x32_bf16 v[92:95], v[180:183], a[188:191], v[92:95]
    s_add_u32 s68, s31, 184320
    s_waitcnt lgkmcnt(6)
    v_mfma_f32_16x16x32_bf16 v[104:107], v[184:187], a[184:187], v[104:107]
    ds_read_b128 a[252:255], v26 offset:4096
    v_mfma_f32_16x16x32_bf16 v[108:111], v[184:187], a[188:191], v[108:111]
    s_add_u32 m0, s26, 73728
    s_nop 0
    buffer_load_dwordx4 v26, s[8:11], s68 offen offset:0 sc1 lds
    v_mfma_f32_16x16x32_bf16 v[120:123], v[188:191], a[184:187], v[120:123]
    ds_read_b128 v[176:179], v26 offset:5120
    v_mfma_f32_16x16x32_bf16 v[124:127], v[188:191], a[188:191], v[124:127]
    buffer_load_dwordx4 a[76:79], v26, s[32:35], s49 offen offset:3072 sc1
    buffer_load_dwordx4 v26, s[8:11], s68 offen offset:1024 sc1 lds
    v_mfma_f32_16x16x32_bf16 v[136:139], v[192:195], a[184:187], v[136:139]
    ds_read_b128 v[180:183], v26 offset:6144
    v_mfma_f32_16x16x32_bf16 v[140:143], v[192:195], a[188:191], v[140:143]
    s_add_u32 s64, s64, 4096
    s_add_u32 s49, s49, 4096
    v_mfma_f32_16x16x32_bf16 v[40:43], v[196:199], a[192:195], v[40:43]
    ds_read_b128 v[184:187], v26 offset:7168
    v_mfma_f32_16x16x32_bf16 v[44:47], v[196:199], a[196:199], v[44:47]
    buffer_load_dwordx4 a[80:83], v26, s[32:35], s64 offen offset:0 sc1
    s_waitcnt lgkmcnt(6)
    v_mfma_f32_16x16x32_bf16 v[56:59], v[200:203], a[192:195], v[56:59]
    ds_read_b128 v[188:191], v26 offset:8192
    v_mfma_f32_16x16x32_bf16 v[60:63], v[200:203], a[196:199], v[60:63]
    buffer_load_dwordx4 v26, s[8:11], s68 offen offset:2048 sc1 lds
    buffer_load_dwordx4 a[84:87], v26, s[32:35], s49 offen offset:0 sc1
    v_mfma_f32_16x16x32_bf16 v[72:75], v[204:207], a[192:195], v[72:75]
    ds_read_b128 v[192:195], v26 offset:9216
    v_mfma_f32_16x16x32_bf16 v[76:79], v[204:207], a[196:199], v[76:79]
    v_mfma_f32_16x16x32_bf16 v[88:91], v[244:247], a[192:195], v[88:91]
    ds_read_b128 v[196:199], v26 offset:10240
    v_mfma_f32_16x16x32_bf16 v[92:95], v[244:247], a[196:199], v[92:95]
    v_mfma_f32_16x16x32_bf16 v[104:107], a[240:243], a[192:195], v[104:107]
    ds_read_b128 v[200:203], v26 offset:11264
    v_mfma_f32_16x16x32_bf16 v[108:111], a[240:243], a[196:199], v[108:111]
    buffer_load_dwordx4 v26, s[8:11], s68 offen offset:3072 sc1 lds
    s_waitcnt lgkmcnt(6)
    v_mfma_f32_16x16x32_bf16 v[120:123], a[244:247], a[192:195], v[120:123]
    ds_read_b128 v[204:207], v26 offset:12288
    v_mfma_f32_16x16x32_bf16 v[124:127], a[244:247], a[196:199], v[124:127]
    s_add_u32 s64, s21, 2
    s_and_b32 s64, s64, 3
    v_mfma_f32_16x16x32_bf16 v[136:139], a[248:251], a[192:195], v[136:139]
    ds_read_b128 v[244:247], v26 offset:13312
    v_mfma_f32_16x16x32_bf16 v[140:143], a[248:251], a[196:199], v[140:143]
    s_mul_i32 s64, s64, 9216
    s_add_u32 s64, s64, s48
    v_mfma_f32_16x16x32_bf16 v[40:43], a[252:255], a[200:203], v[40:43]
    ds_read_b128 a[240:243], v26 offset:14336
    v_mfma_f32_16x16x32_bf16 v[44:47], a[252:255], a[204:207], v[44:47]
    s_add_u32 s64, s64, 4096
    s_add_u32 s49, s64, 147456
    v_mfma_f32_16x16x32_bf16 v[56:59], v[176:179], a[200:203], v[56:59]
    ds_read_b128 a[244:247], v26 offset:15360
    v_mfma_f32_16x16x32_bf16 v[60:63], v[176:179], a[204:207], v[60:63]
    buffer_load_dwordx4 a[88:91], v26, s[32:35], s64 offen offset:3072 sc1
    s_waitcnt lgkmcnt(6)
    v_mfma_f32_16x16x32_bf16 v[72:75], v[180:183], a[200:203], v[72:75]
    ds_read_b128 a[248:251], v26 offset:16384
    v_mfma_f32_16x16x32_bf16 v[76:79], v[180:183], a[204:207], v[76:79]
    s_add_u32 s68, s68, 4096
    s_add_u32 m0, s26, 77824
    v_mfma_f32_16x16x32_bf16 v[88:91], v[184:187], a[200:203], v[88:91]
    ds_read_b128 a[252:255], v26 offset:17408
    v_mfma_f32_16x16x32_bf16 v[92:95], v[184:187], a[204:207], v[92:95]
    buffer_load_dwordx4 v26, s[8:11], s68 offen offset:0 sc1 lds
    buffer_load_dwordx4 a[92:95], v26, s[32:35], s49 offen offset:3072 sc1
    v_mfma_f32_16x16x32_bf16 v[104:107], v[188:191], a[200:203], v[104:107]
    ds_read_b128 v[176:179], v26 offset:18432
    v_mfma_f32_16x16x32_bf16 v[108:111], v[188:191], a[204:207], v[108:111]
    buffer_load_dwordx4 v26, s[8:11], s68 offen offset:1024 sc1 lds
    v_mfma_f32_16x16x32_bf16 v[120:123], v[192:195], a[200:203], v[120:123]
    ds_read_b128 v[180:183], v26 offset:19456
    v_mfma_f32_16x16x32_bf16 v[124:127], v[192:195], a[204:207], v[124:127]
    s_waitcnt lgkmcnt(6)
    v_mfma_f32_16x16x32_bf16 v[136:139], v[196:199], a[200:203], v[136:139]
    ds_read_b128 v[184:187], v26 offset:20480
    v_mfma_f32_16x16x32_bf16 v[140:143], v[196:199], a[204:207], v[140:143]
    s_add_u32 s64, s64, 4096
    s_add_u32 s49, s49, 4096
    v_mfma_f32_16x16x32_bf16 v[40:43], v[200:203], a[208:211], v[40:43]
    ds_read_b128 v[188:191], v26 offset:21504
    v_mfma_f32_16x16x32_bf16 v[44:47], v[200:203], a[212:215], v[44:47]
    buffer_load_dwordx4 a[96:99], v26, s[32:35], s64 offen offset:0 sc1
    buffer_load_dwordx4 v26, s[8:11], s68 offen offset:2048 sc1 lds
    v_mfma_f32_16x16x32_bf16 v[56:59], v[204:207], a[208:211], v[56:59]
    ds_read_b128 v[192:195], v26 offset:22528
    v_mfma_f32_16x16x32_bf16 v[60:63], v[204:207], a[212:215], v[60:63]
    v_mfma_f32_16x16x32_bf16 v[72:75], v[244:247], a[208:211], v[72:75]
    ds_read_b128 v[196:199], v26 offset:23552
    v_mfma_f32_16x16x32_bf16 v[76:79], v[244:247], a[212:215], v[76:79]
    s_waitcnt lgkmcnt(6)
    v_mfma_f32_16x16x32_bf16 v[88:91], a[240:243], a[208:211], v[88:91]
    ds_read_b128 v[200:203], v26 offset:24576
    v_mfma_f32_16x16x32_bf16 v[92:95], a[240:243], a[212:215], v[92:95]
    buffer_load_dwordx4 v26, s[8:11], s68 offen offset:3072 sc1 lds
    buffer_load_dwordx4 a[100:103], v26, s[32:35], s49 offen offset:0 sc1
    v_mfma_f32_16x16x32_bf16 v[104:107], a[244:247], a[208:211], v[104:107]
    ds_read_b128 v[204:207], v26 offset:25600
    v_mfma_f32_16x16x32_bf16 v[108:111], a[244:247], a[212:215], v[108:111]
    v_mfma_f32_16x16x32_bf16 v[120:123], a[248:251], a[208:211], v[120:123]
    ds_read_b128 v[244:247], v26 offset:26624
    v_mfma_f32_16x16x32_bf16 v[124:127], a[248:251], a[212:215], v[124:127]
    v_mfma_f32_16x16x32_bf16 v[136:139], a[252:255], a[208:211], v[136:139]
    ds_read_b128 a[240:243], v26 offset:27648
    v_mfma_f32_16x16x32_bf16 v[140:143], a[252:255], a[212:215], v[140:143]
    s_add_u32 s68, s68, 4096
    s_waitcnt lgkmcnt(6)
    v_mfma_f32_16x16x32_bf16 v[40:43], v[176:179], a[216:219], v[40:43]
    ds_read_b128 a[244:247], v26 offset:28672
    v_mfma_f32_16x16x32_bf16 v[44:47], v[176:179], a[220:223], v[44:47]
    s_add_u32 m0, s26, 81920
    s_nop 0
    buffer_load_dwordx4 v26, s[8:11], s68 offen offset:0 sc1 lds
    v_mfma_f32_16x16x32_bf16 v[56:59], v[180:183], a[216:219], v[56:59]
    ds_read_b128 a[248:251], v26 offset:29696
    v_mfma_f32_16x16x32_bf16 v[60:63], v[180:183], a[220:223], v[60:63]
    s_add_u32 s64, s21, 3
    s_and_b32 s64, s64, 3
    v_mfma_f32_16x16x32_bf16 v[72:75], v[184:187], a[216:219], v[72:75]
    ds_read_b128 a[252:255], v26 offset:30720
    v_mfma_f32_16x16x32_bf16 v[76:79], v[184:187], a[220:223], v[76:79]
    s_mul_i32 s64, s64, 9216
    s_add_u32 s64, s64, s48
    v_mfma_f32_16x16x32_bf16 v[88:91], v[188:191], a[216:219], v[88:91]
    ds_read_b128 v[176:179], v26 offset:31744
    v_mfma_f32_16x16x32_bf16 v[92:95], v[188:191], a[220:223], v[92:95]
    s_add_u32 s64, s64, 4096
    s_waitcnt lgkmcnt(6)
    v_mfma_f32_16x16x32_bf16 v[104:107], v[192:195], a[216:219], v[104:107]
    ds_read_b128 v[180:183], v26 offset:32768
    v_mfma_f32_16x16x32_bf16 v[108:111], v[192:195], a[220:223], v[108:111]
    s_add_u32 s49, s64, 147456
    buffer_load_dwordx4 a[104:107], v26, s[32:35], s64 offen offset:3072 sc1
    v_mfma_f32_16x16x32_bf16 v[120:123], v[196:199], a[216:219], v[120:123]
    ds_read_b128 v[184:187], v26 offset:33792
    v_mfma_f32_16x16x32_bf16 v[124:127], v[196:199], a[220:223], v[124:127]
    buffer_load_dwordx4 a[108:111], v26, s[32:35], s49 offen offset:3072 sc1
    v_mfma_f32_16x16x32_bf16 v[136:139], v[200:203], a[216:219], v[136:139]
    ds_read_b128 v[188:191], v26 offset:34816
    v_mfma_f32_16x16x32_bf16 v[140:143], v[200:203], a[220:223], v[140:143]
    v_mfma_f32_16x16x32_bf16 v[40:43], v[204:207], a[224:227], v[40:43]
    ds_read_b128 v[192:195], v26 offset:35840
    v_mfma_f32_16x16x32_bf16 v[44:47], v[204:207], a[228:231], v[44:47]
    s_waitcnt lgkmcnt(6)
    v_mfma_f32_16x16x32_bf16 v[56:59], v[244:247], a[224:227], v[56:59]
    s_waitcnt vmcnt(20)
    s_barrier
    ds_read_b128 v[196:199], v27 offset:0
    v_mfma_f32_16x16x32_bf16 v[60:63], v[244:247], a[228:231], v[60:63]
    s_add_u32 s64, s64, 4096
    s_add_u32 s49, s49, 4096
    v_mfma_f32_16x16x32_bf16 v[72:75], a[240:243], a[224:227], v[72:75]
    ds_read_b128 v[200:203], v27 offset:1024
    v_mfma_f32_16x16x32_bf16 v[76:79], a[240:243], a[228:231], v[76:79]
    buffer_load_dwordx4 a[112:115], v26, s[32:35], s64 offen offset:0 sc1
    s_add_u32 s69, s31, 221184
    v_mfma_f32_16x16x32_bf16 v[88:91], a[244:247], a[224:227], v[88:91]
    ds_read_b128 v[204:207], v27 offset:2048
    v_mfma_f32_16x16x32_bf16 v[92:95], a[244:247], a[228:231], v[92:95]
    s_add_u32 m0, s26, 110592
    s_nop 0
    buffer_load_dwordx4 v26, s[8:11], s69 offen offset:0 sc1 lds
    v_mfma_f32_16x16x32_bf16 v[104:107], a[248:251], a[224:227], v[104:107]
    ds_read_b128 v[244:247], v27 offset:3072
    v_mfma_f32_16x16x32_bf16 v[108:111], a[248:251], a[228:231], v[108:111]
    s_waitcnt lgkmcnt(6)
    v_mfma_f32_16x16x32_bf16 v[120:123], a[252:255], a[224:227], v[120:123]
    ds_read_b128 a[240:243], v27 offset:4096
    v_mfma_f32_16x16x32_bf16 v[124:127], a[252:255], a[228:231], v[124:127]
    buffer_load_dwordx4 v26, s[8:11], s69 offen offset:1024 sc1 lds
    buffer_load_dwordx4 a[116:119], v26, s[32:35], s49 offen offset:0 sc1
    v_mfma_f32_16x16x32_bf16 v[136:139], v[176:179], a[224:227], v[136:139]
    ds_read_b128 a[244:247], v27 offset:5120
    v_mfma_f32_16x16x32_bf16 v[140:143], v[176:179], a[228:231], v[140:143]
    v_mfma_f32_16x16x32_bf16 v[40:43], v[180:183], a[232:235], v[40:43]
    ds_read_b128 a[248:251], v27 offset:6144
    v_mfma_f32_16x16x32_bf16 v[44:47], v[180:183], a[236:239], v[44:47]
    v_mfma_f32_16x16x32_bf16 v[56:59], v[184:187], a[232:235], v[56:59]
    ds_read_b128 a[252:255], v27 offset:7168
    v_mfma_f32_16x16x32_bf16 v[60:63], v[184:187], a[236:239], v[60:63]
    buffer_load_dwordx4 v26, s[8:11], s69 offen offset:2048 sc1 lds
    s_waitcnt lgkmcnt(6)
    v_mfma_f32_16x16x32_bf16 v[72:75], v[188:191], a[232:235], v[72:75]
    ds_read_b128 v[176:179], v27 offset:8192
    v_mfma_f32_16x16x32_bf16 v[76:79], v[188:191], a[236:239], v[76:79]
    v_mfma_f32_16x16x32_bf16 v[88:91], v[192:195], a[232:235], v[88:91]
    ds_read_b128 v[180:183], v27 offset:9216
    v_mfma_f32_16x16x32_bf16 v[92:95], v[192:195], a[236:239], v[92:95]
    v_mfma_f32_16x16x32_bf16 v[104:107], v[196:199], a[232:235], v[104:107]
    ds_read_b128 v[184:187], v27 offset:10240
    v_mfma_f32_16x16x32_bf16 v[108:111], v[196:199], a[236:239], v[108:111]
    v_mfma_f32_16x16x32_bf16 v[120:123], v[200:203], a[232:235], v[120:123]
    ds_read_b128 v[188:191], v27 offset:11264
    v_mfma_f32_16x16x32_bf16 v[124:127], v[200:203], a[236:239], v[124:127]
    buffer_load_dwordx4 v26, s[8:11], s69 offen offset:3072 sc1 lds
    s_waitcnt lgkmcnt(6)
    v_mfma_f32_16x16x32_bf16 v[136:139], v[204:207], a[232:235], v[136:139]
    ds_read_b128 v[192:195], v27 offset:12288
    v_mfma_f32_16x16x32_bf16 v[140:143], v[204:207], a[236:239], v[140:143]
    v_mfma_f32_16x16x32_bf16 v[40:43], v[244:247], a[0:3], v[40:43]
    ds_read_b128 v[196:199], v27 offset:13312
    v_mfma_f32_16x16x32_bf16 v[44:47], v[244:247], a[4:7], v[44:47]
    v_mfma_f32_16x16x32_bf16 v[56:59], a[240:243], a[0:3], v[56:59]
    ds_read_b128 v[200:203], v27 offset:14336
    v_mfma_f32_16x16x32_bf16 v[60:63], a[240:243], a[4:7], v[60:63]
    s_add_u32 s69, s69, 4096
    s_add_u32 m0, s26, 114688
    v_mfma_f32_16x16x32_bf16 v[72:75], a[244:247], a[0:3], v[72:75]
    ds_read_b128 v[204:207], v27 offset:15360
    v_mfma_f32_16x16x32_bf16 v[76:79], a[244:247], a[4:7], v[76:79]
    buffer_load_dwordx4 v26, s[8:11], s69 offen offset:0 sc1 lds
    s_waitcnt lgkmcnt(6)
    v_mfma_f32_16x16x32_bf16 v[88:91], a[248:251], a[0:3], v[88:91]
    ds_read_b128 v[244:247], v27 offset:16384
    v_mfma_f32_16x16x32_bf16 v[92:95], a[248:251], a[4:7], v[92:95]
    v_mfma_f32_16x16x32_bf16 v[104:107], a[252:255], a[0:3], v[104:107]
    ds_read_b128 a[240:243], v27 offset:17408
    v_mfma_f32_16x16x32_bf16 v[108:111], a[252:255], a[4:7], v[108:111]
    buffer_load_dwordx4 v26, s[8:11], s69 offen offset:1024 sc1 lds
    v_mfma_f32_16x16x32_bf16 v[120:123], v[176:179], a[0:3], v[120:123]
    ds_read_b128 a[244:247], v27 offset:18432
    v_mfma_f32_16x16x32_bf16 v[124:127], v[176:179], a[4:7], v[124:127]
    buffer_load_dword v252, v16, s[36:39], s3 offen offset:0 sc1
    v_mfma_f32_16x16x32_bf16 v[136:139], v[180:183], a[0:3], v[136:139]
    ds_read_b128 a[248:251], v27 offset:19456
    v_mfma_f32_16x16x32_bf16 v[140:143], v[180:183], a[4:7], v[140:143]
    s_waitcnt lgkmcnt(6)
    v_mfma_f32_16x16x32_bf16 v[40:43], v[184:187], a[8:11], v[40:43]
    ds_read_b128 a[252:255], v27 offset:20480
    v_mfma_f32_16x16x32_bf16 v[44:47], v[184:187], a[12:15], v[44:47]
    v_mfma_f32_16x16x32_bf16 v[56:59], v[188:191], a[8:11], v[56:59]
    ds_read_b128 v[176:179], v27 offset:21504
    v_mfma_f32_16x16x32_bf16 v[60:63], v[188:191], a[12:15], v[60:63]
    buffer_load_dwordx4 v26, s[8:11], s69 offen offset:2048 sc1 lds
    v_mfma_f32_16x16x32_bf16 v[72:75], v[192:195], a[8:11], v[72:75]
    ds_read_b128 v[180:183], v27 offset:22528
    v_mfma_f32_16x16x32_bf16 v[76:79], v[192:195], a[12:15], v[76:79]
    v_mfma_f32_16x16x32_bf16 v[88:91], v[196:199], a[8:11], v[88:91]
    ds_read_b128 v[184:187], v27 offset:23552
    v_mfma_f32_16x16x32_bf16 v[92:95], v[196:199], a[12:15], v[92:95]
    s_waitcnt lgkmcnt(6)
    v_mfma_f32_16x16x32_bf16 v[104:107], v[200:203], a[8:11], v[104:107]
    ds_read_b128 v[188:191], v27 offset:24576
    v_mfma_f32_16x16x32_bf16 v[108:111], v[200:203], a[12:15], v[108:111]
    buffer_load_dwordx4 v26, s[8:11], s69 offen offset:3072 sc1 lds
    v_mfma_f32_16x16x32_bf16 v[120:123], v[204:207], a[8:11], v[120:123]
    ds_read_b128 v[192:195], v27 offset:25600
    v_mfma_f32_16x16x32_bf16 v[124:127], v[204:207], a[12:15], v[124:127]
    v_mfma_f32_16x16x32_bf16 v[136:139], v[244:247], a[8:11], v[136:139]
    ds_read_b128 v[196:199], v27 offset:26624
    v_mfma_f32_16x16x32_bf16 v[140:143], v[244:247], a[12:15], v[140:143]
    v_mfma_f32_16x16x32_bf16 v[40:43], a[240:243], a[16:19], v[40:43]
    ds_read_b128 v[200:203], v27 offset:27648
    v_mfma_f32_16x16x32_bf16 v[44:47], a[240:243], a[20:23], v[44:47]
    s_add_u32 s69, s69, 4096
    s_waitcnt lgkmcnt(6)
    v_mfma_f32_16x16x32_bf16 v[56:59], a[244:247], a[16:19], v[56:59]
    ds_read_b128 v[204:207], v27 offset:28672
    v_mfma_f32_16x16x32_bf16 v[60:63], a[244:247], a[20:23], v[60:63]
    s_add_u32 m0, s26, 118784
    s_nop 0
    buffer_load_dwordx4 v26, s[8:11], s69 offen offset:0 sc1 lds
    v_mfma_f32_16x16x32_bf16 v[72:75], a[248:251], a[16:19], v[72:75]
    ds_read_b128 v[244:247], v27 offset:29696
    v_mfma_f32_16x16x32_bf16 v[76:79], a[248:251], a[20:23], v[76:79]
    v_mfma_f32_16x16x32_bf16 v[88:91], a[252:255], a[16:19], v[88:91]
    ds_read_b128 a[240:243], v27 offset:30720
    v_mfma_f32_16x16x32_bf16 v[92:95], a[252:255], a[20:23], v[92:95]
    v_mfma_f32_16x16x32_bf16 v[104:107], v[176:179], a[16:19], v[104:107]
    ds_read_b128 a[244:247], v27 offset:31744
    v_mfma_f32_16x16x32_bf16 v[108:111], v[176:179], a[20:23], v[108:111]
    s_waitcnt lgkmcnt(6)
    v_mfma_f32_16x16x32_bf16 v[120:123], v[180:183], a[16:19], v[120:123]
    ds_read_b128 a[248:251], v27 offset:32768
    v_mfma_f32_16x16x32_bf16 v[124:127], v[180:183], a[20:23], v[124:127]
    v_mfma_f32_16x16x32_bf16 v[136:139], v[184:187], a[16:19], v[136:139]
    ds_read_b128 a[252:255], v27 offset:33792
    v_mfma_f32_16x16x32_bf16 v[140:143], v[184:187], a[20:23], v[140:143]
    v_mfma_f32_16x16x32_bf16 v[40:43], v[188:191], a[24:27], v[40:43]
    ds_read_b128 v[176:179], v27 offset:34816
    v_mfma_f32_16x16x32_bf16 v[44:47], v[188:191], a[28:31], v[44:47]
    v_mfma_f32_16x16x32_bf16 v[56:59], v[192:195], a[24:27], v[56:59]
    ds_read_b128 v[180:183], v27 offset:35840
    v_mfma_f32_16x16x32_bf16 v[60:63], v[192:195], a[28:31], v[60:63]
    s_waitcnt lgkmcnt(6)
    v_mfma_f32_16x16x32_bf16 v[72:75], v[196:199], a[24:27], v[72:75]
    s_waitcnt vmcnt(14)
    s_barrier
    ds_read_b128 v[184:187], v28 offset:0
    v_mfma_f32_16x16x32_bf16 v[76:79], v[196:199], a[28:31], v[76:79]
    v_mfma_f32_16x16x32_bf16 v[88:91], v[200:203], a[24:27], v[88:91]
    ds_read_b128 v[188:191], v28 offset:1024
    v_mfma_f32_16x16x32_bf16 v[92:95], v[200:203], a[28:31], v[92:95]
    s_add_u32 s68, s31, 258048
    s_add_u32 m0, s26, 0
    v_mfma_f32_16x16x32_bf16 v[104:107], v[204:207], a[24:27], v[104:107]
    ds_read_b128 v[192:195], v28 offset:2048
    v_mfma_f32_16x16x32_bf16 v[108:111], v[204:207], a[28:31], v[108:111]
    buffer_load_dwordx4 v26, s[8:11], s68 offen offset:0 sc1 lds
    v_mfma_f32_16x16x32_bf16 v[120:123], v[244:247], a[24:27], v[120:123]
    ds_read_b128 v[196:199], v28 offset:3072
    v_mfma_f32_16x16x32_bf16 v[124:127], v[244:247], a[28:31], v[124:127]
    s_waitcnt lgkmcnt(6)
    v_mfma_f32_16x16x32_bf16 v[136:139], a[240:243], a[24:27], v[136:139]
    ds_read_b128 v[200:203], v28 offset:4096
    v_mfma_f32_16x16x32_bf16 v[140:143], a[240:243], a[28:31], v[140:143]
    buffer_load_dwordx4 v26, s[8:11], s68 offen offset:1024 sc1 lds
    v_mfma_f32_16x16x32_bf16 v[40:43], a[244:247], a[32:35], v[40:43]
    ds_read_b128 v[204:207], v28 offset:5120
    v_mfma_f32_16x16x32_bf16 v[44:47], a[244:247], a[36:39], v[44:47]
    v_mfma_f32_16x16x32_bf16 v[56:59], a[248:251], a[32:35], v[56:59]
    ds_read_b128 v[244:247], v28 offset:6144
    v_mfma_f32_16x16x32_bf16 v[60:63], a[248:251], a[36:39], v[60:63]
    v_mfma_f32_16x16x32_bf16 v[72:75], a[252:255], a[32:35], v[72:75]
    ds_read_b128 a[240:243], v28 offset:7168
    v_mfma_f32_16x16x32_bf16 v[76:79], a[252:255], a[36:39], v[76:79]
    buffer_load_dwordx4 v26, s[8:11], s68 offen offset:2048 sc1 lds
    s_waitcnt lgkmcnt(6)
    v_mfma_f32_16x16x32_bf16 v[88:91], v[176:179], a[32:35], v[88:91]
    ds_read_b128 a[244:247], v28 offset:8192
    v_mfma_f32_16x16x32_bf16 v[92:95], v[176:179], a[36:39], v[92:95]
    v_mfma_f32_16x16x32_bf16 v[104:107], v[180:183], a[32:35], v[104:107]
    ds_read_b128 a[248:251], v28 offset:9216
    v_mfma_f32_16x16x32_bf16 v[108:111], v[180:183], a[36:39], v[108:111]
    v_mfma_f32_16x16x32_bf16 v[120:123], v[184:187], a[32:35], v[120:123]
    ds_read_b128 a[252:255], v28 offset:10240
    v_mfma_f32_16x16x32_bf16 v[124:127], v[184:187], a[36:39], v[124:127]
    v_mfma_f32_16x16x32_bf16 v[136:139], v[188:191], a[32:35], v[136:139]
    ds_read_b128 v[176:179], v28 offset:11264
    v_mfma_f32_16x16x32_bf16 v[140:143], v[188:191], a[36:39], v[140:143]
    buffer_load_dwordx4 v26, s[8:11], s68 offen offset:3072 sc1 lds
    s_waitcnt lgkmcnt(6)
    v_mfma_f32_16x16x32_bf16 v[40:43], v[192:195], a[40:43], v[40:43]
    ds_read_b128 v[180:183], v28 offset:12288
    v_mfma_f32_16x16x32_bf16 v[44:47], v[192:195], a[44:47], v[44:47]
    v_mfma_f32_16x16x32_bf16 v[40:43], v[196:199], a[48:51], v[40:43]
    ds_read_b128 v[184:187], v28 offset:13312
    v_mfma_f32_16x16x32_bf16 v[44:47], v[196:199], a[52:55], v[44:47]
    v_mfma_f32_16x16x32_bf16 v[40:43], v[200:203], a[56:59], v[40:43]
    ds_read_b128 v[188:191], v28 offset:14336
    v_mfma_f32_16x16x32_bf16 v[44:47], v[200:203], a[60:63], v[44:47]
    s_add_u32 s68, s68, 4096
    s_add_u32 m0, s26, 4096
    v_mfma_f32_16x16x32_bf16 v[40:43], v[204:207], a[64:67], v[40:43]
    ds_read_b128 v[192:195], v28 offset:15360
    v_mfma_f32_16x16x32_bf16 v[44:47], v[204:207], a[68:71], v[44:47]
    buffer_load_dwordx4 v26, s[8:11], s68 offen offset:0 sc1 lds
    s_waitcnt lgkmcnt(6)
    v_mfma_f32_16x16x32_bf16 v[40:43], v[244:247], a[72:75], v[40:43]
    ds_read_b128 v[196:199], v28 offset:16384
    v_mfma_f32_16x16x32_bf16 v[44:47], v[244:247], a[76:79], v[44:47]
    s_waitcnt vmcnt(8)
    s_mov_b32 s67, 400000
ffn_pc6:
    v_cmp_eq_u32 vcc, 1, v252
    s_nop 0
    s_cmp_eq_u64 vcc, exec
    s_cbranch_scc1 ffn_ok6
    s_sub_u32 s67, s67, 1
    s_cbranch_scc1 ffn_ok6
    s_sleep 1
    buffer_load_dword v252, v16, s[36:39], s3 offen offset:0 sc1
    s_waitcnt vmcnt(0)
    s_branch ffn_pc6
ffn_ok6:
    v_mfma_f32_16x16x32_bf16 v[40:43], a[240:243], a[80:83], v[40:43]
    ds_read_b128 v[200:203], v28 offset:17408
    v_mfma_f32_16x16x32_bf16 v[44:47], a[240:243], a[84:87], v[44:47]
    buffer_load_dwordx4 v26, s[8:11], s68 offen offset:1024 sc1 lds
    v_mfma_f32_16x16x32_bf16 v[40:43], a[244:247], a[88:91], v[40:43]
    ds_read_b128 v[204:207], v28 offset:18432
    v_mfma_f32_16x16x32_bf16 v[44:47], a[244:247], a[92:95], v[44:47]
    buffer_load_dwordx2 v[208:209], v26, s[16:19], s40 offen sc1
    v_mfma_f32_16x16x32_bf16 v[40:43], a[248:251], a[96:99], v[40:43]
    ds_read_b128 v[244:247], v28 offset:19456
    v_mfma_f32_16x16x32_bf16 v[44:47], a[248:251], a[100:103], v[44:47]
    s_waitcnt lgkmcnt(6)
    v_mfma_f32_16x16x32_bf16 v[40:43], a[252:255], a[104:107], v[40:43]
    ds_read_b128 a[240:243], v28 offset:20480
    v_mfma_f32_16x16x32_bf16 v[44:47], a[252:255], a[108:111], v[44:47]
    s_add_u32 s66, s20, 0
    s_cmp_ge_u32 s66, 9
    v_mfma_f32_16x16x32_bf16 v[40:43], v[176:179], a[112:115], v[40:43]
    ds_read_b128 a[244:247], v28 offset:21504
    v_mfma_f32_16x16x32_bf16 v[44:47], v[176:179], a[116:119], v[44:47]
    s_cselect_b32 s67, 9, 0
    s_sub_u32 s66, s66, s67
    v_mfma_f32_16x16x32_bf16 v[56:59], v[180:183], a[40:43], v[56:59]
    ds_read_b128 a[248:251], v28 offset:22528
    v_mfma_f32_16x16x32_bf16 v[60:63], v[180:183], a[44:47], v[60:63]
    s_lshl_b32 s66, s66, 12
    s_add_u32 s66, s66, s59
    v_mfma_f32_16x16x32_bf16 v[56:59], v[184:187], a[48:51], v[56:59]
    ds_read_b128 a[252:255], v28 offset:23552
    v_mfma_f32_16x16x32_bf16 v[60:63], v[184:187], a[52:55], v[60:63]
    buffer_load_dwordx4 v26, s[8:11], s68 offen offset:2048 sc1 lds
    s_waitcnt lgkmcnt(6)
    v_mfma_f32_16x16x32_bf16 v[56:59], v[188:191], a[56:59], v[56:59]
    ds_read_b128 v[176:179], v28 offset:24576
    v_mfma_f32_16x16x32_bf16 v[60:63], v[188:191], a[60:63], v[60:63]
    buffer_load_dwordx2 v[210:211], v25, s[16:19], s40 offen sc1
    buffer_load_dwordx4 v26, s[8:11], s68 offen offset:3072 sc1 lds
    v_mfma_f32_16x16x32_bf16 v[56:59], v[192:195], a[64:67], v[56:59]
    ds_read_b128 v[180:183], v28 offset:25600
    v_mfma_f32_16x16x32_bf16 v[60:63], v[192:195], a[68:71], v[60:63]
    v_cvt_pk_bf16_f32 v40, v40, v41
    v_cvt_pk_bf16_f32 v41, v42, v43
    v_mfma_f32_16x16x32_bf16 v[56:59], v[196:199], a[72:75], v[56:59]
    ds_read_b128 v[184:187], v28 offset:26624
    v_mfma_f32_16x16x32_bf16 v[60:63], v[196:199], a[76:79], v[60:63]
    v_cvt_pk_bf16_f32 v42, v44, v45
    v_cvt_pk_bf16_f32 v43, v46, v47
    v_mfma_f32_16x16x32_bf16 v[56:59], v[200:203], a[80:83], v[56:59]
    ds_read_b128 v[188:191], v28 offset:27648
    v_mfma_f32_16x16x32_bf16 v[60:63], v[200:203], a[84:87], v[60:63]
    buffer_store_dwordx4 v[40:43], v26, s[12:15], s66 offen sc1
    s_waitcnt lgkmcnt(6)
    v_mfma_f32_16x16x32_bf16 v[56:59], v[204:207], a[88:91], v[56:59]
    ds_read_b128 v[192:195], v28 offset:28672
    v_mfma_f32_16x16x32_bf16 v[60:63], v[204:207], a[92:95], v[60:63]
    s_add_u32 s68, s68, 4096
    s_add_u32 m0, s26, 8192
    v_mfma_f32_16x16x32_bf16 v[56:59], v[244:247], a[96:99], v[56:59]
    ds_read_b128 v[196:199], v28 offset:29696
    v_mfma_f32_16x16x32_bf16 v[60:63], v[244:247], a[100:103], v[60:63]
    buffer_load_dwordx4 v26, s[8:11], s68 offen offset:0 sc1 lds
    buffer_load_dwordx4 v[220:223], v241, s[44:47], s29 offen offset:0
    v_mfma_f32_16x16x32_bf16 v[56:59], a[240:243], a[104:107], v[56:59]
    ds_read_b128 v[200:203], v28 offset:30720
    v_mfma_f32_16x16x32_bf16 v[60:63], a[240:243], a[108:111], v[60:63]
    s_add_u32 s66, s20, 1
    s_cmp_ge_u32 s66, 9
    v_mfma_f32_16x16x32_bf16 v[56:59], a[244:247], a[112:115], v[56:59]
    ds_read_b128 v[204:207], v28 offset:31744
    v_mfma_f32_16x16x32_bf16 v[60:63], a[244:247], a[116:119], v[60:63]
    s_cselect_b32 s67, 9, 0
    s_waitcnt lgkmcnt(6)
    v_mfma_f32_16x16x32_bf16 v[72:75], a[248:251], a[40:43], v[72:75]
    ds_read_b128 v[244:247], v28 offset:32768
    v_mfma_f32_16x16x32_bf16 v[76:79], a[248:251], a[44:47], v[76:79]
    s_sub_u32 s66, s66, s67
    s_lshl_b32 s66, s66, 12
    v_mfma_f32_16x16x32_bf16 v[72:75], a[252:255], a[48:51], v[72:75]
    ds_read_b128 a[240:243], v28 offset:33792
    v_mfma_f32_16x16x32_bf16 v[76:79], a[252:255], a[52:55], v[76:79]
    s_add_u32 s66, s66, s59
    buffer_load_dwordx2 v[212:213], v26, s[16:19], s41 offen sc1
    v_mfma_f32_16x16x32_bf16 v[72:75], v[176:179], a[56:59], v[72:75]
    ds_read_b128 a[244:247], v28 offset:34816
    v_mfma_f32_16x16x32_bf16 v[76:79], v[176:179], a[60:63], v[76:79]
    v_cvt_pk_bf16_f32 v56, v56, v57
    v_cvt_pk_bf16_f32 v57, v58, v59
    v_mfma_f32_16x16x32_bf16 v[72:75], v[180:183], a[64:67], v[72:75]
    ds_read_b128 a[248:251], v28 offset:35840
    v_mfma_f32_16x16x32_bf16 v[76:79], v[180:183], a[68:71], v[76:79]
    v_cvt_pk_bf16_f32 v58, v60, v61
    s_waitcnt lgkmcnt(6)
    v_mfma_f32_16x16x32_bf16 v[72:75], v[184:187], a[72:75], v[72:75]
    s_waitcnt vmcnt(14)
    s_barrier
    ds_read_b128 a[252:255], v29 offset:0
    v_mfma_f32_16x16x32_bf16 v[76:79], v[184:187], a[76:79], v[76:79]
    v_cvt_pk_bf16_f32 v59, v62, v63
    buffer_store_dwordx4 v[56:59], v26, s[12:15], s66 offen sc1
    v_mfma_f32_16x16x32_bf16 v[72:75], v[188:191], a[80:83], v[72:75]
    ds_read_b128 v[176:179], v29 offset:1024
    v_mfma_f32_16x16x32_bf16 v[76:79], v[188:191], a[84:87], v[76:79]
    s_add_u32 s69, s31, 294912
    s_add_u32 m0, s26, 36864
    v_mfma_f32_16x16x32_bf16 v[72:75], v[192:195], a[88:91], v[72:75]
    ds_read_b128 v[180:183], v29 offset:2048
    v_mfma_f32_16x16x32_bf16 v[76:79], v[192:195], a[92:95], v[76:79]
    buffer_load_dwordx4 v26, s[8:11], s69 offen offset:0 sc1 lds
    buffer_load_dwordx2 v[214:215], v25, s[16:19], s41 offen sc1
    v_mfma_f32_16x16x32_bf16 v[72:75], v[196:199], a[96:99], v[72:75]
    ds_read_b128 v[184:187], v29 offset:3072
    v_mfma_f32_16x16x32_bf16 v[76:79], v[196:199], a[100:103], v[76:79]
    s_waitcnt lgkmcnt(6)
    v_mfma_f32_16x16x32_bf16 v[72:75], v[200:203], a[104:107], v[72:75]
    ds_read_b128 v[188:191], v29 offset:4096
    v_mfma_f32_16x16x32_bf16 v[76:79], v[200:203], a[108:111], v[76:79]
    buffer_load_dwordx4 v26, s[8:11], s69 offen offset:1024 sc1 lds
    s_add_u32 s66, s20, 2
    v_mfma_f32_16x16x32_bf16 v[72:75], v[204:207], a[112:115], v[72:75]
    ds_read_b128 v[192:195], v29 offset:5120
    v_mfma_f32_16x16x32_bf16 v[76:79], v[204:207], a[116:119], v[76:79]
    s_cmp_ge_u32 s66, 9
    s_cselect_b32 s67, 9, 0
    v_mfma_f32_16x16x32_bf16 v[88:91], v[244:247], a[40:43], v[88:91]
    ds_read_b128 v[196:199], v29 offset:6144
    v_mfma_f32_16x16x32_bf16 v[92:95], v[244:247], a[44:47], v[92:95]
    s_sub_u32 s66, s66, s67
    s_lshl_b32 s66, s66, 12
    v_mfma_f32_16x16x32_bf16 v[88:91], a[240:243], a[48:51], v[88:91]
    ds_read_b128 v[200:203], v29 offset:7168
    v_mfma_f32_16x16x32_bf16 v[92:95], a[240:243], a[52:55], v[92:95]
    s_add_u32 s66, s66, s59
    s_waitcnt lgkmcnt(6)
    v_mfma_f32_16x16x32_bf16 v[88:91], a[244:247], a[56:59], v[88:91]
    ds_read_b128 v[204:207], v29 offset:8192
    v_mfma_f32_16x16x32_bf16 v[92:95], a[244:247], a[60:63], v[92:95]
    buffer_load_dwordx4 v[224:227], v241, s[44:47], s29 offen offset:64
    buffer_load_dwordx4 v26, s[8:11], s69 offen offset:2048 sc1 lds
    v_mfma_f32_16x16x32_bf16 v[88:91], a[248:251], a[64:67], v[88:91]
    ds_read_b128 v[244:247], v29 offset:9216
    v_mfma_f32_16x16x32_bf16 v[92:95], a[248:251], a[68:71], v[92:95]
    v_cvt_pk_bf16_f32 v72, v72, v73
    v_cvt_pk_bf16_f32 v73, v74, v75
    v_mfma_f32_16x16x32_bf16 v[88:91], a[252:255], a[72:75], v[88:91]
    ds_read_b128 a[240:243], v29 offset:10240
    v_mfma_f32_16x16x32_bf16 v[92:95], a[252:255], a[76:79], v[92:95]
    v_cvt_pk_bf16_f32 v74, v76, v77
    v_cvt_pk_bf16_f32 v75, v78, v79
    v_mfma_f32_16x16x32_bf16 v[88:91], v[176:179], a[80:83], v[88:91]
    ds_read_b128 a[244:247], v29 offset:11264
    v_mfma_f32_16x16x32_bf16 v[92:95], v[176:179], a[84:87], v[92:95]
    buffer_store_dwordx4 v[72:75], v26, s[12:15], s66 offen sc1
    s_waitcnt lgkmcnt(6)
    v_mfma_f32_16x16x32_bf16 v[88:91], v[180:183], a[88:91], v[88:91]
    ds_read_b128 a[248:251], v29 offset:12288
    v_mfma_f32_16x16x32_bf16 v[92:95], v[180:183], a[92:95], v[92:95]
    buffer_load_dwordx4 v26, s[8:11], s69 offen offset:3072 sc1 lds
    buffer_load_dwordx2 v[216:217], v26, s[16:19], s42 offen sc1
    v_mfma_f32_16x16x32_bf16 v[88:91], v[184:187], a[96:99], v[88:91]
    ds_read_b128 a[252:255], v29 offset:13312
    v_mfma_f32_16x16x32_bf16 v[92:95], v[184:187], a[100:103], v[92:95]
    v_mfma_f32_16x16x32_bf16 v[88:91], v[188:191], a[104:107], v[88:91]
    ds_read_b128 v[176:179], v29 offset:14336
    v_mfma_f32_16x16x32_bf16 v[92:95], v[188:191], a[108:111], v[92:95]
    s_add_u32 s69, s69, 4096
    s_add_u32 m0, s26, 40960
    v_mfma_f32_16x16x32_bf16 v[88:91], v[192:195], a[112:115], v[88:91]
    ds_read_b128 v[180:183], v29 offset:15360
    v_mfma_f32_16x16x32_bf16 v[92:95], v[192:195], a[116:119], v[92:95]
    buffer_load_dwordx4 v26, s[8:11], s69 offen offset:0 sc1 lds
    s_waitcnt lgkmcnt(6)
    v_mfma_f32_16x16x32_bf16 v[104:107], v[196:199], a[40:43], v[104:107]
    ds_read_b128 v[184:187], v29 offset:16384
    v_mfma_f32_16x16x32_bf16 v[108:111], v[196:199], a[44:47], v[108:111]
    s_add_u32 s66, s20, 3
    s_cmp_ge_u32 s66, 9
    v_mfma_f32_16x16x32_bf16 v[104:107], v[200:203], a[48:51], v[104:107]
    ds_read_b128 v[188:191], v29 offset:17408
    v_mfma_f32_16x16x32_bf16 v[108:111], v[200:203], a[52:55], v[108:111]
    s_cselect_b32 s67, 9, 0
    s_sub_u32 s66, s66, s67
    v_mfma_f32_16x16x32_bf16 v[104:107], v[204:207], a[56:59], v[104:107]
    ds_read_b128 v[192:195], v29 offset:18432
    v_mfma_f32_16x16x32_bf16 v[108:111], v[204:207], a[60:63], v[108:111]
    s_lshl_b32 s66, s66, 12
    s_add_u32 s66, s66, s59
    v_mfma_f32_16x16x32_bf16 v[104:107], v[244:247], a[64:67], v[104:107]
    ds_read_b128 v[196:199], v29 offset:19456
    v_mfma_f32_16x16x32_bf16 v[108:111], v[244:247], a[68:71], v[108:111]
    buffer_load_dwordx2 v[218:219], v25, s[16:19], s42 offen sc1
    s_waitcnt lgkmcnt(6)
    v_mfma_f32_16x16x32_bf16 v[104:107], a[240:243], a[72:75], v[104:107]
    ds_read_b128 v[200:203], v29 offset:20480
    v_mfma_f32_16x16x32_bf16 v[108:111], a[240:243], a[76:79], v[108:111]
    buffer_load_dwordx4 v26, s[8:11], s69 offen offset:1024 sc1 lds
    v_cvt_pk_bf16_f32 v88, v88, v89
    v_mfma_f32_16x16x32_bf16 v[104:107], a[244:247], a[80:83], v[104:107]
    ds_read_b128 v[204:207], v29 offset:21504
    v_mfma_f32_16x16x32_bf16 v[108:111], a[244:247], a[84:87], v[108:111]
    v_cvt_pk_bf16_f32 v89, v90, v91
    v_cvt_pk_bf16_f32 v90, v92, v93
    v_mfma_f32_16x16x32_bf16 v[104:107], a[248:251], a[88:91], v[104:107]
    ds_read_b128 v[244:247], v29 offset:22528
    v_mfma_f32_16x16x32_bf16 v[108:111], a[248:251], a[92:95], v[108:111]
    v_cvt_pk_bf16_f32 v91, v94, v95
    buffer_store_dwordx4 v[88:91], v26, s[12:15], s66 offen sc1
    v_mfma_f32_16x16x32_bf16 v[104:107], a[252:255], a[96:99], v[104:107]
    ds_read_b128 a[240:243], v29 offset:23552
    v_mfma_f32_16x16x32_bf16 v[108:111], a[252:255], a[100:103], v[108:111]
    buffer_load_dwordx4 v26, s[8:11], s69 offen offset:2048 sc1 lds
    s_waitcnt lgkmcnt(6)
    v_mfma_f32_16x16x32_bf16 v[104:107], v[176:179], a[104:107], v[104:107]
    ds_read_b128 a[244:247], v29 offset:24576
    v_mfma_f32_16x16x32_bf16 v[108:111], v[176:179], a[108:111], v[108:111]
    buffer_load_dwordx4 v[228:231], v241, s[44:47], s29 offen offset:128
    buffer_load_dwordx4 v26, s[8:11], s69 offen offset:3072 sc1 lds
    v_mfma_f32_16x16x32_bf16 v[104:107], v[180:183], a[112:115], v[104:107]
    ds_read_b128 a[248:251], v29 offset:25600
    v_mfma_f32_16x16x32_bf16 v[108:111], v[180:183], a[116:119], v[108:111]
    s_add_u32 s66, s20, 4
    s_cmp_ge_u32 s66, 9
    v_mfma_f32_16x16x32_bf16 v[120:123], v[184:187], a[40:43], v[120:123]
    ds_read_b128 a[252:255], v29 offset:26624
    v_mfma_f32_16x16x32_bf16 v[124:127], v[184:187], a[44:47], v[124:127]
    s_cselect_b32 s67, 9, 0
    s_sub_u32 s66, s66, s67
    v_mfma_f32_16x16x32_bf16 v[120:123], v[188:191], a[48:51], v[120:123]
    ds_read_b128 v[176:179], v29 offset:27648
    v_mfma_f32_16x16x32_bf16 v[124:127], v[188:191], a[52:55], v[124:127]
    s_lshl_b32 s66, s66, 12
    s_waitcnt lgkmcnt(6)
    v_mfma_f32_16x16x32_bf16 v[120:123], v[192:195], a[56:59], v[120:123]
    ds_read_b128 v[180:183], v29 offset:28672
    v_mfma_f32_16x16x32_bf16 v[124:127], v[192:195], a[60:63], v[124:127]
    s_add_u32 s66, s66, s59
    s_add_u32 s69, s69, 4096
    v_mfma_f32_16x16x32_bf16 v[120:123], v[196:199], a[64:67], v[120:123]
    ds_read_b128 v[184:187], v29 offset:29696
    v_mfma_f32_16x16x32_bf16 v[124:127], v[196:199], a[68:71], v[124:127]
    s_add_u32 m0, s26, 45056
    s_nop 0
    buffer_load_dwordx4 v26, s[8:11], s69 offen offset:0 sc1 lds
    v_mfma_f32_16x16x32_bf16 v[120:123], v[200:203], a[72:75], v[120:123]
    ds_read_b128 v[188:191], v29 offset:30720
    v_mfma_f32_16x16x32_bf16 v[124:127], v[200:203], a[76:79], v[124:127]
    v_cvt_pk_bf16_f32 v104, v104, v105
    v_cvt_pk_bf16_f32 v105, v106, v107
    v_mfma_f32_16x16x32_bf16 v[120:123], v[204:207], a[80:83], v[120:123]
    ds_read_b128 v[192:195], v29 offset:31744
    v_mfma_f32_16x16x32_bf16 v[124:127], v[204:207], a[84:87], v[124:127]
    v_cvt_pk_bf16_f32 v106, v108, v109
    s_waitcnt lgkmcnt(6)
    v_mfma_f32_16x16x32_bf16 v[120:123], v[244:247], a[88:91], v[120:123]
    ds_read_b128 v[196:199], v29 offset:32768
    v_mfma_f32_16x16x32_bf16 v[124:127], v[244:247], a[92:95], v[124:127]
    v_cvt_pk_bf16_f32 v107, v110, v111
    buffer_store_dwordx4 v[104:107], v26, s[12:15], s66 offen sc1
    v_mfma_f32_16x16x32_bf16 v[120:123], a[240:243], a[96:99], v[120:123]
    ds_read_b128 v[200:203], v29 offset:33792
    v_mfma_f32_16x16x32_bf16 v[124:127], a[240:243], a[100:103], v[124:127]
    v_mfma_f32_16x16x32_bf16 v[120:123], a[244:247], a[104:107], v[120:123]
    ds_read_b128 v[204:207], v29 offset:34816
    v_mfma_f32_16x16x32_bf16 v[124:127], a[244:247], a[108:111], v[124:127]
    s_add_u32 s66, s20, 5
    s_cmp_ge_u32 s66, 9
    v_mfma_f32_16x16x32_bf16 v[120:123], a[248:251], a[112:115], v[120:123]
    ds_read_b128 v[244:247], v29 offset:35840
    v_mfma_f32_16x16x32_bf16 v[124:127], a[248:251], a[116:119], v[124:127]
    s_cselect_b32 s67, 9, 0
    s_waitcnt lgkmcnt(6)
    v_mfma_f32_16x16x32_bf16 v[136:139], a[252:255], a[40:43], v[136:139]
    s_waitcnt vmcnt(20)
    s_barrier
    ds_read_b128 a[240:243], v26 offset:0
    v_mfma_f32_16x16x32_bf16 v[140:143], a[252:255], a[44:47], v[140:143]
    s_sub_u32 s66, s66, s67
    s_lshl_b32 s66, s66, 12
    v_mfma_f32_16x16x32_bf16 v[136:139], v[176:179], a[48:51], v[136:139]
    ds_read_b128 a[244:247], v26 offset:1024
    v_mfma_f32_16x16x32_bf16 v[140:143], v[176:179], a[52:55], v[140:143]
    s_add_u32 s66, s66, s59
    v_mfma_f32_16x16x32_bf16 v[136:139], v[180:183], a[56:59], v[136:139]
    ds_read_b128 a[248:251], v26 offset:2048
    v_mfma_f32_16x16x32_bf16 v[140:143], v[180:183], a[60:63], v[140:143]
    v_cvt_pk_bf16_f32 v120, v120, v121
    v_cvt_pk_bf16_f32 v121, v122, v123
    v_mfma_f32_16x16x32_bf16 v[136:139], v[184:187], a[64:67], v[136:139]
    ds_read_b128 a[252:255], v26 offset:3072
    v_mfma_f32_16x16x32_bf16 v[140:143], v[184:187], a[68:71], v[140:143]
    v_cvt_pk_bf16_f32 v122, v124, v125
    s_waitcnt lgkmcnt(6)
    v_mfma_f32_16x16x32_bf16 v[136:139], v[188:191], a[72:75], v[136:139]
    ds_read_b128 v[176:179], v26 offset:4096
    v_mfma_f32_16x16x32_bf16 v[140:143], v[188:191], a[76:79], v[140:143]
    v_cvt_pk_bf16_f32 v123, v126, v127
    buffer_store_dwordx4 v[120:123], v26, s[12:15], s66 offen sc1
    v_mfma_f32_16x16x32_bf16 v[136:139], v[192:195], a[80:83], v[136:139]
    ds_read_b128 v[180:183], v26 offset:5120
    v_mfma_f32_16x16x32_bf16 v[140:143], v[192:195], a[84:87], v[140:143]
    v_mfma_f32_16x16x32_bf16 v[136:139], v[196:199], a[88:91], v[136:139]
    ds_read_b128 v[184:187], v26 offset:6144
    v_mfma_f32_16x16x32_bf16 v[140:143], v[196:199], a[92:95], v[140:143]
    v_mfma_f32_16x16x32_bf16 v[136:139], v[200:203], a[96:99], v[136:139]
    ds_read_b128 v[188:191], v26 offset:7168
    v_mfma_f32_16x16x32_bf16 v[140:143], v[200:203], a[100:103], v[140:143]
    s_waitcnt lgkmcnt(6)
    v_mfma_f32_16x16x32_bf16 v[136:139], v[204:207], a[104:107], v[136:139]
    ds_read_b128 v[192:195], v26 offset:8192
    v_mfma_f32_16x16x32_bf16 v[140:143], v[204:207], a[108:111], v[140:143]
    s_add_u32 s66, s20, 6
    s_cmp_ge_u32 s66, 9
    v_mfma_f32_16x16x32_bf16 v[136:139], v[244:247], a[112:115], v[136:139]
    ds_read_b128 v[196:199], v26 offset:9216
    v_mfma_f32_16x16x32_bf16 v[140:143], v[244:247], a[116:119], v[140:143]
    s_cselect_b32 s67, 9, 0
    s_sub_u32 s66, s66, s67
    v_mfma_f32_16x16x32_bf16 v[152:155], a[240:243], v[32:35], 0
    ds_read_b128 v[200:203], v26 offset:10240
    v_mfma_f32_16x16x32_bf16 v[156:159], a[240:243], v[36:39], 0
    s_lshl_b32 s66, s66, 12
    s_add_u32 s66, s66, s59
    v_mfma_f32_16x16x32_bf16 v[168:171], a[244:247], v[32:35], 0
    ds_read_b128 v[204:207], v26 offset:11264
    v_mfma_f32_16x16x32_bf16 v[172:175], a[244:247], v[36:39], 0
    s_waitcnt lgkmcnt(6)
    v_mfma_f32_16x16x32_bf16 v[152:155], a[248:251], v[48:51], v[152:155]
    ds_read_b128 v[244:247], v26 offset:12288
    v_mfma_f32_16x16x32_bf16 v[156:159], a[248:251], v[52:55], v[156:159]
    v_cvt_pk_bf16_f32 v136, v136, v137
    v_cvt_pk_bf16_f32 v137, v138, v139
    v_mfma_f32_16x16x32_bf16 v[168:171], a[252:255], v[48:51], v[168:171]
    ds_read_b128 a[240:243], v26 offset:13312
    v_mfma_f32_16x16x32_bf16 v[172:175], a[252:255], v[52:55], v[172:175]
    v_cvt_pk_bf16_f32 v138, v140, v141
    v_cvt_pk_bf16_f32 v139, v142, v143
    v_mfma_f32_16x16x32_bf16 v[152:155], v[176:179], v[64:67], v[152:155]
    ds_read_b128 a[244:247], v26 offset:14336
    v_mfma_f32_16x16x32_bf16 v[156:159], v[176:179], v[68:71], v[156:159]
    buffer_store_dwordx4 v[136:139], v26, s[12:15], s66 offen sc1
    v_mfma_f32_16x16x32_bf16 v[168:171], v[180:183], v[64:67], v[168:171]
    ds_read_b128 a[248:251], v26 offset:15360
    v_mfma_f32_16x16x32_bf16 v[172:175], v[180:183], v[68:71], v[172:175]
    s_waitcnt lgkmcnt(6)
    v_mfma_f32_16x16x32_bf16 v[152:155], v[184:187], v[80:83], v[152:155]
    ds_read_b128 a[252:255], v26 offset:16384
    v_mfma_f32_16x16x32_bf16 v[156:159], v[184:187], v[84:87], v[156:159]
    v_mfma_f32_16x16x32_bf16 v[168:171], v[188:191], v[80:83], v[168:171]
    ds_read_b128 v[176:179], v26 offset:17408
    v_mfma_f32_16x16x32_bf16 v[172:175], v[188:191], v[84:87], v[172:175]
    v_mfma_f32_16x16x32_bf16 v[152:155], v[192:195], v[96:99], v[152:155]
    ds_read_b128 v[180:183], v26 offset:18432
    v_mfma_f32_16x16x32_bf16 v[156:159], v[192:195], v[100:103], v[156:159]
    v_mfma_f32_16x16x32_bf16 v[168:171], v[196:199], v[96:99], v[168:171]
    ds_read_b128 v[184:187], v26 offset:19456
    v_mfma_f32_16x16x32_bf16 v[172:175], v[196:199], v[100:103], v[172:175]
    s_waitcnt lgkmcnt(6)
    v_mfma_f32_16x16x32_bf16 v[152:155], v[200:203], v[112:115], v[152:155]
    ds_read_b128 v[188:191], v26 offset:20480
    v_mfma_f32_16x16x32_bf16 v[156:159], v[200:203], v[116:119], v[156:159]
    v_mfma_f32_16x16x32_bf16 v[168:171], v[204:207], v[112:115], v[168:171]
    ds_read_b128 v[192:195], v26 offset:21504
    v_mfma_f32_16x16x32_bf16 v[172:175], v[204:207], v[116:119], v[172:175]
    v_mfma_f32_16x16x32_bf16 v[152:155], v[244:247], v[128:131], v[152:155]
    ds_read_b128 v[196:199], v26 offset:22528
    v_mfma_f32_16x16x32_bf16 v[156:159], v[244:247], v[132:135], v[156:159]
    v_mfma_f32_16x16x32_bf16 v[168:171], a[240:243], v[128:131], v[168:171]
    ds_read_b128 v[200:203], v26 offset:23552
    v_mfma_f32_16x16x32_bf16 v[172:175], a[240:243], v[132:135], v[172:175]
    s_waitcnt lgkmcnt(6)
    v_mfma_f32_16x16x32_bf16 v[152:155], a[244:247], v[144:147], v[152:155]
    ds_read_b128 v[204:207], v26 offset:24576
    v_mfma_f32_16x16x32_bf16 v[156:159], a[244:247], v[148:151], v[156:159]
    v_mfma_f32_16x16x32_bf16 v[168:171], a[248:251], v[144:147], v[168:171]
    ds_read_b128 v[244:247], v26 offset:25600
    v_mfma_f32_16x16x32_bf16 v[172:175], a[248:251], v[148:151], v[172:175]
    v_mfma_f32_16x16x32_bf16 v[152:155], a[252:255], v[160:163], v[152:155]
    ds_read_b128 a[240:243], v26 offset:26624
    v_mfma_f32_16x16x32_bf16 v[156:159], a[252:255], v[164:167], v[156:159]
    s_lshl_b32 s66, s23, 2
    v_mov_b32 v2, s66
    v_mfma_f32_16x16x32_bf16 v[168:171], v[176:179], v[160:163], v[168:171]
    ds_read_b128 a[244:247], v26 offset:27648
    v_mfma_f32_16x16x32_bf16 v[172:175], v[176:179], v[164:167], v[172:175]
    s_lshl_b32 s64, s22, 12
    s_waitcnt lgkmcnt(6)
    v_mfma_f32_16x16x32_bf16 v[152:155], v[180:183], a[144:147], v[152:155]
    ds_read_b128 a[248:251], v26 offset:28672
    v_mfma_f32_16x16x32_bf16 v[156:159], v[180:183], a[148:151], v[156:159]
    s_add_u32 s64, s64, s56
    s_waitcnt vmcnt(0)
    v_mfma_f32_16x16x32_bf16 v[168:171], v[184:187], a[144:147], v[168:171]
    ds_read_b128 a[252:255], v26 offset:29696
    v_mfma_f32_16x16x32_bf16 v[172:175], v[184:187], a[148:151], v[172:175]
    buffer_store_dword v3, v2, s[36:39], s58 offen sc1
    v_mfma_f32_16x16x32_bf16 v[152:155], v[188:191], a[152:155], v[152:155]
    ds_read_b128 v[176:179], v26 offset:30720
    v_mfma_f32_16x16x32_bf16 v[156:159], v[188:191], a[156:159], v[156:159]
    v_mfma_f32_16x16x32_bf16 v[168:171], v[192:195], a[152:155], v[168:171]
    ds_read_b128 v[180:183], v26 offset:31744
    v_mfma_f32_16x16x32_bf16 v[172:175], v[192:195], a[156:159], v[172:175]
    s_waitcnt lgkmcnt(6)
    v_mfma_f32_16x16x32_bf16 v[152:155], v[196:199], a[160:163], v[152:155]
    ds_read_b128 v[184:187], v26 offset:32768
    v_mfma_f32_16x16x32_bf16 v[156:159], v[196:199], a[164:167], v[156:159]
    v_mfma_f32_16x16x32_bf16 v[168:171], v[200:203], a[160:163], v[168:171]
    ds_read_b128 v[188:191], v26 offset:33792
    v_mfma_f32_16x16x32_bf16 v[172:175], v[200:203], a[164:167], v[172:175]
    v_mfma_f32_16x16x32_bf16 v[152:155], v[204:207], a[168:171], v[152:155]
    ds_read_b128 v[192:195], v26 offset:34816
    v_mfma_f32_16x16x32_bf16 v[156:159], v[204:207], a[172:175], v[156:159]
    v_mfma_f32_16x16x32_bf16 v[168:171], v[244:247], a[168:171], v[168:171]
    ds_read_b128 v[196:199], v26 offset:35840
    v_mfma_f32_16x16x32_bf16 v[172:175], v[244:247], a[172:175], v[172:175]
    s_waitcnt lgkmcnt(6)
    v_mfma_f32_16x16x32_bf16 v[152:155], a[240:243], a[176:179], v[152:155]
    s_barrier
    ds_read_b128 v[200:203], v27 offset:0
    v_mfma_f32_16x16x32_bf16 v[156:159], a[240:243], a[180:183], v[156:159]
    v_mfma_f32_16x16x32_bf16 v[168:171], a[244:247], a[176:179], v[168:171]
    ds_read_b128 v[204:207], v27 offset:1024
    v_mfma_f32_16x16x32_bf16 v[172:175], a[244:247], a[180:183], v[172:175]
    v_mfma_f32_16x16x32_bf16 v[152:155], a[248:251], a[184:187], v[152:155]
    ds_read_b128 v[244:247], v27 offset:2048
    v_mfma_f32_16x16x32_bf16 v[156:159], a[248:251], a[188:191], v[156:159]
    v_mfma_f32_16x16x32_bf16 v[168:171], a[252:255], a[184:187], v[168:171]
    ds_read_b128 a[240:243], v27 offset:3072
    v_mfma_f32_16x16x32_bf16 v[172:175], a[252:255], a[188:191], v[172:175]
    s_waitcnt lgkmcnt(6)
    v_mfma_f32_16x16x32_bf16 v[152:155], v[176:179], a[192:195], v[152:155]
    ds_read_b128 a[244:247], v27 offset:4096
    v_mfma_f32_16x16x32_bf16 v[156:159], v[176:179], a[196:199], v[156:159]
    v_mfma_f32_16x16x32_bf16 v[168:171], v[180:183], a[192:195], v[168:171]
    ds_read_b128 a[248:251], v27 offset:5120
    v_mfma_f32_16x16x32_bf16 v[172:175], v[180:183], a[196:199], v[172:175]
    v_mfma_f32_16x16x32_bf16 v[152:155], v[184:187], a[200:203], v[152:155]
    ds_read_b128 a[252:255], v27 offset:6144
    v_mfma_f32_16x16x32_bf16 v[156:159], v[184:187], a[204:207], v[156:159]
    v_mfma_f32_16x16x32_bf16 v[168:171], v[188:191], a[200:203], v[168:171]
    ds_read_b128 v[176:179], v27 offset:7168
    v_mfma_f32_16x16x32_bf16 v[172:175], v[188:191], a[204:207], v[172:175]
    s_waitcnt lgkmcnt(6)
    v_mfma_f32_16x16x32_bf16 v[152:155], v[192:195], a[208:211], v[152:155]
    ds_read_b128 v[180:183], v27 offset:8192
    v_mfma_f32_16x16x32_bf16 v[156:159], v[192:195], a[212:215], v[156:159]
    v_mfma_f32_16x16x32_bf16 v[168:171], v[196:199], a[208:211], v[168:171]
    ds_read_b128 v[184:187], v27 offset:9216
    v_mfma_f32_16x16x32_bf16 v[172:175], v[196:199], a[212:215], v[172:175]
    v_mfma_f32_16x16x32_bf16 v[152:155], v[200:203], a[216:219], v[152:155]
    ds_read_b128 v[188:191], v27 offset:10240
    v_mfma_f32_16x16x32_bf16 v[156:159], v[200:203], a[220:223], v[156:159]
    buffer_load_dword v252, v5, s[36:39], s58 offen offset:0 sc1
    v_mfma_f32_16x16x32_bf16 v[168:171], v[204:207], a[216:219], v[168:171]
    ds_read_b128 v[192:195], v27 offset:11264
    v_mfma_f32_16x16x32_bf16 v[172:175], v[204:207], a[220:223], v[172:175]
    s_waitcnt lgkmcnt(6)
    v_mfma_f32_16x16x32_bf16 v[152:155], v[244:247], a[224:227], v[152:155]
    ds_read_b128 v[196:199], v27 offset:12288
    v_mfma_f32_16x16x32_bf16 v[156:159], v[244:247], a[228:231], v[156:159]
    v_mfma_f32_16x16x32_bf16 v[168:171], a[240:243], a[224:227], v[168:171]
    ds_read_b128 v[200:203], v27 offset:13312
    v_mfma_f32_16x16x32_bf16 v[172:175], a[240:243], a[228:231], v[172:175]
    v_mfma_f32_16x16x32_bf16 v[152:155], a[244:247], a[232:235], v[152:155]
    ds_read_b128 v[204:207], v27 offset:14336
    v_mfma_f32_16x16x32_bf16 v[156:159], a[244:247], a[236:239], v[156:159]
    v_mfma_f32_16x16x32_bf16 v[168:171], a[248:251], a[232:235], v[168:171]
    ds_read_b128 v[244:247], v27 offset:15360
    v_mfma_f32_16x16x32_bf16 v[172:175], a[248:251], a[236:239], v[172:175]
    s_waitcnt lgkmcnt(6)
    v_mfma_f32_16x16x32_bf16 v[152:155], a[252:255], a[0:3], v[152:155]
    ds_read_b128 a[240:243], v27 offset:16384
    v_mfma_f32_16x16x32_bf16 v[156:159], a[252:255], a[4:7], v[156:159]
    v_mfma_f32_16x16x32_bf16 v[168:171], v[176:179], a[0:3], v[168:171]
    ds_read_b128 a[244:247], v27 offset:17408
    v_mfma_f32_16x16x32_bf16 v[172:175], v[176:179], a[4:7], v[172:175]
    v_mfma_f32_16x16x32_bf16 v[152:155], v[180:183], a[8:11], v[152:155]
    ds_read_b128 a[248:251], v27 offset:18432
    v_mfma_f32_16x16x32_bf16 v[156:159], v[180:183], a[12:15], v[156:159]
    v_mfma_f32_16x16x32_bf16 v[168:171], v[184:187], a[8:11], v[168:171]
    ds_read_b128 a[252:255], v27 offset:19456
    v_mfma_f32_16x16x32_bf16 v[172:175], v[184:187], a[12:15], v[172:175]
    s_waitcnt lgkmcnt(6)
    v_mfma_f32_16x16x32_bf16 v[152:155], v[188:191], a[16:19], v[152:155]
    ds_read_b128 v[176:179], v27 offset:20480
    v_mfma_f32_16x16x32_bf16 v[156:159], v[188:191], a[20:23], v[156:159]
    v_mfma_f32_16x16x32_bf16 v[168:171], v[192:195], a[16:19], v[168:171]
    ds_read_b128 v[180:183], v27 offset:21504
    v_mfma_f32_16x16x32_bf16 v[172:175], v[192:195], a[20:23], v[172:175]
    v_mfma_f32_16x16x32_bf16 v[152:155], v[196:199], a[24:27], v[152:155]
    ds_read_b128 v[184:187], v27 offset:22528
    v_mfma_f32_16x16x32_bf16 v[156:159], v[196:199], a[28:31], v[156:159]
    v_mfma_f32_16x16x32_bf16 v[168:171], v[200:203], a[24:27], v[168:171]
    ds_read_b128 v[188:191], v27 offset:23552
    v_mfma_f32_16x16x32_bf16 v[172:175], v[200:203], a[28:31], v[172:175]
    s_waitcnt lgkmcnt(6)
    v_mfma_f32_16x16x32_bf16 v[152:155], v[204:207], a[32:35], v[152:155]
    ds_read_b128 v[192:195], v27 offset:24576
    v_mfma_f32_16x16x32_bf16 v[156:159], v[204:207], a[36:39], v[156:159]
    v_mfma_f32_16x16x32_bf16 v[168:171], v[244:247], a[32:35], v[168:171]
    ds_read_b128 v[196:199], v27 offset:25600
    v_mfma_f32_16x16x32_bf16 v[172:175], v[244:247], a[36:39], v[172:175]
    v_mfma_f32_16x16x32_bf16 v[152:155], a[240:243], a[40:43], v[152:155]
    ds_read_b128 v[200:203], v27 offset:26624
    v_mfma_f32_16x16x32_bf16 v[156:159], a[240:243], a[44:47], v[156:159]
    v_mfma_f32_16x16x32_bf16 v[168:171], a[244:247], a[40:43], v[168:171]
    ds_read_b128 v[204:207], v27 offset:27648
    v_mfma_f32_16x16x32_bf16 v[172:175], a[244:247], a[44:47], v[172:175]
    s_waitcnt lgkmcnt(6)
    v_mfma_f32_16x16x32_bf16 v[152:155], a[248:251], a[48:51], v[152:155]
    ds_read_b128 v[244:247], v27 offset:28672
    v_mfma_f32_16x16x32_bf16 v[156:159], a[248:251], a[52:55], v[156:159]
    v_mfma_f32_16x16x32_bf16 v[168:171], a[252:255], a[48:51], v[168:171]
    ds_read_b128 a[240:243], v27 offset:29696
    v_mfma_f32_16x16x32_bf16 v[172:175], a[252:255], a[52:55], v[172:175]
    v_mfma_f32_16x16x32_bf16 v[152:155], v[176:179], a[56:59], v[152:155]
    ds_read_b128 a[244:247], v27 offset:30720
    v_mfma_f32_16x16x32_bf16 v[156:159], v[176:179], a[60:63], v[156:159]
    s_waitcnt vmcnt(0)
    s_mov_b32 s67, 400000
ffn_pc7:
    v_cmp_eq_u32 vcc, 1, v252
    s_nop 0
    s_cmp_eq_u64 vcc, exec
    s_cbranch_scc1 ffn_ok7
    s_sub_u32 s67, s67, 1
    s_cbranch_scc1 ffn_ok7
    buffer_load_dword v252, v5, s[36:39], s58 offen offset:0 sc1
    s_waitcnt vmcnt(0)
    s_branch ffn_pc7
ffn_ok7:
    s_add_u32 s67, s23, 1
    s_and_b32 s67, s67, 3
    s_lshl_b32 s67, s67, 10
    s_add_u32 s67, s67, s64
    s_add_u32 s4, s67, 4096
    buffer_load_dwordx4 v[44:47], v26, s[12:15], s67 offen sc1
    buffer_load_dwordx4 v[60:63], v26, s[12:15], s4 offen sc1
    s_add_u32 s67, s23, 2
    s_and_b32 s67, s67, 3
    s_lshl_b32 s67, s67, 10
    s_add_u32 s67, s67, s64
    s_add_u32 s4, s67, 4096
    buffer_load_dwordx4 v[76:79], v26, s[12:15], s67 offen sc1
    buffer_load_dwordx4 v[92:95], v26, s[12:15], s4 offen sc1
    s_add_u32 s67, s23, 3
    s_and_b32 s67, s67, 3
    s_lshl_b32 s67, s67, 10
    s_add_u32 s67, s67, s64
    s_add_u32 s4, s67, 4096
    buffer_load_dwordx4 v[108:111], v26, s[12:15], s67 offen sc1
    buffer_load_dwordx4 v[124:127], v26, s[12:15], s4 offen sc1
    s_sub_u32 s67, s64, 4096
    s_cmp_eq_u32 s23, 3
    s_cselect_b32 s67, s67, 0x70000000
    buffer_load_dwordx4 v[40:43], v26, s[12:15], s67 offen offset:0 sc1
    buffer_load_dwordx4 v[56:59], v26, s[12:15], s67 offen offset:1024 sc1
    buffer_load_dwordx4 v[72:75], v26, s[12:15], s67 offen offset:2048 sc1
    buffer_load_dwordx4 v[88:91], v26, s[12:15], s67 offen offset:3072 sc1
    v_mfma_f32_16x16x32_bf16 v[168:171], v[180:183], a[56:59], v[168:171]
    ds_read_b128 a[248:251], v27 offset:31744
    v_mfma_f32_16x16x32_bf16 v[172:175], v[180:183], a[60:63], v[172:175]
    s_waitcnt lgkmcnt(6)
    v_mfma_f32_16x16x32_bf16 v[152:155], v[184:187], a[64:67], v[152:155]
    ds_read_b128 a[252:255], v27 offset:32768
    v_mfma_f32_16x16x32_bf16 v[156:159], v[184:187], a[68:71], v[156:159]
    v_mfma_f32_16x16x32_bf16 v[168:171], v[188:191], a[64:67], v[168:171]
    ds_read_b128 v[176:179], v27 offset:33792
    v_mfma_f32_16x16x32_bf16 v[172:175], v[188:191], a[68:71], v[172:175]
    v_mfma_f32_16x16x32_bf16 v[152:155], v[192:195], a[72:75], v[152:155]
    ds_read_b128 v[180:183], v27 offset:34816
    v_mfma_f32_16x16x32_bf16 v[156:159], v[192:195], a[76:79], v[156:159]
    v_mfma_f32_16x16x32_bf16 v[168:171], v[196:199], a[72:75], v[168:171]
    ds_read_b128 v[184:187], v27 offset:35840
    v_mfma_f32_16x16x32_bf16 v[172:175], v[196:199], a[76:79], v[172:175]
    s_waitcnt lgkmcnt(6)
    v_mfma_f32_16x16x32_bf16 v[152:155], v[200:203], a[80:83], v[152:155]
    v_mfma_f32_16x16x32_bf16 v[156:159], v[200:203], a[84:87], v[156:159]
    v_mfma_f32_16x16x32_bf16 v[168:171], v[204:207], a[80:83], v[168:171]
    v_mfma_f32_16x16x32_bf16 v[172:175], v[204:207], a[84:87], v[172:175]
    v_mfma_f32_16x16x32_bf16 v[152:155], v[244:247], a[88:91], v[152:155]
    v_mfma_f32_16x16x32_bf16 v[156:159], v[244:247], a[92:95], v[156:159]
    v_mfma_f32_16x16x32_bf16 v[168:171], a[240:243], a[88:91], v[168:171]
    v_mfma_f32_16x16x32_bf16 v[172:175], a[240:243], a[92:95], v[172:175]
    s_waitcnt lgkmcnt(2)
    v_mfma_f32_16x16x32_bf16 v[152:155], a[244:247], a[96:99], v[152:155]
    v_mfma_f32_16x16x32_bf16 v[156:159], a[244:247], a[100:103], v[156:159]
    v_mfma_f32_16x16x32_bf16 v[168:171], a[248:251], a[96:99], v[168:171]
    v_mfma_f32_16x16x32_bf16 v[172:175], a[248:251], a[100:103], v[172:175]
    v_mfma_f32_16x16x32_bf16 v[152:155], a[252:255], a[104:107], v[152:155]
    v_mfma_f32_16x16x32_bf16 v[156:159], a[252:255], a[108:111], v[156:159]
    v_mfma_f32_16x16x32_bf16 v[168:171], v[176:179], a[104:107], v[168:171]
    v_mfma_f32_16x16x32_bf16 v[172:175], v[176:179], a[108:111], v[172:175]
    s_waitcnt lgkmcnt(0)
    v_mfma_f32_16x16x32_bf16 v[152:155], v[180:183], a[112:115], v[152:155]
    v_mfma_f32_16x16x32_bf16 v[156:159], v[180:183], a[116:119], v[156:159]
    v_mfma_f32_16x16x32_bf16 v[168:171], v[184:187], a[112:115], v[168:171]
    v_mfma_f32_16x16x32_bf16 v[172:175], v[184:187], a[116:119], v[172:175]
    s_mov_b32 s16, s62
    s_and_b32 s17, s63, 0xffff
    s_mov_b32 s18, 2359296
    s_mov_b32 s19, 0x20000
    v_rcp_f32 v242, v248
    v_rcp_f32 v246, v249
    v_sub_u32 v9, 31, v6
    s_mov_b32 s67, 1179648
    s_cmp_gt_u32 s27, 32
    s_cselect_b64 vcc, -1, 0
    s_cselect_b32 s67, 4293787648, s67
    v_cndmask_b32 v8, v6, v9, vcc
    v_lshlrev_b32 v8, 6, v8
    v_add_u32 v8, s27, v8
    v_mul_u32_u24 v8, 1152, v8
    v_lshl_add_u32 v8, v7, 3, v8
    v_add_u32 v9, s67, v8
    s_mul_i32 s64, s21, 288
    s_lshl_b32 s49, s22, 5
    s_add_u32 s64, s64, s49
    s_waitcnt vmcnt(0)
    s_cmp_eq_u32 s23, 3
    s_cbranch_scc1 ffn_q3
    v_lshlrev_b32 v10, 16, v44
    v_and_b32 v11, s6, v44
    v_pk_add_f32 v[152:153], v[152:153], v[10:11]
    v_lshlrev_b32 v10, 16, v76
    v_and_b32 v11, s6, v76
    v_pk_add_f32 v[152:153], v[152:153], v[10:11]
    v_lshlrev_b32 v10, 16, v108
    v_and_b32 v11, s6, v108
    v_pk_add_f32 v[152:153], v[152:153], v[10:11]
    v_pk_mul_f32 v[152:153], v[152:153], v[242:243] op_sel_hi:[1,0]
    v_lshlrev_b32 v10, 16, v208
    v_and_b32 v11, s6, v208
    v_pk_fma_f32 v[152:153], v[152:153], v[220:221], v[10:11]
    v_cvt_pk_bf16_f32 v208, v152, v153
    v_lshlrev_b32 v10, 16, v45
    v_and_b32 v11, s6, v45
    v_pk_add_f32 v[154:155], v[154:155], v[10:11]
    v_lshlrev_b32 v10, 16, v77
    v_and_b32 v11, s6, v77
    v_pk_add_f32 v[154:155], v[154:155], v[10:11]
    v_lshlrev_b32 v10, 16, v109
    v_and_b32 v11, s6, v109
    v_pk_add_f32 v[154:155], v[154:155], v[10:11]
    v_pk_mul_f32 v[154:155], v[154:155], v[242:243] op_sel_hi:[1,0]
    v_lshlrev_b32 v10, 16, v209
    v_and_b32 v11, s6, v209
    v_pk_fma_f32 v[154:155], v[154:155], v[222:223], v[10:11]
    v_cvt_pk_bf16_f32 v209, v154, v155
    buffer_store_dwordx2 v[208:209], v8, s[16:19], s64 offen offset:0
    v_lshlrev_b32 v10, 16, v46
    v_and_b32 v11, s6, v46
    v_pk_add_f32 v[156:157], v[156:157], v[10:11]
    v_lshlrev_b32 v10, 16, v78
    v_and_b32 v11, s6, v78
    v_pk_add_f32 v[156:157], v[156:157], v[10:11]
    v_lshlrev_b32 v10, 16, v110
    v_and_b32 v11, s6, v110
    v_pk_add_f32 v[156:157], v[156:157], v[10:11]
    v_pk_mul_f32 v[156:157], v[156:157], v[246:247] op_sel_hi:[1,0]
    v_lshlrev_b32 v10, 16, v210
    v_and_b32 v11, s6, v210
    v_pk_fma_f32 v[156:157], v[156:157], v[220:221], v[10:11]
    v_cvt_pk_bf16_f32 v210, v156, v157
    v_lshlrev_b32 v10, 16, v47
    v_and_b32 v11, s6, v47
    v_pk_add_f32 v[158:159], v[158:159], v[10:11]
    v_lshlrev_b32 v10, 16, v79
    v_and_b32 v11, s6, v79
    v_pk_add_f32 v[158:159], v[158:159], v[10:11]
    v_lshlrev_b32 v10, 16, v111
    v_and_b32 v11, s6, v111
    v_pk_add_f32 v[158:159], v[158:159], v[10:11]
    v_pk_mul_f32 v[158:159], v[158:159], v[246:247] op_sel_hi:[1,0]
    v_lshlrev_b32 v10, 16, v211
    v_and_b32 v11, s6, v211
    v_pk_fma_f32 v[158:159], v[158:159], v[222:223], v[10:11]
    v_cvt_pk_bf16_f32 v211, v158, v159
    buffer_store_dwordx2 v[210:211], v9, s[16:19], s64 offen offset:0
    v_lshlrev_b32 v10, 16, v60
    v_and_b32 v11, s6, v60
    v_pk_add_f32 v[168:169], v[168:169], v[10:11]
    v_lshlrev_b32 v10, 16, v92
    v_and_b32 v11, s6, v92
    v_pk_add_f32 v[168:169], v[168:169], v[10:11]
    v_lshlrev_b32 v10, 16, v124
    v_and_b32 v11, s6, v124
    v_pk_add_f32 v[168:169], v[168:169], v[10:11]
    v_pk_mul_f32 v[168:169], v[168:169], v[242:243] op_sel_hi:[1,0]
    v_lshlrev_b32 v10, 16, v212
    v_and_b32 v11, s6, v212
    v_pk_fma_f32 v[168:169], v[168:169], v[224:225], v[10:11]
    v_cvt_pk_bf16_f32 v212, v168, v169
    v_lshlrev_b32 v10, 16, v61
    v_and_b32 v11, s6, v61
    v_pk_add_f32 v[170:171], v[170:171], v[10:11]
    v_lshlrev_b32 v10, 16, v93
    v_and_b32 v11, s6, v93
    v_pk_add_f32 v[170:171], v[170:171], v[10:11]
    v_lshlrev_b32 v10, 16, v125
    v_and_b32 v11, s6, v125
    v_pk_add_f32 v[170:171], v[170:171], v[10:11]
    v_pk_mul_f32 v[170:171], v[170:171], v[242:243] op_sel_hi:[1,0]
    v_lshlrev_b32 v10, 16, v213
    v_and_b32 v11, s6, v213
    v_pk_fma_f32 v[170:171], v[170:171], v[226:227], v[10:11]
    v_cvt_pk_bf16_f32 v213, v170, v171
    buffer_store_dwordx2 v[212:213], v8, s[16:19], s64 offen offset:32
    v_lshlrev_b32 v10, 16, v62
    v_and_b32 v11, s6, v62
    v_pk_add_f32 v[172:173], v[172:173], v[10:11]
    v_lshlrev_b32 v10, 16, v94
    v_and_b32 v11, s6, v94
    v_pk_add_f32 v[172:173], v[172:173], v[10:11]
    v_lshlrev_b32 v10, 16, v126
    v_and_b32 v11, s6, v126
    v_pk_add_f32 v[172:173], v[172:173], v[10:11]
    v_pk_mul_f32 v[172:173], v[172:173], v[246:247] op_sel_hi:[1,0]
    v_lshlrev_b32 v10, 16, v214
    v_and_b32 v11, s6, v214
    v_pk_fma_f32 v[172:173], v[172:173], v[224:225], v[10:11]
    v_cvt_pk_bf16_f32 v214, v172, v173
    v_lshlrev_b32 v10, 16, v63
    v_and_b32 v11, s6, v63
    v_pk_add_f32 v[174:175], v[174:175], v[10:11]
    v_lshlrev_b32 v10, 16, v95
    v_and_b32 v11, s6, v95
    v_pk_add_f32 v[174:175], v[174:175], v[10:11]
    v_lshlrev_b32 v10, 16, v127
    v_and_b32 v11, s6, v127
    v_pk_add_f32 v[174:175], v[174:175], v[10:11]
    v_pk_mul_f32 v[174:175], v[174:175], v[246:247] op_sel_hi:[1,0]
    v_lshlrev_b32 v10, 16, v215
    v_and_b32 v11, s6, v215
    v_pk_fma_f32 v[174:175], v[174:175], v[226:227], v[10:11]
    v_cvt_pk_bf16_f32 v215, v174, v175
    buffer_store_dwordx2 v[214:215], v9, s[16:19], s64 offen offset:32
    s_branch ffn_end
ffn_q3:
    s_sub_u32 s64, s64, 32
    v_mov_b32 v176, 0
    v_mov_b32 v177, 0
    v_mov_b32 v178, 0
    v_mov_b32 v179, 0
    v_mov_b32 v180, 0
    v_mov_b32 v181, 0
    v_mov_b32 v182, 0
    v_mov_b32 v183, 0
    v_lshlrev_b32 v10, 16, v44
    v_and_b32 v11, s6, v44
    v_pk_add_f32 v[152:153], v[152:153], v[10:11]
    v_lshlrev_b32 v10, 16, v76
    v_and_b32 v11, s6, v76
    v_pk_add_f32 v[152:153], v[152:153], v[10:11]
    v_lshlrev_b32 v10, 16, v108
    v_and_b32 v11, s6, v108
    v_pk_add_f32 v[152:153], v[152:153], v[10:11]
    v_pk_mul_f32 v[152:153], v[152:153], v[242:243] op_sel_hi:[1,0]
    v_lshlrev_b32 v10, 16, v212
    v_and_b32 v11, s6, v212
    v_pk_fma_f32 v[152:153], v[152:153], v[224:225], v[10:11]
    v_cvt_pk_bf16_f32 v212, v152, v153
    v_lshlrev_b32 v10, 16, v45
    v_and_b32 v11, s6, v45
    v_pk_add_f32 v[154:155], v[154:155], v[10:11]
    v_lshlrev_b32 v10, 16, v77
    v_and_b32 v11, s6, v77
    v_pk_add_f32 v[154:155], v[154:155], v[10:11]
    v_lshlrev_b32 v10, 16, v109
    v_and_b32 v11, s6, v109
    v_pk_add_f32 v[154:155], v[154:155], v[10:11]
    v_pk_mul_f32 v[154:155], v[154:155], v[242:243] op_sel_hi:[1,0]
    v_lshlrev_b32 v10, 16, v213
    v_and_b32 v11, s6, v213
    v_pk_fma_f32 v[154:155], v[154:155], v[226:227], v[10:11]
    v_cvt_pk_bf16_f32 v213, v154, v155
    buffer_store_dwordx2 v[212:213], v8, s[16:19], s64 offen offset:32
    v_lshlrev_b32 v10, 16, v46
    v_and_b32 v11, s6, v46
    v_pk_add_f32 v[156:157], v[156:157], v[10:11]
    v_lshlrev_b32 v10, 16, v78
    v_and_b32 v11, s6, v78
    v_pk_add_f32 v[156:157], v[156:157], v[10:11]
    v_lshlrev_b32 v10, 16, v110
    v_and_b32 v11, s6, v110
    v_pk_add_f32 v[156:157], v[156:157], v[10:11]
    v_pk_mul_f32 v[156:157], v[156:157], v[246:247] op_sel_hi:[1,0]
    v_lshlrev_b32 v10, 16, v214
    v_and_b32 v11, s6, v214
    v_pk_fma_f32 v[156:157], v[156:157], v[224:225], v[10:11]
    v_cvt_pk_bf16_f32 v214, v156, v157
    v_lshlrev_b32 v10, 16, v47
    v_and_b32 v11, s6, v47
    v_pk_add_f32 v[158:159], v[158:159], v[10:11]
    v_lshlrev_b32 v10, 16, v79
    v_and_b32 v11, s6, v79
    v_pk_add_f32 v[158:159], v[158:159], v[10:11]
    v_lshlrev_b32 v10, 16, v111
    v_and_b32 v11, s6, v111
    v_pk_add_f32 v[158:159], v[158:159], v[10:11]
    v_pk_mul_f32 v[158:159], v[158:159], v[246:247] op_sel_hi:[1,0]
    v_lshlrev_b32 v10, 16, v215
    v_and_b32 v11, s6, v215
    v_pk_fma_f32 v[158:159], v[158:159], v[226:227], v[10:11]
    v_cvt_pk_bf16_f32 v215, v158, v159
    buffer_store_dwordx2 v[214:215], v9, s[16:19], s64 offen offset:32
    v_lshlrev_b32 v10, 16, v60
    v_and_b32 v11, s6, v60
    v_pk_add_f32 v[168:169], v[168:169], v[10:11]
    v_lshlrev_b32 v10, 16, v92
    v_and_b32 v11, s6, v92
    v_pk_add_f32 v[168:169], v[168:169], v[10:11]
    v_lshlrev_b32 v10, 16, v124
    v_and_b32 v11, s6, v124
    v_pk_add_f32 v[168:169], v[168:169], v[10:11]
    v_pk_mul_f32 v[168:169], v[168:169], v[242:243] op_sel_hi:[1,0]
    v_lshlrev_b32 v10, 16, v216
    v_and_b32 v11, s6, v216
    v_pk_fma_f32 v[168:169], v[168:169], v[228:229], v[10:11]
    v_cvt_pk_bf16_f32 v216, v168, v169
    v_lshlrev_b32 v10, 16, v61
    v_and_b32 v11, s6, v61
    v_pk_add_f32 v[170:171], v[170:171], v[10:11]
    v_lshlrev_b32 v10, 16, v93
    v_and_b32 v11, s6, v93
    v_pk_add_f32 v[170:171], v[170:171], v[10:11]
    v_lshlrev_b32 v10, 16, v125
    v_and_b32 v11, s6, v125
    v_pk_add_f32 v[170:171], v[170:171], v[10:11]
    v_pk_mul_f32 v[170:171], v[170:171], v[242:243] op_sel_hi:[1,0]
    v_lshlrev_b32 v10, 16, v217
    v_and_b32 v11, s6, v217
    v_pk_fma_f32 v[170:171], v[170:171], v[230:231], v[10:11]
    v_cvt_pk_bf16_f32 v217, v170, v171
    buffer_store_dwordx2 v[216:217], v8, s[16:19], s64 offen offset:64
    v_lshlrev_b32 v10, 16, v62
    v_and_b32 v11, s6, v62
    v_pk_add_f32 v[172:173], v[172:173], v[10:11]
    v_lshlrev_b32 v10, 16, v94
    v_and_b32 v11, s6, v94
    v_pk_add_f32 v[172:173], v[172:173], v[10:11]
    v_lshlrev_b32 v10, 16, v126
    v_and_b32 v11, s6, v126
    v_pk_add_f32 v[172:173], v[172:173], v[10:11]
    v_pk_mul_f32 v[172:173], v[172:173], v[246:247] op_sel_hi:[1,0]
    v_lshlrev_b32 v10, 16, v218
    v_and_b32 v11, s6, v218
    v_pk_fma_f32 v[172:173], v[172:173], v[228:229], v[10:11]
    v_cvt_pk_bf16_f32 v218, v172, v173
    v_lshlrev_b32 v10, 16, v63
    v_and_b32 v11, s6, v63
    v_pk_add_f32 v[174:175], v[174:175], v[10:11]
    v_lshlrev_b32 v10, 16, v95
    v_and_b32 v11, s6, v95
    v_pk_add_f32 v[174:175], v[174:175], v[10:11]
    v_lshlrev_b32 v10, 16, v127
    v_and_b32 v11, s6, v127
    v_pk_add_f32 v[174:175], v[174:175], v[10:11]
    v_pk_mul_f32 v[174:175], v[174:175], v[246:247] op_sel_hi:[1,0]
    v_lshlrev_b32 v10, 16, v219
    v_and_b32 v11, s6, v219
    v_pk_fma_f32 v[174:175], v[174:175], v[230:231], v[10:11]
    v_cvt_pk_bf16_f32 v219, v174, v175
    buffer_store_dwordx2 v[218:219], v9, s[16:19], s64 offen offset:64
    v_lshlrev_b32 v10, 16, v40
    v_and_b32 v11, s6, v40
    v_pk_add_f32 v[176:177], v[176:177], v[10:11]
    v_lshlrev_b32 v10, 16, v56
    v_and_b32 v11, s6, v56
    v_pk_add_f32 v[176:177], v[176:177], v[10:11]
    v_lshlrev_b32 v10, 16, v72
    v_and_b32 v11, s6, v72
    v_pk_add_f32 v[176:177], v[176:177], v[10:11]
    v_lshlrev_b32 v10, 16, v88
    v_and_b32 v11, s6, v88
    v_pk_add_f32 v[176:177], v[176:177], v[10:11]
    v_pk_mul_f32 v[176:177], v[176:177], v[242:243] op_sel_hi:[1,0]
    v_lshlrev_b32 v10, 16, v208
    v_and_b32 v11, s6, v208
    v_pk_fma_f32 v[176:177], v[176:177], v[220:221], v[10:11]
    v_cvt_pk_bf16_f32 v208, v176, v177
    v_lshlrev_b32 v10, 16, v41
    v_and_b32 v11, s6, v41
    v_pk_add_f32 v[178:179], v[178:179], v[10:11]
    v_lshlrev_b32 v10, 16, v57
    v_and_b32 v11, s6, v57
    v_pk_add_f32 v[178:179], v[178:179], v[10:11]
    v_lshlrev_b32 v10, 16, v73
    v_and_b32 v11, s6, v73
    v_pk_add_f32 v[178:179], v[178:179], v[10:11]
    v_lshlrev_b32 v10, 16, v89
    v_and_b32 v11, s6, v89
    v_pk_add_f32 v[178:179], v[178:179], v[10:11]
    v_pk_mul_f32 v[178:179], v[178:179], v[242:243] op_sel_hi:[1,0]
    v_lshlrev_b32 v10, 16, v209
    v_and_b32 v11, s6, v209
    v_pk_fma_f32 v[178:179], v[178:179], v[222:223], v[10:11]
    v_cvt_pk_bf16_f32 v209, v178, v179
    buffer_store_dwordx2 v[208:209], v8, s[16:19], s64 offen offset:0
    v_lshlrev_b32 v10, 16, v42
    v_and_b32 v11, s6, v42
    v_pk_add_f32 v[180:181], v[180:181], v[10:11]
    v_lshlrev_b32 v10, 16, v58
    v_and_b32 v11, s6, v58
    v_pk_add_f32 v[180:181], v[180:181], v[10:11]
    v_lshlrev_b32 v10, 16, v74
    v_and_b32 v11, s6, v74
    v_pk_add_f32 v[180:181], v[180:181], v[10:11]
    v_lshlrev_b32 v10, 16, v90
    v_and_b32 v11, s6, v90
    v_pk_add_f32 v[180:181], v[180:181], v[10:11]
    v_pk_mul_f32 v[180:181], v[180:181], v[246:247] op_sel_hi:[1,0]
    v_lshlrev_b32 v10, 16, v210
    v_and_b32 v11, s6, v210
    v_pk_fma_f32 v[180:181], v[180:181], v[220:221], v[10:11]
    v_cvt_pk_bf16_f32 v210, v180, v181
    v_lshlrev_b32 v10, 16, v43
    v_and_b32 v11, s6, v43
    v_pk_add_f32 v[182:183], v[182:183], v[10:11]
    v_lshlrev_b32 v10, 16, v59
    v_and_b32 v11, s6, v59
    v_pk_add_f32 v[182:183], v[182:183], v[10:11]
    v_lshlrev_b32 v10, 16, v75
    v_and_b32 v11, s6, v75
    v_pk_add_f32 v[182:183], v[182:183], v[10:11]
    v_lshlrev_b32 v10, 16, v91
    v_and_b32 v11, s6, v91
    v_pk_add_f32 v[182:183], v[182:183], v[10:11]
    v_pk_mul_f32 v[182:183], v[182:183], v[246:247] op_sel_hi:[1,0]
    v_lshlrev_b32 v10, 16, v211
    v_and_b32 v11, s6, v211
    v_pk_fma_f32 v[182:183], v[182:183], v[222:223], v[10:11]
    v_cvt_pk_bf16_f32 v211, v182, v183
    buffer_store_dwordx2 v[210:211], v9, s[16:19], s64 offen offset:0
ffn_end:
ffn_done:
    s_endpgm
.p2align 10
code_end:
    s_endpgm
.p2align 10
    s_endpgm
.section .rodata,"a"
.p2align 6
.amdhsa_kernel ka_kernel
  .amdhsa_next_free_vgpr 128
  .amdhsa_next_free_sgpr 100
  .amdhsa_accum_offset 128
  .amdhsa_group_segment_fixed_size 0
  .amdhsa_kernarg_size 104
  .amdhsa_user_sgpr_count 2
  .amdhsa_user_sgpr_kernarg_segment_ptr 1
  .amdhsa_system_sgpr_workgroup_id_x 1
.end_amdhsa_kernel
.p2align 6
.amdhsa_kernel kbf_kernel
  .amdhsa_next_free_vgpr 512
  .amdhsa_next_free_sgpr 102
  .amdhsa_accum_offset 256
  .amdhsa_group_segment_fixed_size 0
  .amdhsa_kernarg_size 104
  .amdhsa_user_sgpr_count 2
  .amdhsa_user_sgpr_kernarg_segment_ptr 1
  .amdhsa_system_sgpr_workgroup_id_x 1
.end_amdhsa_kernel
```
